```python
import torch

def _softmax(x, axis=-1):
    return torch.softmax(x, dim=axis)
def _gelu(x):
    return torch.nn.functional.gelu(x, approximate="tanh")
def _silu(x):
    return torch.nn.functional.silu(x)
def _sigmoid(x):
    return torch.sigmoid(x)
def _layernorm(x, axis=-1, eps=1e-5):
    m = x.mean(dim=axis, keepdim=True)
    v = x.var(dim=axis, keepdim=True, unbiased=False)
    return (x - m) / torch.sqrt(v + eps)
def _scatter_add(tgt, idx, src, axis=0):
    return tgt.clone().index_add_(axis, idx, src)
def _segment_sum(src, seg, n):
    out = torch.zeros((n,) + src.shape[1:], dtype=src.dtype)
    return out.index_add_(0, seg, src)
def _pad(x, pw):
    flat = tuple(v for pair in reversed(pw) for v in pair)
    return torch.nn.functional.pad(x, flat)

kernel_name = 'sequential_preLN__ssm_conv_h3__glu_gated_swiglu__prompt'

def setup_inputs():

    _w = (lambda a: (lambda t: t.to(torch.bfloat16) if t.is_floating_point() else t)(torch.as_tensor(a)))
    def _A_setup():
        B, S, D = 1, 2048, 640
        ks = 4
        return {
            "q": _w((lambda *s: torch.randn(*s, dtype=torch.bfloat16) * 0.05)(B, S, D)),
            "k": _w((lambda *s: torch.randn(*s, dtype=torch.bfloat16) * 0.2)(B, S, D)),
            "v": _w((lambda *s: torch.randn(*s, dtype=torch.bfloat16) * 0.2)(B, S, D)),
            "shift_k": _w((lambda *s: torch.randn(*s, dtype=torch.bfloat16) * 0.2)(D, ks) * 0.5),
            "ssm_k": _w((lambda *s: torch.randn(*s, dtype=torch.bfloat16) * 0.4)(D, S) * (1.0 / S ** 0.5)),
            "ssm_D": _w((lambda *s: torch.randn(*s, dtype=torch.bfloat16) * 0.2)(D)),
        }
    _A_in = _A_setup()

    def _B_setup():
        B, S, D, F = 1, 2048, 640, 1536
        return {
            "x": _w((lambda *s: torch.randn(*s, dtype=torch.bfloat16) * 0.05)(B, S, D)),
            "w1": _w((lambda *s: torch.randn(*s, dtype=torch.bfloat16) * 0.2)(D, F) * (2.0 / D) ** 0.5),
            "w3": _w((lambda *s: torch.randn(*s, dtype=torch.bfloat16) * 0.2)(D, F) * (2.0 / D) ** 0.5),
            "w2": _w((lambda *s: torch.randn(*s, dtype=torch.bfloat16) * 0.2)(F, D) * (2.0 / F) ** 0.5),
        }
    _B_in = _B_setup()

    return {
        "A_q": _A_in["q"],
        "A_k": _A_in["k"],
        "A_v": _A_in["v"],
        "A_shift_k": _A_in["shift_k"],
        "A_ssm_k": _A_in["ssm_k"],
        "A_ssm_D": _A_in["ssm_D"],
        "B_x": _B_in["x"],
        "B_w1": _B_in["w1"],
        "B_w3": _B_in["w3"],
        "B_w2": _B_in["w2"],
    }

def reference(A_q, A_k, A_v, A_shift_k, A_ssm_k, A_ssm_D, B_x, B_w1, B_w3, B_w2):
    def _A_ref(q, k, v, shift_k, ssm_k, ssm_D):
        B, S, D = q.shape
        ks = shift_k.shape[-1]
        k_pad = _pad(k, ((0, 0), (ks - 1, 0), (0, 0)))
        k_shift = torch.zeros_like(k)
        for t in range(ks):
            k_shift = k_shift + k_pad[:, t:t + S, :] * shift_k[:, ks - 1 - t][None, None, :]
        kv = k_shift * v
        L = 2 * S
        kv_pad = _pad(kv, ((0, 0), (0, S), (0, 0)))
        kf_pad = _pad(ssm_k, ((0, 0), (0, S)))
        kv_f = (lambda x, axes=(-2,-1): torch.fft.rfft2(x.float(), dim=axes))(kv_pad[:, None, :, :], axes=(1, 2))
        kf_f = (lambda x, axes=(-2,-1): torch.fft.rfft2(x.float(), dim=axes))(kf_pad[:, None, :], axes=(1, 2))
        kf_f = (lambda x, *d: x.permute(*d))(kf_f, 1, 2, 0)
        y_f = kv_f * kf_f[None, :, :, :]
        y = (lambda x, s, axes=(-2,-1): torch.fft.irfft2(x, s=s, dim=axes).to(torch.bfloat16))(y_f, (1, L), axes=(1, 2))[:, 0, :S, :]
        y = y + kv * ssm_D[None, None, :]
        return q * y

    def _B_ref(x, w1, w3, w2):
        gate = torch.einsum("bsd,df->bsf", x, w1)
        up = torch.einsum("bsd,df->bsf", x, w3)
        h = _silu(gate) * up
        out = torch.einsum("bsf,fd->bsd", h, w2)
        return out

    x = A_q
    h = x + _A_ref(_layernorm(x, axis=-1), A_k, A_v, A_shift_k, A_ssm_k, A_ssm_D)
    h2 = h + _B_ref(_layernorm(h, axis=-1), B_w1, B_w3, B_w2)
    return h2
```

```asm
; @launch grid=(256,1,1) block=(256,1,1) lds=163840
.amdgcn_target "amdgcn-amd-amdhsa--gfx950"
.text
.globl sequential_preLN__ssm_conv_h3__glu_gated_swiglu__prompt_kernel
.p2align 8
.type sequential_preLN__ssm_conv_h3__glu_gated_swiglu__prompt_kernel,@function
sequential_preLN__ssm_conv_h3__glu_gated_swiglu__prompt_kernel:
    s_load_dwordx16 s[64:79], s[0:1], 0
    s_load_dwordx8 s[32:39], s[0:1], 64
    s_load_dwordx2 s[80:81], s[0:1], 96
    s_cmp_ge_u32 s2, 256
    s_cbranch_scc1 L_end
    v_lshrrev_b32 v2, 6, v0
    v_and_b32 v1, 63, v0
    v_readfirstlane_b32 s3, v2
    s_and_b32 s4, s2, 7
    s_lshr_b32 s5, s2, 3
    s_lshl_b32 s6, s4, 4
    s_and_b32 s12, s2, 128
    s_add_u32 s6, s6, s12
    s_and_b32 s12, s5, 15
    s_add_u32 s6, s6, s12
    s_mul_i32 s13, s6, 10240
    s_cmp_lg_u32 s3, 3
    s_cbranch_scc1 L_nopf_1
    s_getpc_b64 s[90:91]
L_pc:
    s_sub_u32 s90, s90, L_pc-sequential_preLN__ssm_conv_h3__glu_gated_swiglu__prompt_kernel
    s_subb_u32 s91, s91, 0
    s_lshl_b32 s14, s5, 11
    v_lshlrev_b32 v9, 7, v1
    v_add_u32 v9, s14, v9
    v_min_u32 v9, CODE_PF_MAX, v9
    s_mov_b64 exec, 0xffff
    global_load_dword v252, v9, s[90:91]
    s_mov_b64 exec, -1
    s_cmp_lt_u32 s5, 20
    s_cbranch_scc1 L_p0_stc
    s_branch L_p0_stf
L_nopf_1:
    s_cmp_ge_u32 s5, 20
    s_cbranch_scc1 L_p0_kvf
L_p0_kvc:
    v_lshlrev_b32 v2, 3, v0
    v_add_u32 v78, s13, v2
    v_subrev_u32 v79, 3840, v78
    v_lshlrev_b32 v80, 5, v0
    s_movk_i32 s11, 160
    s_mov_b32 s50, 2621440
    s_mov_b32 s51, 0x20000
    s_mov_b32 s54, 2621440
    s_mov_b32 s55, 0x20000
    s_mov_b32 s46, 2621440
    s_mov_b32 s47, 0x20000
    s_mov_b32 s58, 5120
    s_mov_b32 s59, 0x20000
    s_mov_b32 s82, 21790720
    s_mov_b32 s83, 0x20000
    s_mov_b32 s63, 0x20000
    s_mul_i32 s16, s4, 20
    s_add_u32 s16, s16, s5
    s_lshl_b32 s16, s16, 2
    s_add_u32 s16, s16, s3
    s_movk_i32 s62, 4096
    s_mov_b32 s8, 0x05040100
    s_mov_b32 s9, 0x07060302
    s_mov_b32 s10, 0xffff0000
    v_lshlrev_b32 v2, 4, v1
    s_lshl_b32 s14, s3, 12
    s_lshl_b32 s15, s4, 8
    s_add_u32 s14, s14, s15
    s_lshl_b32 s15, s5, 2
    s_add_u32 s14, s14, s15
    v_lshl_add_u32 v4, v1, 11, s14
    s_lshr_b32 s17, s5, 2
    s_lshr_b32 s14, s4, 2
    s_lshl_b32 s14, s14, 3
    s_add_u32 s17, s17, s14
    s_and_b32 s18, s5, 3
    s_and_b32 s14, s4, 3
    s_lshl_b32 s14, s14, 2
    s_add_u32 s18, s18, s14
    s_and_b32 s19, s18, 7
    s_lshr_b32 s20, s18, 3
    s_lshl_b32 s14, s17, 10
    s_lshl_b32 s15, s3, 8
    s_add_u32 s15, s15, s14
    s_lshl_b32 s43, s18, 2
    s_add_u32 s15, s15, s43
    s_cmp_lt_u32 s3, 4
    s_cselect_b32 s15, s15, 0x7ff00000
    v_mov_b32 v3, s15
    s_lshr_b32 s15, s18, 2
    s_lshl_b32 s15, s15, 8
    s_add_u32 s14, s14, s15
    v_and_b32 v7, 3, v1
    v_lshl_add_u32 v7, v7, 4, s14
    s_lshl_b32 s14, s18, 2
    s_add_u32 s14, s14, s3
    s_mul_i32 s88, s14, 61440
    s_add_u32 s88, s88, 8650752
    s_lshl_b32 s14, s19, 2
    s_add_u32 s14, s14, s3
    s_mul_i32 s89, s14, 61440
    s_add_u32 s89, s89, 12582912
    s_lshl_b32 s14, s17, 1
    s_add_u32 s14, s14, s20
    s_mul_i32 s40, s14, 98816
    s_mul_i32 s14, s3, 12288
    s_add_u32 s40, s40, s14
    s_add_u32 s40, s40, 14680064
    v_mul_u32_u24 v206, 144, v0
    v_add_u32 v206, 0, v206
    v_lshrrev_b32 v170, 3, v1
    v_and_b32 v171, 7, v1
    v_lshlrev_b32 v171, 4, v171
    v_mul_u32_u24 v172, 144, v170
    s_mul_i32 s15, s3, 5760
    s_add_u32 s15, s15, 0
    v_add3_u32 v172, v172, v171, s15
    v_mul_u32_u24 v173, 32896, v170
    s_mul_i32 s14, s3, 1315840
    s_lshl_b32 s15, s6, 7
    s_add_u32 s14, s14, s15
    v_add3_u32 v173, v173, v171, s14
    v_cmp_gt_u32 s[30:31], s11, v0
    s_waitcnt lgkmcnt(0)
    s_mov_b64 s[48:49], s[66:67]
    s_mov_b64 s[56:57], s[70:71]
    s_mov_b64 s[52:53], s[68:69]
    s_mov_b32 s14, 5120
    s_mov_b64 exec, s[30:31]
    buffer_load_dwordx2 v[40:41], v79, s[48:51], 0 offen offset:0 nt
    buffer_load_dwordx2 v[42:43], v79, s[48:51], 0 offen offset:1280 nt
    buffer_load_dwordx2 v[44:45], v79, s[48:51], 0 offen offset:2560 nt
    buffer_load_dwordx2 v[46:47], v78, s[48:51], 0 offen offset:0 nt
    buffer_load_dwordx2 v[48:49], v78, s[48:51], 0 offen offset:1280 nt
    buffer_load_dwordx2 v[50:51], v78, s[48:51], 0 offen offset:2560 nt
    buffer_load_dwordx2 v[52:53], v78, s[48:51], 0 offen offset:3840 nt
    buffer_load_dwordx2 v[54:55], v78, s[48:51], s14 offen offset:0 nt
    buffer_load_dwordx2 v[56:57], v78, s[48:51], s14 offen offset:1280 nt
    buffer_load_dwordx2 v[58:59], v78, s[48:51], s14 offen offset:2560 nt
    buffer_load_dwordx2 v[60:61], v78, s[48:51], s14 offen offset:3840 nt
    buffer_load_dwordx4 v[32:35], v80, s[56:59], 0 offen
    buffer_load_dwordx4 v[36:39], v80, s[56:59], 0 offen offset:16
    buffer_load_dwordx2 v[62:63], v78, s[52:55], 0 offen offset:0 nt
    buffer_load_dwordx2 v[64:65], v78, s[52:55], 0 offen offset:1280 nt
    buffer_load_dwordx2 v[66:67], v78, s[52:55], 0 offen offset:2560 nt
    buffer_load_dwordx2 v[68:69], v78, s[52:55], 0 offen offset:3840 nt
    buffer_load_dwordx2 v[70:71], v78, s[52:55], s14 offen offset:0 nt
    buffer_load_dwordx2 v[72:73], v78, s[52:55], s14 offen offset:1280 nt
    buffer_load_dwordx2 v[74:75], v78, s[52:55], s14 offen offset:2560 nt
    buffer_load_dwordx2 v[76:77], v78, s[52:55], s14 offen offset:3840 nt
    s_mov_b64 exec, -1
    s_load_dword s92, s[80:81], 98304
    s_mov_b64 s[64:65], s[78:79]
    s_mov_b64 s[68:69], s[32:33]
    s_mov_b32 s66, 1966080
    s_mov_b32 s67, 0x20000
    s_mov_b32 s70, 1966080
    s_mov_b32 s71, 0x20000
    s_lshl_b32 s14, s16, 1
    s_and_b32 s14, s14, -4
    s_load_dword s21, s[74:75], s14
    s_lshl_b32 s12, s16, 12
    s_add_u32 s60, s72, s12
    s_addc_u32 s61, s73, 0
    s_mov_b64 s[76:77], s[36:37]
    s_mov_b32 s78, 2621440
    s_mov_b32 s79, 0x20000
    s_lshr_b32 s101, s16, 2
    s_add_u32 s101, s101, 288
    v_lshrrev_b32 v207, 3, v0
    v_mul_u32_u24 v207, 3072, v207
    v_and_b32 v171, 7, v1
    v_lshl_add_u32 v207, v171, 4, v207
    s_mul_i32 s15, s3, 16768
    v_add_u32 v241, s15, v2
    v_add_u32 v240, 67072, v241
    v_lshlrev_b32 v10, 2, v1
    s_mov_b32 s14, 0x64175302
    v_bfe_u32 v10, s14, v10, 4
    v_mul_u32_u24 v10, 2096, v10
    v_cmp_eq_u32 vcc, 0, v1
    s_nop 1
    v_cndmask_b32_e64 v11, 0, 16, vcc
    v_add3_u32 v243, v10, v11, s15
    v_add_u32 v242, 67072, v243
    v_lshrrev_b32 v12, 4, v1
    v_and_b32 v13, 15, v1
    v_lshl_add_u32 v14, v12, 3, v13
    v_add_u32 v14, 1, v14
    v_and_b32 v15, 7, v14
    v_lshlrev_b32 v15, 2, v15
    v_bfe_u32 v15, s14, v15, 4
    v_mul_u32_u24 v15, 2096, v15
    v_lshrrev_b32 v14, 3, v14
    v_lshlrev_b32 v14, 4, v14
    v_add3_u32 v9, v14, v15, s15
    v_add_u32 v251, 67072, v9
    s_mul_i32 s15, s3, 9248
    s_add_u32 s15, s15, 67072
    v_lshlrev_b32 v10, 1, v13
    v_sub_u32 v10, v10, v12
    v_add_u32 v10, 5, v10
    v_lshlrev_b32 v10, 4, v10
    v_add_u32 v10, s15, v10
    v_lshlrev_b32 v11, 5, v13
    v_lshl_add_u32 v11, v12, 3, v11
    s_add_u32 s14, s15, 5136
    v_add_u32 v11, s14, v11
    v_lshrrev_b32 v14, 1, v12
    v_lshl_add_u32 v14, v13, 1, v14
    v_lshlrev_b32 v14, 6, v14
    v_and_b32 v15, 1, v12
    v_lshlrev_b32 v16, 4, v15
    v_add_u32 v14, 108032, v14
    v_add_u32 v14, v14, v16
    v_lshrrev_b32 v16, 2, v13
    v_lshl_add_u32 v15, v15, 2, v16
    v_mul_u32_u24 v15, 82048, v15
    s_bfe_u32 s14, s16, 0x20001
    v_and_b32 v16, 3, v13
    v_xor_b32 v16, s14, v16
    v_lshlrev_b32 v16, 5, v16
    v_lshrrev_b32 v17, 1, v12
    v_lshlrev_b32 v17, 4, v17
    v_add3_u32 v15, v15, v16, v17
    v_lshl_add_u32 v28, v12, 3, v13
    v_sub_u32 v28, 15, v28
    v_lshlrev_b32 v16, 4, v0
    v_and_b32 v17, 7, v0
    v_mul_u32_u24 v17, 4624, v17
    v_lshrrev_b32 v19, 3, v0
    v_add_u32 v17, 67072, v17
    s_lshr_b32 s12, s18, 2
    s_mov_b32 s13, 0
    s_mul_i32 s85, s19, 10240
    s_add_u32 s85, s85, 81920
    s_mul_i32 s14, s12, 20480
    s_sub_u32 s85, s85, s14
    s_sub_u32 s14, s85, 81920
    s_min_u32 s23, s85, s14
    s_lshl_b32 s84, s3, 11
    s_add_u32 s84, s84, s23
    s_sub_u32 s14, s84, 81920
    s_min_u32 s84, s84, s14
    s_add_u32 s85, s23, 8192
    s_sub_u32 s14, s85, 81920
    s_min_u32 s85, s85, s14
    s_sub_u32 s23, s23, 1024
    s_cmp_gt_u32 s23, 70656
    s_cselect_b32 s23, 16384, 0
    s_mul_i32 s24, s17, 82048
    s_lshl_b32 s25, s3, 12
    s_add_u32 s24, s24, 5767168
    s_mul_i32 s15, s12, 20480
    s_add_u32 s15, s15, s25
    s_sub_u32 s14, s15, 81920
    s_min_u32 s15, s15, s14
    s_add_u32 s49, s15, s24
    s_add_u32 s15, s15, 16384
    s_sub_u32 s14, s15, 81920
    s_min_u32 s15, s15, s14
    s_add_u32 s50, s15, s24
    s_add_u32 s15, s15, 16384
    s_sub_u32 s14, s15, 81920
    s_min_u32 s15, s15, s14
    s_add_u32 s51, s15, s24
    s_add_u32 s15, s15, 16384
    s_sub_u32 s14, s15, 81920
    s_min_u32 s15, s15, s14
    s_add_u32 s52, s15, s24
    s_add_u32 s15, s15, 16384
    s_sub_u32 s14, s15, 81920
    s_min_u32 s15, s15, s14
    s_add_u32 s53, s15, s24
    s_add_u32 s14, s12, 0
    s_and_b32 s14, s14, 3
    s_mul_i32 s14, s14, 15360
    s_add_u32 s44, s14, s88
    s_add_u32 s14, s12, 1
    s_and_b32 s14, s14, 3
    s_mul_i32 s14, s14, 15360
    s_add_u32 s45, s14, s88
    s_add_u32 s14, s12, 2
    s_and_b32 s14, s14, 3
    s_mul_i32 s14, s14, 15360
    s_add_u32 s46, s14, s88
    s_add_u32 s14, s12, 3
    s_and_b32 s14, s14, 3
    s_mul_i32 s14, s14, 15360
    s_add_u32 s47, s14, s88
    s_lshl_b32 s14, s17, 14
    s_lshl_b32 s15, s3, 8
    s_add_u32 s14, s14, s15
    s_add_u32 s14, s14, 21004288
    s_lshl_b32 s15, s18, 10
    s_add_u32 s48, s14, s15
    s_and_b32 s15, s15, 3072
    s_add_u32 s94, s14, s15
    s_mul_i32 s54, s13, 20480
    s_add_u32 s54, s54, s89
    s_lshl_b32 s57, s13, 12
    s_add_u32 s57, s57, s40
    s_add_u32 s13, s13, 1
    s_sub_u32 s14, s13, 3
    s_min_u32 s13, s13, s14
    s_mul_i32 s55, s13, 20480
    s_add_u32 s55, s55, s89
    s_lshl_b32 s58, s13, 12
    s_add_u32 s58, s58, s40
    s_add_u32 s13, s13, 1
    s_sub_u32 s14, s13, 3
    s_min_u32 s13, s13, s14
    s_mul_i32 s56, s13, 20480
    s_add_u32 s56, s56, s89
    s_lshl_b32 s59, s13, 12
    s_add_u32 s59, s59, s40
    s_lshl_b32 s87, s18, 2
    s_add_u32 s87, s87, s3
    s_mul_i32 s87, s87, 192
    s_add_u32 s87, s87, 8396800
    v_lshl_add_u32 v17, v19, 4, v17
    v_mov_b32 v244, v9
    v_mov_b32 v245, v10
    v_mov_b32 v246, v11
    v_mov_b32 v247, v14
    v_mov_b32 v248, v15
    v_mov_b32 v249, v16
    v_mov_b32 v250, v17
    v_lshrrev_b32 v12, 2, v1
    v_lshlrev_b32 v13, 7, v12
    v_and_b32 v14, 3, v1
    v_lshl_add_u32 v13, v14, 3, v13
    v_bfe_u32 v14, v1, 3, 2
    v_xor_b32 v15, s3, v14
    s_lshl_b32 s13, s20, 1
    v_xor_b32 v16, s13, v14
    v_lshl_add_u32 v17, v16, 5, v13
    v_add_u32 v13, 131072, v13
    v_xor_b32 v16, 0, v15
    v_lshl_add_u32 v8, v16, 5, v13
    v_xor_b32 v16, 1, v15
    v_lshl_add_u32 v9, v16, 5, v13
    v_xor_b32 v16, 2, v15
    v_lshl_add_u32 v10, v16, 5, v13
    v_xor_b32 v16, 3, v15
    v_lshl_add_u32 v11, v16, 5, v13
    v_and_b32 v16, 15, v1
    v_lshlrev_b32 v16, 4, v16
    v_add_u32 v16, s23, v16
    v_add_u32 v16, 131072, v16
    s_xor_b32 s12, s3, 0
    s_lshl_b32 s12, s12, 8
    v_add_u32 v19, s12, v16
    s_xor_b32 s12, s3, 1
    s_lshl_b32 s12, s12, 8
    v_add_u32 v20, s12, v16
    s_xor_b32 s12, s3, 2
    s_lshl_b32 s12, s12, 8
    v_add_u32 v21, s12, v16
    s_xor_b32 s12, s3, 3
    s_lshl_b32 s12, s12, 8
    v_add_u32 v22, s12, v16
    v_lshrrev_b32 v16, 4, v1
    v_xor_b32 v16, s3, v16
    v_mul_u32_u24 v16, 49408, v16
    v_and_b32 v23, 15, v1
    v_lshl_add_u32 v23, v23, 4, v16
    v_and_b32 v16, 3, v1
    v_cmp_eq_u32 s[32:33], 1, v16
    v_cmp_eq_u32 s[34:35], 2, v16
    v_cmp_eq_u32 s[36:37], 3, v16
    s_mul_i32 s22, s17, 197632
    s_lshl_b32 s13, s18, 2
    s_add_u32 s13, s13, s3
    s_mul_i32 s13, s13, 768
    s_add_u32 s22, s22, s13
    s_add_u32 s22, s22, 14680064
    s_mul_i32 s12, s3, 5120
    v_add_u32 v25, s12, v2
    s_lshl_b32 s12, s3, 10
    v_add_u32 v26, s12, v2
    v_and_b32 v27, 15, v1
    v_mul_u32_u24 v27, 1280, v27
    v_lshrrev_b32 v16, 4, v1
    v_lshl_add_u32 v27, v16, 3, v27
    s_lshl_b32 s12, s17, 1
    s_add_u32 s12, s12, s20
    s_mul_i32 s12, s12, 40960
    s_mul_i32 s13, s19, 160
    s_add_u32 s100, s12, s13
    s_lshl_b32 s13, s3, 5
    s_add_u32 s95, s100, s13
    v_and_b32 v24, 7, v1
    v_max_u32 v24, 5, v24
    v_and_b32 v16, 56, v1
    v_lshlrev_b32 v16, 5, v16
    v_lshl_add_u32 v24, v24, 4, v16
    s_lshl_b32 s12, s4, 11
    v_add_u32 v24, s12, v24
    v_and_b32 v12, 15, v1
    v_lshlrev_b32 v12, 4, v12
    v_and_b32 v13, 48, v1
    v_lshl_add_u32 v13, v13, 8, v12
    v_subrev_u32 v5, 16, v2
    buffer_load_dwordx4 v[208:211], v5, s[60:63], 0 offen nt
    buffer_load_dwordx4 v[212:215], v2, s[60:63], 0 offen offset:0 nt
    buffer_load_dwordx4 v[216:219], v2, s[60:63], 0 offen offset:1008 nt
    buffer_load_dwordx4 v[220:223], v2, s[60:63], 0 offen offset:1024 nt
    buffer_load_dwordx4 v[224:227], v2, s[60:63], 0 offen offset:2032 nt
    buffer_load_dwordx4 v[228:231], v2, s[60:63], 0 offen offset:2048 nt
    buffer_load_dwordx4 v[232:235], v2, s[60:63], 0 offen offset:3056 nt
    buffer_load_dwordx4 v[236:239], v2, s[60:63], 0 offen offset:3072 nt
    s_waitcnt vmcnt(28)
    v_lshlrev_b32 v94, 16, v40
    v_and_b32 v95, s10, v40
    v_lshlrev_b32 v96, 16, v41
    v_and_b32 v97, s10, v41
    s_waitcnt vmcnt(27)
    v_lshlrev_b32 v98, 16, v42
    v_and_b32 v99, s10, v42
    v_lshlrev_b32 v100, 16, v43
    v_and_b32 v101, s10, v43
    s_waitcnt vmcnt(26)
    v_lshlrev_b32 v102, 16, v44
    v_and_b32 v103, s10, v44
    v_lshlrev_b32 v104, 16, v45
    v_and_b32 v105, s10, v45
    s_waitcnt vmcnt(25)
    v_lshlrev_b32 v106, 16, v46
    v_and_b32 v107, s10, v46
    v_lshlrev_b32 v108, 16, v47
    v_and_b32 v109, s10, v47
    s_waitcnt vmcnt(24)
    v_lshlrev_b32 v110, 16, v48
    v_and_b32 v111, s10, v48
    v_lshlrev_b32 v112, 16, v49
    v_and_b32 v113, s10, v49
    s_waitcnt vmcnt(23)
    v_lshlrev_b32 v114, 16, v50
    v_and_b32 v115, s10, v50
    v_lshlrev_b32 v116, 16, v51
    v_and_b32 v117, s10, v51
    s_waitcnt vmcnt(22)
    v_lshlrev_b32 v118, 16, v52
    v_and_b32 v119, s10, v52
    v_lshlrev_b32 v120, 16, v53
    v_and_b32 v121, s10, v53
    s_waitcnt vmcnt(21)
    v_lshlrev_b32 v122, 16, v54
    v_and_b32 v123, s10, v54
    v_lshlrev_b32 v124, 16, v55
    v_and_b32 v125, s10, v55
    s_waitcnt vmcnt(20)
    v_lshlrev_b32 v126, 16, v56
    v_and_b32 v127, s10, v56
    v_lshlrev_b32 v128, 16, v57
    v_and_b32 v129, s10, v57
    s_waitcnt vmcnt(19)
    v_lshlrev_b32 v130, 16, v58
    v_and_b32 v131, s10, v58
    v_lshlrev_b32 v132, 16, v59
    v_and_b32 v133, s10, v59
    s_waitcnt vmcnt(18)
    v_lshlrev_b32 v134, 16, v60
    v_and_b32 v135, s10, v60
    v_lshlrev_b32 v136, 16, v61
    v_and_b32 v137, s10, v61
    s_waitcnt vmcnt(17)
    v_lshlrev_b32 v78, 16, v32
    v_and_b32 v82, s10, v32
    v_lshlrev_b32 v86, 16, v33
    v_and_b32 v90, s10, v33
    v_lshlrev_b32 v79, 16, v34
    v_and_b32 v83, s10, v34
    v_lshlrev_b32 v87, 16, v35
    v_and_b32 v91, s10, v35
    s_waitcnt vmcnt(16)
    v_lshlrev_b32 v80, 16, v36
    v_and_b32 v84, s10, v36
    v_lshlrev_b32 v88, 16, v37
    v_and_b32 v92, s10, v37
    v_lshlrev_b32 v81, 16, v38
    v_and_b32 v85, s10, v38
    v_lshlrev_b32 v89, 16, v39
    v_and_b32 v93, s10, v39
    v_pk_mul_f32 v[138:139], v[106:107], v[78:79]
    v_pk_mul_f32 v[140:141], v[108:109], v[80:81]
    v_pk_mul_f32 v[142:143], v[110:111], v[78:79]
    v_pk_mul_f32 v[144:145], v[112:113], v[80:81]
    v_pk_mul_f32 v[146:147], v[114:115], v[78:79]
    v_pk_mul_f32 v[148:149], v[116:117], v[80:81]
    v_pk_mul_f32 v[150:151], v[118:119], v[78:79]
    v_pk_mul_f32 v[152:153], v[120:121], v[80:81]
    v_pk_mul_f32 v[154:155], v[122:123], v[78:79]
    v_pk_mul_f32 v[156:157], v[124:125], v[80:81]
    v_pk_mul_f32 v[158:159], v[126:127], v[78:79]
    v_pk_mul_f32 v[160:161], v[128:129], v[80:81]
    v_pk_mul_f32 v[162:163], v[130:131], v[78:79]
    v_pk_mul_f32 v[164:165], v[132:133], v[80:81]
    v_pk_mul_f32 v[166:167], v[134:135], v[78:79]
    v_pk_mul_f32 v[168:169], v[136:137], v[80:81]
    v_pk_fma_f32 v[138:139], v[102:103], v[82:83], v[138:139]
    v_pk_fma_f32 v[140:141], v[104:105], v[84:85], v[140:141]
    v_pk_fma_f32 v[142:143], v[106:107], v[82:83], v[142:143]
    v_pk_fma_f32 v[144:145], v[108:109], v[84:85], v[144:145]
    v_pk_fma_f32 v[146:147], v[110:111], v[82:83], v[146:147]
    v_pk_fma_f32 v[148:149], v[112:113], v[84:85], v[148:149]
    v_pk_fma_f32 v[150:151], v[114:115], v[82:83], v[150:151]
    v_pk_fma_f32 v[152:153], v[116:117], v[84:85], v[152:153]
    v_pk_fma_f32 v[154:155], v[118:119], v[82:83], v[154:155]
    v_pk_fma_f32 v[156:157], v[120:121], v[84:85], v[156:157]
    v_pk_fma_f32 v[158:159], v[122:123], v[82:83], v[158:159]
    v_pk_fma_f32 v[160:161], v[124:125], v[84:85], v[160:161]
    v_pk_fma_f32 v[162:163], v[126:127], v[82:83], v[162:163]
    v_pk_fma_f32 v[164:165], v[128:129], v[84:85], v[164:165]
    v_pk_fma_f32 v[166:167], v[130:131], v[82:83], v[166:167]
    v_pk_fma_f32 v[168:169], v[132:133], v[84:85], v[168:169]
    v_pk_fma_f32 v[138:139], v[98:99], v[86:87], v[138:139]
    v_pk_fma_f32 v[140:141], v[100:101], v[88:89], v[140:141]
    v_pk_fma_f32 v[142:143], v[102:103], v[86:87], v[142:143]
    v_pk_fma_f32 v[144:145], v[104:105], v[88:89], v[144:145]
    v_pk_fma_f32 v[146:147], v[106:107], v[86:87], v[146:147]
    v_pk_fma_f32 v[148:149], v[108:109], v[88:89], v[148:149]
    v_pk_fma_f32 v[150:151], v[110:111], v[86:87], v[150:151]
    v_pk_fma_f32 v[152:153], v[112:113], v[88:89], v[152:153]
    v_pk_fma_f32 v[154:155], v[114:115], v[86:87], v[154:155]
    v_pk_fma_f32 v[156:157], v[116:117], v[88:89], v[156:157]
    v_pk_fma_f32 v[158:159], v[118:119], v[86:87], v[158:159]
    v_pk_fma_f32 v[160:161], v[120:121], v[88:89], v[160:161]
    v_pk_fma_f32 v[162:163], v[122:123], v[86:87], v[162:163]
    v_pk_fma_f32 v[164:165], v[124:125], v[88:89], v[164:165]
    v_pk_fma_f32 v[166:167], v[126:127], v[86:87], v[166:167]
    v_pk_fma_f32 v[168:169], v[128:129], v[88:89], v[168:169]
    v_pk_fma_f32 v[138:139], v[94:95], v[90:91], v[138:139]
    v_pk_fma_f32 v[140:141], v[96:97], v[92:93], v[140:141]
    v_pk_fma_f32 v[142:143], v[98:99], v[90:91], v[142:143]
    v_pk_fma_f32 v[144:145], v[100:101], v[92:93], v[144:145]
    v_pk_fma_f32 v[146:147], v[102:103], v[90:91], v[146:147]
    v_pk_fma_f32 v[148:149], v[104:105], v[92:93], v[148:149]
    v_pk_fma_f32 v[150:151], v[106:107], v[90:91], v[150:151]
    v_pk_fma_f32 v[152:153], v[108:109], v[92:93], v[152:153]
    v_pk_fma_f32 v[154:155], v[110:111], v[90:91], v[154:155]
    v_pk_fma_f32 v[156:157], v[112:113], v[92:93], v[156:157]
    v_pk_fma_f32 v[158:159], v[114:115], v[90:91], v[158:159]
    v_pk_fma_f32 v[160:161], v[116:117], v[92:93], v[160:161]
    v_pk_fma_f32 v[162:163], v[118:119], v[90:91], v[162:163]
    v_pk_fma_f32 v[164:165], v[120:121], v[92:93], v[164:165]
    v_pk_fma_f32 v[166:167], v[122:123], v[90:91], v[166:167]
    v_pk_fma_f32 v[168:169], v[124:125], v[92:93], v[168:169]
    s_waitcnt vmcnt(15)
    v_lshlrev_b32 v174, 16, v62
    v_and_b32 v175, s10, v62
    v_lshlrev_b32 v176, 16, v63
    v_and_b32 v177, s10, v63
    s_waitcnt vmcnt(14)
    v_lshlrev_b32 v178, 16, v64
    v_and_b32 v179, s10, v64
    v_lshlrev_b32 v180, 16, v65
    v_and_b32 v181, s10, v65
    s_waitcnt vmcnt(13)
    v_lshlrev_b32 v182, 16, v66
    v_and_b32 v183, s10, v66
    v_lshlrev_b32 v184, 16, v67
    v_and_b32 v185, s10, v67
    s_waitcnt vmcnt(12)
    v_lshlrev_b32 v186, 16, v68
    v_and_b32 v187, s10, v68
    v_lshlrev_b32 v188, 16, v69
    v_and_b32 v189, s10, v69
    s_waitcnt vmcnt(11)
    v_lshlrev_b32 v190, 16, v70
    v_and_b32 v191, s10, v70
    v_lshlrev_b32 v192, 16, v71
    v_and_b32 v193, s10, v71
    s_waitcnt vmcnt(10)
    v_lshlrev_b32 v194, 16, v72
    v_and_b32 v195, s10, v72
    v_lshlrev_b32 v196, 16, v73
    v_and_b32 v197, s10, v73
    s_waitcnt vmcnt(9)
    v_lshlrev_b32 v198, 16, v74
    v_and_b32 v199, s10, v74
    v_lshlrev_b32 v200, 16, v75
    v_and_b32 v201, s10, v75
    s_waitcnt vmcnt(8)
    v_lshlrev_b32 v202, 16, v76
    v_and_b32 v203, s10, v76
    v_lshlrev_b32 v204, 16, v77
    v_and_b32 v205, s10, v77
    v_pk_mul_f32 v[138:139], v[138:139], v[174:175]
    v_pk_mul_f32 v[140:141], v[140:141], v[176:177]
    v_pk_mul_f32 v[142:143], v[142:143], v[178:179]
    v_pk_mul_f32 v[144:145], v[144:145], v[180:181]
    v_pk_mul_f32 v[146:147], v[146:147], v[182:183]
    v_pk_mul_f32 v[148:149], v[148:149], v[184:185]
    v_pk_mul_f32 v[150:151], v[150:151], v[186:187]
    v_pk_mul_f32 v[152:153], v[152:153], v[188:189]
    v_pk_mul_f32 v[154:155], v[154:155], v[190:191]
    v_pk_mul_f32 v[156:157], v[156:157], v[192:193]
    v_pk_mul_f32 v[158:159], v[158:159], v[194:195]
    v_pk_mul_f32 v[160:161], v[160:161], v[196:197]
    v_pk_mul_f32 v[162:163], v[162:163], v[198:199]
    v_pk_mul_f32 v[164:165], v[164:165], v[200:201]
    v_pk_mul_f32 v[166:167], v[166:167], v[202:203]
    v_pk_mul_f32 v[168:169], v[168:169], v[204:205]
    s_mov_b64 exec, s[30:31]
    v_cvt_pk_bf16_f32 v94, v166, v162
    v_cvt_pk_bf16_f32 v95, v158, v154
    v_cvt_pk_bf16_f32 v96, v150, v146
    v_cvt_pk_bf16_f32 v97, v142, v138
    ds_write_b128 v206, v[94:97] offset:0
    v_cvt_pk_bf16_f32 v102, v167, v163
    v_cvt_pk_bf16_f32 v103, v159, v155
    v_cvt_pk_bf16_f32 v104, v151, v147
    v_cvt_pk_bf16_f32 v105, v143, v139
    ds_write_b128 v206, v[102:105] offset:32
    v_cvt_pk_bf16_f32 v110, v168, v164
    v_cvt_pk_bf16_f32 v111, v160, v156
    v_cvt_pk_bf16_f32 v112, v152, v148
    v_cvt_pk_bf16_f32 v113, v144, v140
    ds_write_b128 v206, v[110:113] offset:64
    v_cvt_pk_bf16_f32 v118, v169, v165
    v_cvt_pk_bf16_f32 v119, v161, v157
    v_cvt_pk_bf16_f32 v120, v153, v149
    v_cvt_pk_bf16_f32 v121, v145, v141
    ds_write_b128 v206, v[118:121] offset:96
    s_mov_b64 exec, -1
L_p0_joinc:
    s_nop 4
    s_waitcnt lgkmcnt(0)
    s_barrier
    ds_read_b128 v[140:143], v172 offset:0
    ds_read_b128 v[144:147], v172 offset:1152
    ds_read_b128 v[148:151], v172 offset:2304
    ds_read_b128 v[152:155], v172 offset:3456
    ds_read_b128 v[156:159], v172 offset:4608
    s_mul_i32 s92, s92, 1664525
    s_add_u32 s92, s92, 1013904223
    s_mov_b32 s93, s92
    v_mov_b32 v6, s92
    s_mov_b32 s14, 262144
    s_waitcnt lgkmcnt(4)
    buffer_store_dwordx4 v[140:143], v173, s[80:83], s14 offen sc1
    s_mov_b32 s14, 525312
    s_waitcnt lgkmcnt(3)
    buffer_store_dwordx4 v[144:147], v173, s[80:83], s14 offen sc1
    s_mov_b32 s14, 788480
    s_waitcnt lgkmcnt(2)
    buffer_store_dwordx4 v[148:151], v173, s[80:83], s14 offen sc1
    s_mov_b32 s14, 1051648
    s_waitcnt lgkmcnt(1)
    buffer_store_dwordx4 v[152:155], v173, s[80:83], s14 offen sc1
    s_mov_b32 s14, 1314816
    s_waitcnt lgkmcnt(0)
    buffer_store_dwordx4 v[156:159], v173, s[80:83], s14 offen sc1
    s_and_b32 s14, s16, 1
    s_lshl_b32 s14, s14, 4
    s_lshr_b32 s21, s21, s14
    s_and_b32 s21, s21, 0xffff
    v_and_b32 v15, 1, v28
    v_lshlrev_b32 v15, 4, v15
    v_lshlrev_b32_e64 v15, v15, s21
    v_lshrrev_b32 v16, 1, v28
    v_cmp_eq_u32 vcc, 0, v16
    s_nop 1
    v_cndmask_b32 v28, 0, v15, vcc
    v_cmp_eq_u32 vcc, 1, v16
    s_nop 1
    v_cndmask_b32 v29, 0, v15, vcc
    v_cmp_eq_u32 vcc, 2, v16
    s_nop 1
    v_cndmask_b32 v30, 0, v15, vcc
    v_cmp_eq_u32 vcc, 3, v16
    s_nop 1
    v_cndmask_b32 v31, 0, v15, vcc
    v_mov_b32 v80, 0
    v_mov_b32 v81, 0
    v_mov_b32 v82, 0
    v_mov_b32 v83, 0
    s_add_u32 s15, s101, 0
    s_mul_i32 s12, s15, 2731
    s_lshr_b32 s12, s12, 16
    s_mul_i32 s14, s12, 24
    s_sub_u32 s15, s15, s14
    s_mul_i32 s14, s12, 768
    s_add_u32 s14, s14, s15
    s_lshl_b32 s14, s14, 7
    s_lshl_b32 s12, s3, 10
    s_add_u32 m0, s12, 145408
    s_nop 0
    buffer_load_dwordx4 v207, s[64:67], s14 offen nt lds
    s_add_u32 m0, m0, 4224
    s_nop 0
    buffer_load_dwordx4 v207, s[68:71], s14 offen nt lds
    s_lshl_b32 s15, s4, 2
    s_add_u32 s15, s15, s5
    s_add_u32 s15, s15, 432
    s_mul_i32 s12, s15, 2731
    s_lshr_b32 s12, s12, 16
    s_mul_i32 s14, s12, 24
    s_sub_u32 s15, s15, s14
    s_mul_i32 s14, s12, 768
    s_add_u32 s14, s14, s15
    s_lshl_b32 s14, s14, 7
    s_cmp_ge_u32 s5, 16
    s_cselect_b32 s14, s14, 0x7ff00000
    s_lshl_b32 s12, s3, 10
    s_add_u32 m0, s12, 153856
    s_nop 0
    buffer_load_dwordx4 v207, s[64:67], s14 offen nt lds
    s_add_u32 m0, m0, 4224
    s_nop 0
    buffer_load_dwordx4 v207, s[68:71], s14 offen nt lds
    v_lshrrev_b32 v104, 4, v1
    v_lshlrev_b32 v88, 9, v104
    v_bfe_u32 v105, v1, 2, 2
    v_lshl_add_u32 v88, v105, 5, v88
    v_and_b32 v105, 1, v1
    v_lshl_add_u32 v88, v105, 4, v88
    v_bfe_u32 v105, v1, 1, 1
    v_mul_u32_u24 v105, 4224, v105
    s_lshl_b32 s12, s3, 2
    s_add_u32 s12, s12, 145408
    v_add3_u32 v88, v88, v105, s12
    v_and_b32 v104, 15, v1
    v_and_b32 v91, 48, v1
    v_lshl_add_u32 v91, v104, 6, v91
    v_mov_b32 v105, 0x3f803f80
    v_cmp_eq_u32 vcc, 0, v104
    s_nop 1
    v_cndmask_b32 v92, 0, v105, vcc
    v_cndmask_b32 v93, 0, v105, vcc
    v_cndmask_b32 v94, 0, v105, vcc
    v_cndmask_b32 v95, 0, v105, vcc
    v_cmp_eq_u32 vcc, 1, v104
    s_nop 1
    v_cndmask_b32 v96, 0, v105, vcc
    v_cndmask_b32 v97, 0, v105, vcc
    v_cndmask_b32 v98, 0, v105, vcc
    v_cndmask_b32 v99, 0, v105, vcc
    s_waitcnt vmcnt(15)
    ds_write_b128 v240, v[212:215] offset:4224
    ds_write_b128 v240, v[210:213] offset:14688
    v_mov_b32 v32, v209
    v_mov_b32 v33, v210
    v_mov_b32 v34, v211
    v_mov_b32 v35, v212
    v_mov_b32 v36, v213
    v_mov_b32 v37, v214
    ds_write_b128 v240, v[32:35] offset:6304
    ds_write_b128 v240, v[34:37] offset:8400
    v_alignbit_b32 v38, v209, v208, 16
    v_alignbit_b32 v39, v210, v209, 16
    v_alignbit_b32 v40, v211, v210, 16
    v_alignbit_b32 v41, v212, v211, 16
    v_alignbit_b32 v42, v213, v212, 16
    v_alignbit_b32 v43, v214, v213, 16
    ds_write_b128 v240, v[38:41] offset:16
    ds_write_b128 v240, v[40:43] offset:2112
    v_alignbit_b32 v44, v210, v209, 16
    v_alignbit_b32 v45, v211, v210, 16
    v_alignbit_b32 v46, v212, v211, 16
    v_alignbit_b32 v47, v213, v212, 16
    v_alignbit_b32 v48, v214, v213, 16
    v_alignbit_b32 v49, v215, v214, 16
    ds_write_b128 v240, v[44:47] offset:10496
    ds_write_b128 v240, v[46:49] offset:12592
    s_waitcnt vmcnt(13)
    ds_write_b128 v240, v[220:223] offset:5248
    ds_write_b128 v240, v[218:221] offset:15712
    v_mov_b32 v56, v217
    v_mov_b32 v57, v218
    v_mov_b32 v58, v219
    v_mov_b32 v59, v220
    v_mov_b32 v60, v221
    v_mov_b32 v61, v222
    ds_write_b128 v240, v[56:59] offset:7328
    ds_write_b128 v240, v[58:61] offset:9424
    v_alignbit_b32 v62, v217, v216, 16
    v_alignbit_b32 v63, v218, v217, 16
    v_alignbit_b32 v64, v219, v218, 16
    v_alignbit_b32 v65, v220, v219, 16
    v_alignbit_b32 v66, v221, v220, 16
    v_alignbit_b32 v67, v222, v221, 16
    ds_write_b128 v240, v[62:65] offset:1040
    ds_write_b128 v240, v[64:67] offset:3136
    v_alignbit_b32 v68, v218, v217, 16
    v_alignbit_b32 v69, v219, v218, 16
    v_alignbit_b32 v70, v220, v219, 16
    v_alignbit_b32 v71, v221, v220, 16
    v_alignbit_b32 v72, v222, v221, 16
    v_alignbit_b32 v73, v223, v222, 16
    ds_write_b128 v240, v[68:71] offset:11520
    ds_write_b128 v240, v[70:73] offset:13616
    s_waitcnt vmcnt(4)
    s_barrier
    s_and_b32 s43, s2, 128
    s_add_u32 s43, s43, 0
    s_mov_b64 exec, 3
    buffer_atomic_swap v6, v4, s[80:83], s43 offen sc1
    s_mov_b64 exec, -1
    s_waitcnt vmcnt(1)
    s_barrier
    ds_read_b32 v104, v88 offset:0
    ds_read_b32 v105, v88 offset:128
    ds_read_b32 v106, v88 offset:256
    ds_read_b32 v107, v88 offset:384
    ds_read_b32 v108, v88 offset:2048
    ds_read_b32 v109, v88 offset:2176
    ds_read_b32 v110, v88 offset:2304
    ds_read_b32 v111, v88 offset:2432
    s_add_u32 s15, s101, 0
    s_mul_i32 s12, s15, 2731
    s_lshr_b32 s12, s12, 16
    s_mul_i32 s14, s12, 24
    s_sub_u32 s15, s15, s14
    s_lshl_b32 s42, s15, 2
    s_add_u32 s42, s42, s3
    s_lshl_b32 s42, s42, 1
    s_mul_i32 s86, s12, 192
    s_add_u32 s86, s86, s42
    s_lshl_b32 s86, s86, 6
    s_add_u32 s86, s86, 8396800
    s_mul_i32 s41, s12, 3072
    s_add_u32 s41, s41, 8650752
    s_waitcnt lgkmcnt(6)
    v_perm_b32 v128, v105, v104, s8
    s_waitcnt lgkmcnt(4)
    v_perm_b32 v129, v107, v106, s8
    s_waitcnt lgkmcnt(2)
    v_perm_b32 v130, v109, v108, s8
    s_waitcnt lgkmcnt(0)
    v_perm_b32 v131, v111, v110, s8
    s_add_u32 s12, s42, 0
    s_mul_i32 s13, s12, 21846
    s_lshr_b32 s13, s13, 16
    s_mul_i32 s13, s13, 57
    s_add_u32 s12, s12, s13
    s_lshl_b32 s12, s12, 10
    s_add_u32 s12, s12, s41
    v_mfma_f32_16x16x32_bf16 v[100:103], v[128:131], v[92:95], 0
    buffer_store_dwordx4 v[128:131], v2, s[80:83], s12 offen sc1
    v_perm_b32 v132, v105, v104, s9
    v_perm_b32 v133, v107, v106, s9
    v_perm_b32 v134, v109, v108, s9
    v_perm_b32 v135, v111, v110, s9
    s_add_u32 s12, s42, 1
    s_mul_i32 s13, s12, 21846
    s_lshr_b32 s13, s13, 16
    s_mul_i32 s13, s13, 57
    s_add_u32 s12, s12, s13
    s_lshl_b32 s12, s12, 10
    s_add_u32 s12, s12, s41
    v_mfma_f32_16x16x32_bf16 v[100:103], v[132:135], v[96:99], v[100:103]
    buffer_store_dwordx4 v[132:135], v2, s[80:83], s12 offen sc1
    s_mov_b32 exec_lo, 0x00030003
    s_mov_b32 exec_hi, 0x00030003
    s_nop 4
    buffer_store_dwordx4 v[100:103], v91, s[80:83], s86 offen sc1
    s_mov_b64 exec, -1
    s_cmp_lt_u32 s5, 16
    s_cbranch_scc1 L_u2_8
    ds_read_b32 v112, v88 offset:8448
    ds_read_b32 v113, v88 offset:8576
    ds_read_b32 v114, v88 offset:8704
    ds_read_b32 v115, v88 offset:8832
    ds_read_b32 v116, v88 offset:10496
    ds_read_b32 v117, v88 offset:10624
    ds_read_b32 v118, v88 offset:10752
    ds_read_b32 v119, v88 offset:10880
    s_lshl_b32 s15, s4, 2
    s_add_u32 s15, s15, s5
    s_add_u32 s15, s15, 432
    s_mul_i32 s12, s15, 2731
    s_lshr_b32 s12, s12, 16
    s_mul_i32 s14, s12, 24
    s_sub_u32 s15, s15, s14
    s_lshl_b32 s42, s15, 2
    s_add_u32 s42, s42, s3
    s_lshl_b32 s42, s42, 1
    s_mul_i32 s86, s12, 192
    s_add_u32 s86, s86, s42
    s_lshl_b32 s86, s86, 6
    s_add_u32 s86, s86, 8396800
    s_mul_i32 s41, s12, 3072
    s_add_u32 s41, s41, 8650752
    s_waitcnt lgkmcnt(6)
    v_perm_b32 v136, v113, v112, s8
    s_waitcnt lgkmcnt(4)
    v_perm_b32 v137, v115, v114, s8
    s_waitcnt lgkmcnt(2)
    v_perm_b32 v138, v117, v116, s8
    s_waitcnt lgkmcnt(0)
    v_perm_b32 v139, v119, v118, s8
    s_add_u32 s12, s42, 0
    s_mul_i32 s13, s12, 21846
    s_lshr_b32 s13, s13, 16
    s_mul_i32 s13, s13, 57
    s_add_u32 s12, s12, s13
    s_lshl_b32 s12, s12, 10
    s_add_u32 s12, s12, s41
    v_mfma_f32_16x16x32_bf16 v[100:103], v[136:139], v[92:95], 0
    buffer_store_dwordx4 v[136:139], v2, s[80:83], s12 offen sc1
    v_perm_b32 v140, v113, v112, s9
    v_perm_b32 v141, v115, v114, s9
    v_perm_b32 v142, v117, v116, s9
    v_perm_b32 v143, v119, v118, s9
    s_add_u32 s12, s42, 1
    s_mul_i32 s13, s12, 21846
    s_lshr_b32 s13, s13, 16
    s_mul_i32 s13, s13, 57
    s_add_u32 s12, s12, s13
    s_lshl_b32 s12, s12, 10
    s_add_u32 s12, s12, s41
    v_mfma_f32_16x16x32_bf16 v[100:103], v[140:143], v[96:99], v[100:103]
    buffer_store_dwordx4 v[140:143], v2, s[80:83], s12 offen sc1
    s_mov_b32 exec_lo, 0x00030003
    s_mov_b32 exec_hi, 0x00030003
    s_nop 4
    buffer_store_dwordx4 v[100:103], v91, s[80:83], s86 offen sc1
    s_mov_b64 exec, -1
L_u2_8:
    s_nop 11
    s_mov_b64 exec, 0xff
    ds_write_b128 v242, v[80:83]
    ds_read_b128 v[84:87], v242 offset:2048
    s_mov_b64 exec, -1
    ds_read_b128 a[112:115], v251 offset:0
    ds_read_b128 a[128:131], v251 offset:64
    ds_read_b128 a[144:147], v251 offset:128
    ds_read_b128 a[160:163], v251 offset:192
    ds_read_b128 a[176:179], v251 offset:256
    ds_read_b128 a[192:195], v251 offset:320
    ds_read_b128 a[208:211], v251 offset:384
    ds_read_b128 a[224:227], v251 offset:448
    ds_read_b128 a[116:119], v251 offset:512
    ds_read_b128 a[132:135], v251 offset:576
    ds_read_b128 a[148:151], v251 offset:640
    ds_read_b128 a[164:167], v251 offset:704
    ds_read_b128 a[180:183], v251 offset:768
    ds_read_b128 a[196:199], v251 offset:832
    ds_read_b128 a[212:215], v251 offset:896
    ds_read_b128 a[228:231], v251 offset:960
    ds_read_b128 a[120:123], v251 offset:1024
    ds_read_b128 a[136:139], v251 offset:1088
    ds_read_b128 a[152:155], v251 offset:1152
    ds_read_b128 a[168:171], v251 offset:1216
    ds_read_b128 a[184:187], v251 offset:1280
    ds_read_b128 a[200:203], v251 offset:1344
    ds_read_b128 a[216:219], v251 offset:1408
    ds_read_b128 a[232:235], v251 offset:1472
    ds_read_b128 a[124:127], v251 offset:1536
    ds_read_b128 a[140:143], v251 offset:1600
    ds_read_b128 a[156:159], v251 offset:1664
    ds_read_b128 a[172:175], v251 offset:1728
    ds_read_b128 a[188:191], v251 offset:1792
    ds_read_b128 a[204:207], v251 offset:1856
    ds_read_b128 a[220:223], v251 offset:1920
    ds_read_b128 a[236:239], v251 offset:1984
    s_mov_b64 exec, 0xff
    s_waitcnt lgkmcnt(15)
    ds_write_b128 v243, v[84:87]
    s_mov_b64 exec, -1
    s_waitcnt vmcnt(0) lgkmcnt(0)
    s_barrier
    s_mov_b32 s43, 16384
    s_mov_b64 exec, 3
    buffer_atomic_swap v6, v4, s[80:83], s43 offen sc1
    s_mov_b64 exec, -1
    s_lshr_b32 s12, s16, 2
    s_mul_i32 s12, s12, 32896
    s_add_u32 s12, s12, 262144
    s_lshl_b32 s13, s3, 11
    s_add_u32 m0, s13, 108032
    s_add_u32 s13, s13, 102400
    v_and_b32 v5, 3, v1
    v_and_b32 v252, 56, v1
    v_lshlrev_b32 v252, 5, v252
    v_lshl_add_u32 v5, v5, 4, v252
    s_lshl_b32 s27, s4, 11
    v_add_u32 v5, s27, v5
    s_cmp_lg_u32 s3, 0
    s_cbranch_scc1 L_skip_9
    s_mov_b32 s27, 0
    s_mov_b32 s11, 0x20000
L_poll_10:
    buffer_load_dwordx4 v[252:255], v5, s[80:83], s27 offen sc1
    s_waitcnt vmcnt(0)
    v_cmp_eq_u64 vcc, s[92:93], v[252:253]
    v_cmp_eq_u64 s[30:31], s[92:93], v[254:255]
    s_nop 0
    s_and_b64 vcc, vcc, s[30:31]
    s_cmp_eq_u64 vcc, -1
    s_cbranch_scc1 L_polld_11
    s_sub_u32 s11, s11, 1
    s_cbranch_scc0 L_poll_10
L_polld_11:
L_skip_9:
    s_nop 4
    s_barrier
    buffer_load_dwordx4 v[160:163], v249, s[80:83], s12 offen sc1
    s_add_u32 s12, s12, 4096
    buffer_load_dwordx4 v[164:167], v249, s[80:83], s12 offen sc1
    s_add_u32 s12, s12, 4096
    buffer_load_dwordx4 v[168:171], v249, s[80:83], s12 offen sc1
    s_add_u32 s12, s12, 4096
    buffer_load_dwordx4 v[172:175], v249, s[80:83], s12 offen sc1
    s_add_u32 s12, s12, 4096
    buffer_load_dwordx4 v2, s[80:83], s13 offen offset:0 sc1 lds
    buffer_load_dwordx4 v2, s[80:83], s13 offen offset:1024 sc1 lds
    s_add_u32 m0, m0, 8192
    s_add_u32 s13, s13, 8192
    v_and_b32 v5, 3, v1
    v_add_u32 v5, 12, v5
    v_and_b32 v252, 56, v1
    v_lshlrev_b32 v252, 5, v252
    v_lshl_add_u32 v5, v5, 4, v252
    s_lshl_b32 s27, s4, 11
    v_add_u32 v5, s27, v5
    s_mov_b32 s27, 0
    buffer_load_dwordx4 v[252:255], v5, s[80:83], s27 offen sc1
    ds_write_b128 v250, v[80:83]
    ds_write_b128 v241, v[228:231] offset:4224
    ds_write_b128 v241, v[226:229] offset:14688
    v_mov_b32 v32, v225
    v_mov_b32 v33, v226
    v_mov_b32 v34, v227
    v_mov_b32 v35, v228
    v_mov_b32 v36, v229
    v_mov_b32 v37, v230
    ds_write_b128 v241, v[32:35] offset:6304
    ds_write_b128 v241, v[34:37] offset:8400
    v_alignbit_b32 v38, v225, v224, 16
    v_alignbit_b32 v39, v226, v225, 16
    v_alignbit_b32 v40, v227, v226, 16
    v_alignbit_b32 v41, v228, v227, 16
    v_alignbit_b32 v42, v229, v228, 16
    v_alignbit_b32 v43, v230, v229, 16
    ds_write_b128 v241, v[38:41] offset:16
    ds_write_b128 v241, v[40:43] offset:2112
    v_alignbit_b32 v44, v226, v225, 16
    v_alignbit_b32 v45, v227, v226, 16
    v_alignbit_b32 v46, v228, v227, 16
    v_alignbit_b32 v47, v229, v228, 16
    v_alignbit_b32 v48, v230, v229, 16
    v_alignbit_b32 v49, v231, v230, 16
    ds_write_b128 v241, v[44:47] offset:10496
    ds_write_b128 v241, v[46:49] offset:12592
    ds_write_b128 v241, v[236:239] offset:5248
    ds_write_b128 v241, v[234:237] offset:15712
    v_mov_b32 v56, v233
    v_mov_b32 v57, v234
    v_mov_b32 v58, v235
    v_mov_b32 v59, v236
    v_mov_b32 v60, v237
    v_mov_b32 v61, v238
    ds_write_b128 v241, v[56:59] offset:7328
    ds_write_b128 v241, v[58:61] offset:9424
    v_alignbit_b32 v62, v233, v232, 16
    v_alignbit_b32 v63, v234, v233, 16
    v_alignbit_b32 v64, v235, v234, 16
    v_alignbit_b32 v65, v236, v235, 16
    v_alignbit_b32 v66, v237, v236, 16
    v_alignbit_b32 v67, v238, v237, 16
    ds_write_b128 v241, v[62:65] offset:1040
    ds_write_b128 v241, v[64:67] offset:3136
    v_alignbit_b32 v68, v234, v233, 16
    v_alignbit_b32 v69, v235, v234, 16
    v_alignbit_b32 v70, v236, v235, 16
    v_alignbit_b32 v71, v237, v236, 16
    v_alignbit_b32 v72, v238, v237, 16
    v_alignbit_b32 v73, v239, v238, 16
    ds_write_b128 v241, v[68:71] offset:11520
    ds_write_b128 v241, v[70:73] offset:13616
    s_waitcnt vmcnt(6)
    ds_write_b128 v250, v[160:163] offset:512
    s_waitcnt vmcnt(5)
    ds_write_b128 v250, v[164:167] offset:1024
    s_waitcnt vmcnt(4)
    ds_write_b128 v250, v[168:171] offset:1536
    s_waitcnt vmcnt(3)
    ds_write_b128 v250, v[172:175] offset:2048
    s_waitcnt vmcnt(1)
    s_waitcnt lgkmcnt(0)
    s_barrier
    ds_read_b128 v[76:79], v245 offset:1984
    ds_read_b128 v[72:75], v245 offset:1472
    ds_read_b128 v[68:71], v245 offset:960
    ds_read_b128 v[64:67], v245 offset:448
    s_waitcnt lgkmcnt(3)
    v_mfma_f32_16x16x32_bf16 v[44:47], v[28:31], v[76:79], 0
    ds_read_b128 v[108:111], v245 offset:1920
    s_waitcnt lgkmcnt(3)
    v_mfma_f32_16x16x32_bf16 v[40:43], v[28:31], v[72:75], 0
    s_waitcnt lgkmcnt(2)
    v_mfma_f32_16x16x32_bf16 v[36:39], v[28:31], v[68:71], 0
    s_waitcnt lgkmcnt(1)
    v_mfma_f32_16x16x32_bf16 v[32:35], v[28:31], v[64:67], 0
    ds_read_b128 v[104:107], v245 offset:1408
    v_mfma_f32_16x16x32_bf16 v[44:47], a[112:115], v[76:79], v[44:47]
    v_mfma_f32_16x16x32_bf16 v[40:43], a[112:115], v[72:75], v[40:43]
    v_mfma_f32_16x16x32_bf16 v[36:39], a[112:115], v[68:71], v[36:39]
    v_mfma_f32_16x16x32_bf16 v[32:35], a[112:115], v[64:67], v[32:35]
    ds_read_b128 v[100:103], v245 offset:896
    v_mfma_f32_16x16x32_bf16 v[44:47], a[116:119], v[72:75], v[44:47]
    v_mfma_f32_16x16x32_bf16 v[40:43], a[116:119], v[68:71], v[40:43]
    v_mfma_f32_16x16x32_bf16 v[36:39], a[116:119], v[64:67], v[36:39]
    ds_read_b128 v[96:99], v245 offset:384
    v_mfma_f32_16x16x32_bf16 v[44:47], a[120:123], v[68:71], v[44:47]
    v_mfma_f32_16x16x32_bf16 v[40:43], a[120:123], v[64:67], v[40:43]
    v_mfma_f32_16x16x32_bf16 v[44:47], a[124:127], v[64:67], v[44:47]
    s_waitcnt lgkmcnt(3)
    v_mfma_f32_16x16x32_bf16 v[44:47], a[128:131], v[108:111], v[44:47]
    ds_read_b128 v[76:79], v245 offset:1856
    s_waitcnt lgkmcnt(3)
    v_mfma_f32_16x16x32_bf16 v[40:43], a[128:131], v[104:107], v[40:43]
    ds_read_b128 v[72:75], v245 offset:1344
    s_waitcnt lgkmcnt(3)
    v_mfma_f32_16x16x32_bf16 v[36:39], a[128:131], v[100:103], v[36:39]
    ds_read_b128 v[68:71], v245 offset:832
    s_waitcnt lgkmcnt(3)
    v_mfma_f32_16x16x32_bf16 v[32:35], a[128:131], v[96:99], v[32:35]
    v_mfma_f32_16x16x32_bf16 v[44:47], a[132:135], v[104:107], v[44:47]
    ds_read_b128 v[64:67], v245 offset:320
    v_mfma_f32_16x16x32_bf16 v[40:43], a[132:135], v[100:103], v[40:43]
    ds_read_b64 v[224:225], v246 offset:0
    v_mfma_f32_16x16x32_bf16 v[36:39], a[132:135], v[96:99], v[36:39]
    v_mfma_f32_16x16x32_bf16 v[44:47], a[136:139], v[100:103], v[44:47]
    ds_read_b128 v[226:229], v247 offset:0
    v_mfma_f32_16x16x32_bf16 v[40:43], a[136:139], v[96:99], v[40:43]
    ds_read_b128 v[230:233], v247 offset:32
    v_mfma_f32_16x16x32_bf16 v[44:47], a[140:143], v[96:99], v[44:47]
    s_waitcnt lgkmcnt(6)
    v_mfma_f32_16x16x32_bf16 v[44:47], a[144:147], v[76:79], v[44:47]
    s_waitcnt vmcnt(0)
    v_cmp_eq_u64 vcc, s[92:93], v[252:253]
    v_cmp_eq_u64 s[30:31], s[92:93], v[254:255]
    s_nop 0
    s_and_b64 vcc, vcc, s[30:31]
    s_cmp_eq_u64 vcc, -1
    s_cbranch_scc1 L_ok_12
    s_mov_b32 s11, 0x20000
L_poll_13:
    buffer_load_dwordx4 v[252:255], v5, s[80:83], s27 offen sc1
    s_waitcnt vmcnt(0)
    v_cmp_eq_u64 vcc, s[92:93], v[252:253]
    v_cmp_eq_u64 s[30:31], s[92:93], v[254:255]
    s_nop 0
    s_and_b64 vcc, vcc, s[30:31]
    s_cmp_eq_u64 vcc, -1
    s_cbranch_scc1 L_polld_14
    s_sub_u32 s11, s11, 1
    s_cbranch_scc0 L_poll_13
L_polld_14:
L_ok_12:
    s_waitcnt lgkmcnt(5)
    v_mfma_f32_16x16x32_bf16 v[40:43], a[144:147], v[72:75], v[40:43]
    ds_read_b128 v[108:111], v245 offset:1792
    ds_read_b128 v[104:107], v245 offset:1280
    s_waitcnt lgkmcnt(6)
    v_mfma_f32_16x16x32_bf16 v[36:39], a[144:147], v[68:71], v[36:39]
    ds_read_b128 v[100:103], v245 offset:768
    ds_read_b128 v[96:99], v245 offset:256
    s_waitcnt lgkmcnt(7)
    v_mfma_f32_16x16x32_bf16 v[32:35], a[144:147], v[64:67], v[32:35]
    buffer_load_dwordx4 v[176:179], v249, s[80:83], s12 offen sc1
    v_mfma_f32_16x16x32_bf16 v[44:47], a[148:151], v[72:75], v[44:47]
    s_waitcnt lgkmcnt(6)
    v_lshlrev_b32 v192, 16, v224
    v_and_b32 v193, s10, v224
    v_mfma_f32_16x16x32_bf16 v[40:43], a[148:151], v[68:71], v[40:43]
    v_lshlrev_b32 v194, 16, v225
    v_and_b32 v195, s10, v225
    v_mfma_f32_16x16x32_bf16 v[36:39], a[148:151], v[64:67], v[36:39]
    s_waitcnt lgkmcnt(4)
    v_fma_f32 v196, v192, v226, v230
    v_fma_f32 v197, v193, v227, v231
    v_mfma_f32_16x16x32_bf16 v[44:47], a[152:155], v[68:71], v[44:47]
    v_fma_f32 v198, v194, v228, v232
    s_add_u32 s12, s12, 4096
    v_mfma_f32_16x16x32_bf16 v[40:43], a[152:155], v[64:67], v[40:43]
    buffer_load_dwordx4 v[180:183], v249, s[80:83], s12 offen sc1
    v_mfma_f32_16x16x32_bf16 v[44:47], a[156:159], v[64:67], v[44:47]
    v_fma_f32 v199, v195, v229, v233
    ds_read_b64 v[234:235], v246 offset:512
    ds_read_b128 v[236:239], v247 offset:2048
    ds_read_b128 v[240:243], v247 offset:2080
    s_waitcnt lgkmcnt(6)
    v_mfma_f32_16x16x32_bf16 v[44:47], a[160:163], v[108:111], v[44:47]
    ds_read_b128 v[76:79], v245 offset:1728
    ds_read_b128 v[72:75], v245 offset:1216
    s_waitcnt lgkmcnt(7)
    v_mfma_f32_16x16x32_bf16 v[40:43], a[160:163], v[104:107], v[40:43]
    ds_read_b128 v[68:71], v245 offset:704
    ds_read_b128 v[64:67], v245 offset:192
    s_waitcnt lgkmcnt(8)
    v_mfma_f32_16x16x32_bf16 v[36:39], a[160:163], v[100:103], v[36:39]
    s_waitcnt lgkmcnt(6)
    v_lshlrev_b32 v200, 16, v234
    s_add_u32 s12, s12, 4096
    v_mfma_f32_16x16x32_bf16 v[32:35], a[160:163], v[96:99], v[32:35]
    buffer_load_dwordx4 v[184:187], v249, s[80:83], s12 offen sc1
    v_mfma_f32_16x16x32_bf16 v[44:47], a[164:167], v[104:107], v[44:47]
    v_and_b32 v201, s10, v234
    v_lshlrev_b32 v202, 16, v235
    v_mfma_f32_16x16x32_bf16 v[40:43], a[164:167], v[100:103], v[40:43]
    v_and_b32 v203, s10, v235
    s_waitcnt lgkmcnt(4)
    v_fma_f32 v204, v200, v236, v240
    v_mfma_f32_16x16x32_bf16 v[36:39], a[164:167], v[96:99], v[36:39]
    v_fma_f32 v205, v201, v237, v241
    v_fma_f32 v206, v202, v238, v242
    v_mfma_f32_16x16x32_bf16 v[44:47], a[168:171], v[100:103], v[44:47]
    v_fma_f32 v207, v203, v239, v243
    s_add_u32 s12, s12, 4096
    v_mfma_f32_16x16x32_bf16 v[40:43], a[168:171], v[96:99], v[40:43]
    buffer_load_dwordx4 v[188:191], v249, s[80:83], s12 offen sc1
    v_mfma_f32_16x16x32_bf16 v[44:47], a[172:175], v[96:99], v[44:47]
    ds_read_b64 v[224:225], v246 offset:1024
    ds_read_b128 v[226:229], v247 offset:4096
    ds_read_b128 v[230:233], v247 offset:4128
    s_waitcnt lgkmcnt(6)
    v_mfma_f32_16x16x32_bf16 v[44:47], a[176:179], v[76:79], v[44:47]
    ds_read_b128 v[108:111], v245 offset:1664
    ds_read_b128 v[104:107], v245 offset:1152
    s_waitcnt lgkmcnt(7)
    v_mfma_f32_16x16x32_bf16 v[40:43], a[176:179], v[72:75], v[40:43]
    ds_read_b128 v[100:103], v245 offset:640
    ds_read_b128 v[96:99], v245 offset:128
    s_waitcnt lgkmcnt(8)
    v_mfma_f32_16x16x32_bf16 v[36:39], a[176:179], v[68:71], v[36:39]
    s_waitcnt lgkmcnt(6)
    v_lshlrev_b32 v208, 16, v224
    v_and_b32 v209, s10, v224
    v_mfma_f32_16x16x32_bf16 v[32:35], a[176:179], v[64:67], v[32:35]
    buffer_load_dwordx4 v2, s[80:83], s13 offen offset:0 sc1 lds
    v_mfma_f32_16x16x32_bf16 v[44:47], a[180:183], v[72:75], v[44:47]
    v_lshlrev_b32 v210, 16, v225
    v_and_b32 v211, s10, v225
    v_mfma_f32_16x16x32_bf16 v[40:43], a[180:183], v[68:71], v[40:43]
    s_waitcnt lgkmcnt(4)
    v_fma_f32 v212, v208, v226, v230
    v_fma_f32 v213, v209, v227, v231
    v_mfma_f32_16x16x32_bf16 v[36:39], a[180:183], v[64:67], v[36:39]
    v_fma_f32 v214, v210, v228, v232
    v_fma_f32 v215, v211, v229, v233
    v_mfma_f32_16x16x32_bf16 v[44:47], a[184:187], v[68:71], v[44:47]
    ds_read_b64 v[234:235], v246 offset:1536
    ds_read_b128 v[236:239], v247 offset:6144
    v_mfma_f32_16x16x32_bf16 v[40:43], a[184:187], v[64:67], v[40:43]
    buffer_load_dwordx4 v2, s[80:83], s13 offen offset:1024 sc1 lds
    v_mfma_f32_16x16x32_bf16 v[44:47], a[188:191], v[64:67], v[44:47]
    ds_read_b128 v[240:243], v247 offset:6176
    s_waitcnt lgkmcnt(6)
    v_mfma_f32_16x16x32_bf16 v[44:47], a[192:195], v[108:111], v[44:47]
    ds_read_b128 v[76:79], v245 offset:1600
    ds_read_b128 v[72:75], v245 offset:1088
    s_waitcnt lgkmcnt(7)
    v_mfma_f32_16x16x32_bf16 v[40:43], a[192:195], v[104:107], v[40:43]
    ds_read_b128 v[68:71], v245 offset:576
    ds_read_b128 v[64:67], v245 offset:64
    s_waitcnt lgkmcnt(8)
    v_mfma_f32_16x16x32_bf16 v[36:39], a[192:195], v[100:103], v[36:39]
    s_waitcnt lgkmcnt(6)
    v_lshlrev_b32 v216, 16, v234
    v_and_b32 v217, s10, v234
    v_mfma_f32_16x16x32_bf16 v[32:35], a[192:195], v[96:99], v[32:35]
    v_lshlrev_b32 v218, 16, v235
    v_and_b32 v219, s10, v235
    v_mfma_f32_16x16x32_bf16 v[44:47], a[196:199], v[104:107], v[44:47]
    s_waitcnt lgkmcnt(4)
    v_fma_f32 v220, v216, v236, v240
    v_mfma_f32_16x16x32_bf16 v[40:43], a[196:199], v[100:103], v[40:43]
    v_fma_f32 v221, v217, v237, v241
    v_fma_f32 v222, v218, v238, v242
    v_mfma_f32_16x16x32_bf16 v[36:39], a[196:199], v[96:99], v[36:39]
    v_fma_f32 v223, v219, v239, v243
    v_and_b32 v5, 7, v1
    v_mfma_f32_16x16x32_bf16 v[44:47], a[200:203], v[100:103], v[44:47]
    v_and_b32 v252, 56, v1
    v_lshlrev_b32 v252, 5, v252
    v_mfma_f32_16x16x32_bf16 v[40:43], a[200:203], v[96:99], v[40:43]
    v_lshl_add_u32 v5, v5, 4, v252
    s_lshl_b32 s27, s4, 11
    v_mfma_f32_16x16x32_bf16 v[44:47], a[204:207], v[96:99], v[44:47]
    v_add_u32 v5, s27, v5
    s_waitcnt lgkmcnt(3)
    v_mfma_f32_16x16x32_bf16 v[44:47], a[208:211], v[76:79], v[44:47]
    s_mov_b32 s27, 16384
    buffer_load_dwordx4 v[252:255], v5, s[80:83], s27 offen sc1
    s_waitcnt lgkmcnt(2)
    v_mfma_f32_16x16x32_bf16 v[40:43], a[208:211], v[72:75], v[40:43]
    ds_read_b128 v[108:111], v245 offset:1536
    s_waitcnt lgkmcnt(2)
    v_mfma_f32_16x16x32_bf16 v[36:39], a[208:211], v[68:71], v[36:39]
    s_waitcnt lgkmcnt(1)
    v_mfma_f32_16x16x32_bf16 v[32:35], a[208:211], v[64:67], v[32:35]
    ds_read_b128 v[104:107], v245 offset:1024
    v_mfma_f32_16x16x32_bf16 v[44:47], a[212:215], v[72:75], v[44:47]
    v_mfma_f32_16x16x32_bf16 v[40:43], a[212:215], v[68:71], v[40:43]
    ds_read_b128 v[100:103], v245 offset:512
    v_mfma_f32_16x16x32_bf16 v[36:39], a[212:215], v[64:67], v[36:39]
    v_mfma_f32_16x16x32_bf16 v[44:47], a[216:219], v[68:71], v[44:47]
    ds_read_b128 v[96:99], v245 offset:0
    v_mfma_f32_16x16x32_bf16 v[40:43], a[216:219], v[64:67], v[40:43]
    v_mfma_f32_16x16x32_bf16 v[44:47], a[220:223], v[64:67], v[44:47]
    s_waitcnt lgkmcnt(3)
    v_mfma_f32_16x16x32_bf16 v[44:47], a[224:227], v[108:111], v[44:47]
    ds_read_b128 v[76:79], v245 offset:1984
    s_waitcnt lgkmcnt(3)
    v_mfma_f32_16x16x32_bf16 v[40:43], a[224:227], v[104:107], v[40:43]
    ds_read_b128 v[72:75], v245 offset:1472
    s_waitcnt lgkmcnt(3)
    v_mfma_f32_16x16x32_bf16 v[36:39], a[224:227], v[100:103], v[36:39]
    ds_read_b128 v[68:71], v245 offset:960
    s_waitcnt lgkmcnt(3)
    v_mfma_f32_16x16x32_bf16 v[32:35], a[224:227], v[96:99], v[32:35]
    ds_read_b128 v[64:67], v245 offset:448
    v_mfma_f32_16x16x32_bf16 v[44:47], a[228:231], v[104:107], v[44:47]
    v_mfma_f32_16x16x32_bf16 v[40:43], a[228:231], v[100:103], v[40:43]
    ds_read_b128 v[128:131], v244 offset:0
    v_mfma_f32_16x16x32_bf16 v[36:39], a[228:231], v[96:99], v[36:39]
    ds_read_b128 v[132:135], v244 offset:512
    v_mfma_f32_16x16x32_bf16 v[44:47], a[232:235], v[100:103], v[44:47]
    ds_read_b128 v[136:139], v244 offset:1024
    v_mfma_f32_16x16x32_bf16 v[40:43], a[232:235], v[96:99], v[40:43]
    ds_read_b128 v[140:143], v244 offset:1536
    v_mfma_f32_16x16x32_bf16 v[44:47], a[236:239], v[96:99], v[44:47]
    s_lshl_b32 s12, s16, 7
    s_add_u32 s12, s12, 5767168
    v_pk_fma_f32 v[192:193], v[196:197], v[32:33], v[192:193]
    v_pk_fma_f32 v[194:195], v[198:199], v[34:35], v[194:195]
    v_cvt_pk_bf16_f32 v224, v192, v193
    v_cvt_pk_bf16_f32 v225, v194, v195
    v_pk_fma_f32 v[200:201], v[204:205], v[36:37], v[200:201]
    v_pk_fma_f32 v[202:203], v[206:207], v[38:39], v[202:203]
    v_cvt_pk_bf16_f32 v226, v200, v201
    v_cvt_pk_bf16_f32 v227, v202, v203
    s_nop 0
    v_permlane16_swap_b32 v224, v226
    v_permlane16_swap_b32 v225, v227
    buffer_store_dwordx4 v[224:227], v248, s[80:83], s12 offen sc1
    s_add_u32 s12, s12, 656384
    v_pk_fma_f32 v[208:209], v[212:213], v[40:41], v[208:209]
    v_pk_fma_f32 v[210:211], v[214:215], v[42:43], v[210:211]
    v_cvt_pk_bf16_f32 v228, v208, v209
    v_cvt_pk_bf16_f32 v229, v210, v211
    v_pk_fma_f32 v[216:217], v[220:221], v[44:45], v[216:217]
    v_pk_fma_f32 v[218:219], v[222:223], v[46:47], v[218:219]
    v_cvt_pk_bf16_f32 v230, v216, v217
    v_cvt_pk_bf16_f32 v231, v218, v219
    s_nop 0
    v_permlane16_swap_b32 v228, v230
    v_permlane16_swap_b32 v229, v231
    buffer_store_dwordx4 v[228:231], v248, s[80:83], s12 offen sc1
    s_waitcnt lgkmcnt(7)
    v_mfma_f32_16x16x32_bf16 v[48:51], a[116:119], v[76:79], 0
    s_waitcnt vmcnt(8)
    ds_write_b128 v250, v[176:179] offset:2560
    v_mfma_f32_16x16x32_bf16 v[52:55], a[120:123], v[76:79], 0
    v_mfma_f32_16x16x32_bf16 v[56:59], a[124:127], v[76:79], 0
    s_waitcnt vmcnt(7)
    ds_write_b128 v250, v[180:183] offset:3072
    s_waitcnt lgkmcnt(5)
    v_mfma_f32_16x16x32_bf16 v[60:63], v[128:131], v[76:79], 0
    v_mfma_f32_16x16x32_bf16 v[48:51], a[120:123], v[72:75], v[48:51]
    s_waitcnt vmcnt(6)
    ds_write_b128 v250, v[184:187] offset:3584
    v_mfma_f32_16x16x32_bf16 v[52:55], a[124:127], v[72:75], v[52:55]
    v_mfma_f32_16x16x32_bf16 v[56:59], v[128:131], v[72:75], v[56:59]
    s_waitcnt vmcnt(5)
    ds_write_b128 v250, v[188:191] offset:4096
    s_waitcnt lgkmcnt(6)
    v_mfma_f32_16x16x32_bf16 v[60:63], v[132:135], v[72:75], v[60:63]
    v_mfma_f32_16x16x32_bf16 v[48:51], a[124:127], v[68:71], v[48:51]
    v_mfma_f32_16x16x32_bf16 v[52:55], v[128:131], v[68:71], v[52:55]
    s_waitcnt vmcnt(3)
    s_waitcnt lgkmcnt(0)
    s_barrier
    ds_read_b128 v[80:83], v245 offset:2496
    v_mfma_f32_16x16x32_bf16 v[56:59], v[132:135], v[68:71], v[56:59]
    ds_read_b128 v[84:87], v245 offset:3008
    ds_read_b128 v[88:91], v245 offset:3520
    v_mfma_f32_16x16x32_bf16 v[60:63], v[136:139], v[68:71], v[60:63]
    ds_read_b128 v[92:95], v245 offset:4032
    v_mfma_f32_16x16x32_bf16 v[48:51], v[128:131], v[64:67], v[48:51]
    v_mfma_f32_16x16x32_bf16 v[52:55], v[132:135], v[64:67], v[52:55]
    v_mfma_f32_16x16x32_bf16 v[56:59], v[136:139], v[64:67], v[56:59]
    v_mfma_f32_16x16x32_bf16 v[60:63], v[140:143], v[64:67], v[60:63]
    s_waitcnt lgkmcnt(3)
    v_mfma_f32_16x16x32_bf16 v[48:51], v[28:31], v[80:83], v[48:51]
    ds_read_b128 v[124:127], v245 offset:3968
    v_mfma_f32_16x16x32_bf16 v[48:51], a[112:115], v[80:83], v[48:51]
    ds_read_b128 v[120:123], v245 offset:3456
    v_mfma_f32_16x16x32_bf16 v[52:55], a[116:119], v[80:83], v[52:55]
    ds_read_b128 v[116:119], v245 offset:2944
    v_mfma_f32_16x16x32_bf16 v[56:59], a[120:123], v[80:83], v[56:59]
    ds_read_b128 v[112:115], v245 offset:2432
    v_mfma_f32_16x16x32_bf16 v[60:63], a[124:127], v[80:83], v[60:63]
    ds_read_b128 v[108:111], v245 offset:1920
    s_waitcnt lgkmcnt(7)
    v_mfma_f32_16x16x32_bf16 v[52:55], v[28:31], v[84:87], v[52:55]
    ds_read_b128 v[104:107], v245 offset:1408
    v_mfma_f32_16x16x32_bf16 v[52:55], a[112:115], v[84:87], v[52:55]
    v_mfma_f32_16x16x32_bf16 v[56:59], a[116:119], v[84:87], v[56:59]
    ds_read_b128 v[100:103], v245 offset:896
    v_mfma_f32_16x16x32_bf16 v[60:63], a[120:123], v[84:87], v[60:63]
    ds_read_b128 v[96:99], v245 offset:384
    s_waitcnt lgkmcnt(9)
    v_mfma_f32_16x16x32_bf16 v[56:59], v[28:31], v[88:91], v[56:59]
    ds_read_b128 v[144:147], v244 offset:64
    v_mfma_f32_16x16x32_bf16 v[56:59], a[112:115], v[88:91], v[56:59]
    ds_read_b128 v[148:151], v244 offset:576
    v_mfma_f32_16x16x32_bf16 v[60:63], a[116:119], v[88:91], v[60:63]
    ds_read_b128 v[152:155], v244 offset:1088
    s_waitcnt lgkmcnt(11)
    v_mfma_f32_16x16x32_bf16 v[60:63], v[28:31], v[92:95], v[60:63]
    ds_read_b128 v[156:159], v244 offset:1600
    v_mfma_f32_16x16x32_bf16 v[60:63], a[112:115], v[92:95], v[60:63]
    s_waitcnt lgkmcnt(11)
    v_mfma_f32_16x16x32_bf16 v[60:63], a[128:131], v[124:127], v[60:63]
    s_waitcnt vmcnt(2)
    v_cmp_eq_u64 vcc, s[92:93], v[252:253]
    v_cmp_eq_u64 s[30:31], s[92:93], v[254:255]
    s_nop 0
    s_and_b64 vcc, vcc, s[30:31]
    s_cmp_eq_u64 vcc, -1
    s_cbranch_scc1 L_ok_15
    s_mov_b32 s11, 0x20000
L_poll_16:
    buffer_load_dwordx4 v[252:255], v5, s[80:83], s27 offen sc1
    s_waitcnt vmcnt(0)
    v_cmp_eq_u64 vcc, s[92:93], v[252:253]
    v_cmp_eq_u64 s[30:31], s[92:93], v[254:255]
    s_nop 0
    s_and_b64 vcc, vcc, s[30:31]
    s_cmp_eq_u64 vcc, -1
    s_cbranch_scc1 L_polld_17
    s_sub_u32 s11, s11, 1
    s_cbranch_scc0 L_poll_16
L_polld_17:
L_ok_15:
    s_waitcnt lgkmcnt(10)
    v_mfma_f32_16x16x32_bf16 v[56:59], a[128:131], v[120:123], v[56:59]
    ds_read_b128 v[92:95], v245 offset:3904
    s_add_u32 s41, s44, 0
    s_waitcnt lgkmcnt(10)
    v_mfma_f32_16x16x32_bf16 v[52:55], a[128:131], v[116:119], v[52:55]
    buffer_load_dwordx4 a[0:3], v2, s[80:83], s41 offen offset:0 sc1
    s_waitcnt lgkmcnt(9)
    v_mfma_f32_16x16x32_bf16 v[48:51], a[128:131], v[112:115], v[48:51]
    ds_read_b128 v[88:91], v245 offset:3392
    ds_read_b128 v[84:87], v245 offset:2880
    v_mfma_f32_16x16x32_bf16 v[60:63], a[132:135], v[120:123], v[60:63]
    ds_read_b128 v[80:83], v245 offset:2368
    ds_read_b128 v[76:79], v245 offset:1856
    v_mfma_f32_16x16x32_bf16 v[56:59], a[132:135], v[116:119], v[56:59]
    ds_read_b128 v[72:75], v245 offset:1344
    ds_read_b128 v[68:71], v245 offset:832
    v_mfma_f32_16x16x32_bf16 v[52:55], a[132:135], v[112:115], v[52:55]
    buffer_load_dwordx4 a[4:7], v2, s[80:83], s41 offen offset:1024 sc1
    s_waitcnt lgkmcnt(14)
    v_mfma_f32_16x16x32_bf16 v[48:51], a[132:135], v[108:111], v[48:51]
    ds_read_b128 v[64:67], v245 offset:320
    v_mfma_f32_16x16x32_bf16 v[60:63], a[136:139], v[116:119], v[60:63]
    ds_read_b128 v[128:131], v244 offset:128
    ds_read_b128 v[132:135], v244 offset:640
    v_mfma_f32_16x16x32_bf16 v[56:59], a[136:139], v[112:115], v[56:59]
    ds_read_b128 v[136:139], v244 offset:1152
    ds_read_b128 v[140:143], v244 offset:1664
    v_mfma_f32_16x16x32_bf16 v[52:55], a[136:139], v[108:111], v[52:55]
    buffer_load_dwordx4 a[8:11], v2, s[80:83], s41 offen offset:2048 sc1
    s_waitcnt lgkmcnt(15)
    v_mfma_f32_16x16x32_bf16 v[48:51], a[136:139], v[104:107], v[48:51]
    s_waitcnt vmcnt(3)
    s_barrier
    s_mov_b32 s43, 32768
    s_mov_b64 exec, 3
    buffer_atomic_swap v6, v4, s[80:83], s43 offen sc1
    s_mov_b64 exec, -1
    ds_read_b64 v[224:225], v246 offset:2048
    v_mfma_f32_16x16x32_bf16 v[60:63], a[140:143], v[112:115], v[60:63]
    ds_read_b128 v[226:229], v247 offset:8192
    v_mfma_f32_16x16x32_bf16 v[56:59], a[140:143], v[108:111], v[56:59]
    buffer_load_dwordx4 a[12:15], v2, s[80:83], s41 offen offset:3072 sc1
    v_mfma_f32_16x16x32_bf16 v[52:55], a[140:143], v[104:107], v[52:55]
    ds_read_b128 v[230:233], v247 offset:8224
    v_and_b32 v166, 15, v1
    v_mfma_f32_16x16x32_bf16 v[48:51], a[140:143], v[100:103], v[48:51]
    v_mul_u32_u24 v167, 12288, v166
    v_and_or_b32 v167, v1, 48, v167
    v_mfma_f32_16x16x32_bf16 v[60:63], v[144:147], v[108:111], v[60:63]
    v_lshrrev_b32 v166, 2, v166
    s_add_u32 s41, s44, 4096
    v_mfma_f32_16x16x32_bf16 v[56:59], v[144:147], v[104:107], v[56:59]
    buffer_load_dwordx4 a[16:19], v2, s[80:83], s41 offen offset:0 sc1
    v_mfma_f32_16x16x32_bf16 v[52:55], v[144:147], v[100:103], v[52:55]
    v_lshlrev_b32 v166, 28, v166
    v_add_u32 v166, 196608, v166
    v_mfma_f32_16x16x32_bf16 v[48:51], v[144:147], v[96:99], v[48:51]
    v_add_u32 v166, v166, v167
    s_waitcnt lgkmcnt(15)
    v_mfma_f32_16x16x32_bf16 v[60:63], v[148:151], v[104:107], v[60:63]
    v_and_b32 v5, 7, v1
    v_min_u32 v5, 4, v5
    v_mfma_f32_16x16x32_bf16 v[56:59], v[148:151], v[100:103], v[56:59]
    buffer_load_dwordx4 a[20:23], v2, s[80:83], s41 offen offset:1024 sc1
    v_mfma_f32_16x16x32_bf16 v[52:55], v[148:151], v[96:99], v[52:55]
    v_and_b32 v252, 56, v1
    v_lshlrev_b32 v252, 5, v252
    v_mfma_f32_16x16x32_bf16 v[60:63], v[152:155], v[100:103], v[60:63]
    v_lshl_add_u32 v5, v5, 4, v252
    s_lshl_b32 s27, s4, 11
    v_mfma_f32_16x16x32_bf16 v[56:59], v[152:155], v[96:99], v[56:59]
    buffer_load_dwordx4 a[24:27], v2, s[80:83], s41 offen offset:2048 sc1
    v_mfma_f32_16x16x32_bf16 v[60:63], v[156:159], v[96:99], v[60:63]
    v_add_u32 v5, s27, v5
    s_waitcnt lgkmcnt(14)
    v_mfma_f32_16x16x32_bf16 v[60:63], a[144:147], v[92:95], v[60:63]
    ds_read_b128 v[124:127], v245 offset:3840
    ds_read_b128 v[120:123], v245 offset:3328
    s_waitcnt lgkmcnt(15)
    v_mfma_f32_16x16x32_bf16 v[56:59], a[144:147], v[88:91], v[56:59]
    ds_read_b128 v[116:119], v245 offset:2816
    s_waitcnt lgkmcnt(15)
    v_mfma_f32_16x16x32_bf16 v[52:55], a[144:147], v[84:87], v[52:55]
    buffer_load_dwordx4 a[28:31], v2, s[80:83], s41 offen offset:3072 sc1
    s_waitcnt lgkmcnt(14)
    v_mfma_f32_16x16x32_bf16 v[48:51], a[144:147], v[80:83], v[48:51]
    ds_read_b128 v[112:115], v245 offset:2304
    v_mfma_f32_16x16x32_bf16 v[60:63], a[148:151], v[88:91], v[60:63]
    ds_read_b128 v[108:111], v245 offset:1792
    ds_read_b128 v[104:107], v245 offset:1280
    v_mfma_f32_16x16x32_bf16 v[56:59], a[148:151], v[84:87], v[56:59]
    s_add_u32 s41, s44, 8192
    v_mfma_f32_16x16x32_bf16 v[52:55], a[148:151], v[80:83], v[52:55]
    buffer_load_dwordx4 a[32:35], v2, s[80:83], s41 offen offset:0 sc1
    s_waitcnt lgkmcnt(15)
    v_mfma_f32_16x16x32_bf16 v[48:51], a[148:151], v[76:79], v[48:51]
    ds_read_b128 v[100:103], v245 offset:768
    ds_read_b128 v[96:99], v245 offset:256
    v_mfma_f32_16x16x32_bf16 v[60:63], a[152:155], v[84:87], v[60:63]
    ds_read_b128 v[144:147], v244 offset:192
    v_mfma_f32_16x16x32_bf16 v[56:59], a[152:155], v[80:83], v[56:59]
    ds_read_b128 v[148:151], v244 offset:704
    v_mfma_f32_16x16x32_bf16 v[52:55], a[152:155], v[76:79], v[52:55]
    buffer_load_dwordx4 a[36:39], v2, s[80:83], s41 offen offset:1024 sc1
    v_mfma_f32_16x16x32_bf16 v[48:51], a[152:155], v[72:75], v[48:51]
    ds_read_b128 v[152:155], v244 offset:1216
    v_mfma_f32_16x16x32_bf16 v[60:63], a[156:159], v[80:83], v[60:63]
    ds_read_b128 v[156:159], v244 offset:1728
    s_waitcnt lgkmcnt(14)
    v_lshlrev_b32 v192, 16, v224
    v_mfma_f32_16x16x32_bf16 v[56:59], a[156:159], v[76:79], v[56:59]
    buffer_load_dwordx4 a[40:43], v2, s[80:83], s41 offen offset:2048 sc1
    v_mfma_f32_16x16x32_bf16 v[52:55], a[156:159], v[72:75], v[52:55]
    v_and_b32 v193, s10, v224
    v_mfma_f32_16x16x32_bf16 v[48:51], a[156:159], v[68:71], v[48:51]
    v_lshlrev_b32 v194, 16, v225
    v_mfma_f32_16x16x32_bf16 v[60:63], v[128:131], v[76:79], v[60:63]
    v_and_b32 v195, s10, v225
    v_mfma_f32_16x16x32_bf16 v[56:59], v[128:131], v[72:75], v[56:59]
    buffer_load_dwordx4 a[44:47], v2, s[80:83], s41 offen offset:3072 sc1
    v_mfma_f32_16x16x32_bf16 v[52:55], v[128:131], v[68:71], v[52:55]
    s_waitcnt lgkmcnt(12)
    v_fma_f32 v196, v192, v226, v230
    v_fma_f32 v197, v193, v227, v231
    v_mfma_f32_16x16x32_bf16 v[48:51], v[128:131], v[64:67], v[48:51]
    v_fma_f32 v198, v194, v228, v232
    v_mfma_f32_16x16x32_bf16 v[60:63], v[132:135], v[72:75], v[60:63]
    v_fma_f32 v199, v195, v229, v233
    s_add_u32 s41, s44, 12288
    v_mfma_f32_16x16x32_bf16 v[56:59], v[132:135], v[68:71], v[56:59]
    buffer_load_dwordx4 a[48:51], v2, s[80:83], s41 offen offset:0 sc1
    v_mfma_f32_16x16x32_bf16 v[52:55], v[132:135], v[64:67], v[52:55]
    ds_read_b64 v[234:235], v246 offset:2560
    v_mfma_f32_16x16x32_bf16 v[60:63], v[136:139], v[68:71], v[60:63]
    ds_read_b128 v[236:239], v247 offset:10240
    v_mfma_f32_16x16x32_bf16 v[56:59], v[136:139], v[64:67], v[56:59]
    buffer_load_dwordx4 a[52:55], v2, s[80:83], s41 offen offset:1024 sc1
    v_mfma_f32_16x16x32_bf16 v[60:63], v[140:143], v[64:67], v[60:63]
    ds_read_b128 v[240:243], v247 offset:10272
    s_waitcnt lgkmcnt(14)
    v_mfma_f32_16x16x32_bf16 v[60:63], a[160:163], v[124:127], v[60:63]
    ds_read_b128 v[92:95], v245 offset:3776
    ds_read_b128 v[88:91], v245 offset:3264
    s_waitcnt lgkmcnt(15)
    v_mfma_f32_16x16x32_bf16 v[56:59], a[160:163], v[120:123], v[56:59]
    ds_read_b128 v[84:87], v245 offset:2752
    s_waitcnt lgkmcnt(15)
    v_mfma_f32_16x16x32_bf16 v[52:55], a[160:163], v[116:119], v[52:55]
    buffer_load_dwordx4 a[56:59], v2, s[80:83], s41 offen offset:2048 sc1
    s_waitcnt lgkmcnt(14)
    v_mfma_f32_16x16x32_bf16 v[48:51], a[160:163], v[112:115], v[48:51]
    ds_read_b128 v[80:83], v245 offset:2240
    v_mfma_f32_16x16x32_bf16 v[60:63], a[164:167], v[120:123], v[60:63]
    ds_read_b128 v[76:79], v245 offset:1728
    ds_read_b128 v[72:75], v245 offset:1216
    v_mfma_f32_16x16x32_bf16 v[56:59], a[164:167], v[116:119], v[56:59]
    s_add_u32 s41, s45, 0
    v_mfma_f32_16x16x32_bf16 v[52:55], a[164:167], v[112:115], v[52:55]
    buffer_load_dwordx4 a[60:63], v2, s[80:83], s41 offen offset:0 sc1
    s_waitcnt lgkmcnt(15)
    v_mfma_f32_16x16x32_bf16 v[48:51], a[164:167], v[108:111], v[48:51]
    ds_read_b128 v[68:71], v245 offset:704
    ds_read_b128 v[64:67], v245 offset:192
    v_mfma_f32_16x16x32_bf16 v[60:63], a[168:171], v[116:119], v[60:63]
    ds_read_b128 v[128:131], v244 offset:256
    v_mfma_f32_16x16x32_bf16 v[56:59], a[168:171], v[112:115], v[56:59]
    ds_read_b128 v[132:135], v244 offset:768
    v_mfma_f32_16x16x32_bf16 v[52:55], a[168:171], v[108:111], v[52:55]
    buffer_load_dwordx4 a[64:67], v2, s[80:83], s41 offen offset:1024 sc1
    v_mfma_f32_16x16x32_bf16 v[48:51], a[168:171], v[104:107], v[48:51]
    ds_read_b128 v[136:139], v244 offset:1280
    v_mfma_f32_16x16x32_bf16 v[60:63], a[172:175], v[112:115], v[60:63]
    ds_read_b128 v[140:143], v244 offset:1792
    s_waitcnt lgkmcnt(14)
    v_lshlrev_b32 v200, 16, v234
    v_mfma_f32_16x16x32_bf16 v[56:59], a[172:175], v[108:111], v[56:59]
    buffer_load_dwordx4 a[68:71], v2, s[80:83], s41 offen offset:2048 sc1
    v_mfma_f32_16x16x32_bf16 v[52:55], a[172:175], v[104:107], v[52:55]
    v_and_b32 v201, s10, v234
    v_mfma_f32_16x16x32_bf16 v[48:51], a[172:175], v[100:103], v[48:51]
    v_lshlrev_b32 v202, 16, v235
    v_mfma_f32_16x16x32_bf16 v[60:63], v[144:147], v[108:111], v[60:63]
    v_and_b32 v203, s10, v235
    v_mfma_f32_16x16x32_bf16 v[56:59], v[144:147], v[104:107], v[56:59]
    buffer_load_dwordx4 a[72:75], v2, s[80:83], s41 offen offset:3072 sc1
    v_mfma_f32_16x16x32_bf16 v[52:55], v[144:147], v[100:103], v[52:55]
    s_waitcnt lgkmcnt(12)
    v_fma_f32 v204, v200, v236, v240
    v_fma_f32 v205, v201, v237, v241
    v_mfma_f32_16x16x32_bf16 v[48:51], v[144:147], v[96:99], v[48:51]
    v_fma_f32 v206, v202, v238, v242
    v_mfma_f32_16x16x32_bf16 v[60:63], v[148:151], v[104:107], v[60:63]
    v_fma_f32 v207, v203, v239, v243
    s_add_u32 s41, s45, 4096
    v_mfma_f32_16x16x32_bf16 v[56:59], v[148:151], v[100:103], v[56:59]
    buffer_load_dwordx4 a[76:79], v2, s[80:83], s41 offen offset:0 sc1
    v_mfma_f32_16x16x32_bf16 v[52:55], v[148:151], v[96:99], v[52:55]
    ds_read_b64 v[224:225], v246 offset:3072
    v_mfma_f32_16x16x32_bf16 v[60:63], v[152:155], v[100:103], v[60:63]
    ds_read_b128 v[226:229], v247 offset:12288
    v_mfma_f32_16x16x32_bf16 v[56:59], v[152:155], v[96:99], v[56:59]
    buffer_load_dwordx4 a[80:83], v2, s[80:83], s41 offen offset:1024 sc1
    v_mfma_f32_16x16x32_bf16 v[60:63], v[156:159], v[96:99], v[60:63]
    ds_read_b128 v[230:233], v247 offset:12320
    s_waitcnt lgkmcnt(14)
    v_mfma_f32_16x16x32_bf16 v[60:63], a[176:179], v[92:95], v[60:63]
    ds_read_b128 v[124:127], v245 offset:3712
    ds_read_b128 v[120:123], v245 offset:3200
    s_waitcnt lgkmcnt(15)
    v_mfma_f32_16x16x32_bf16 v[56:59], a[176:179], v[88:91], v[56:59]
    ds_read_b128 v[116:119], v245 offset:2688
    s_waitcnt lgkmcnt(15)
    v_mfma_f32_16x16x32_bf16 v[52:55], a[176:179], v[84:87], v[52:55]
    buffer_load_dwordx4 a[84:87], v2, s[80:83], s41 offen offset:2048 sc1
    s_waitcnt lgkmcnt(14)
    v_mfma_f32_16x16x32_bf16 v[48:51], a[176:179], v[80:83], v[48:51]
    ds_read_b128 v[112:115], v245 offset:2176
    v_mfma_f32_16x16x32_bf16 v[60:63], a[180:183], v[88:91], v[60:63]
    ds_read_b128 v[108:111], v245 offset:1664
    ds_read_b128 v[104:107], v245 offset:1152
    v_mfma_f32_16x16x32_bf16 v[56:59], a[180:183], v[84:87], v[56:59]
    ds_read_b128 v[100:103], v245 offset:640
    v_mfma_f32_16x16x32_bf16 v[52:55], a[180:183], v[80:83], v[52:55]
    buffer_load_dwordx4 a[88:91], v2, s[80:83], s41 offen offset:3072 sc1
    s_waitcnt lgkmcnt(15)
    v_mfma_f32_16x16x32_bf16 v[48:51], a[180:183], v[76:79], v[48:51]
    ds_read_b128 v[96:99], v245 offset:128
    v_mfma_f32_16x16x32_bf16 v[60:63], a[184:187], v[84:87], v[60:63]
    ds_read_b128 v[144:147], v244 offset:320
    v_mfma_f32_16x16x32_bf16 v[56:59], a[184:187], v[80:83], v[56:59]
    ds_read_b128 v[148:151], v244 offset:832
    s_add_u32 s41, s45, 8192
    v_mfma_f32_16x16x32_bf16 v[52:55], a[184:187], v[76:79], v[52:55]
    buffer_load_dwordx4 a[92:95], v2, s[80:83], s41 offen offset:0 sc1
    v_mfma_f32_16x16x32_bf16 v[48:51], a[184:187], v[72:75], v[48:51]
    ds_read_b128 v[152:155], v244 offset:1344
    v_mfma_f32_16x16x32_bf16 v[60:63], a[188:191], v[80:83], v[60:63]
    ds_read_b128 v[156:159], v244 offset:1856
    s_waitcnt lgkmcnt(14)
    v_lshlrev_b32 v208, 16, v224
    v_mfma_f32_16x16x32_bf16 v[56:59], a[188:191], v[76:79], v[56:59]
    buffer_load_dwordx4 a[96:99], v2, s[80:83], s41 offen offset:1024 sc1
    v_mfma_f32_16x16x32_bf16 v[52:55], a[188:191], v[72:75], v[52:55]
    v_and_b32 v209, s10, v224
    v_mfma_f32_16x16x32_bf16 v[48:51], a[188:191], v[68:71], v[48:51]
    v_lshlrev_b32 v210, 16, v225
    v_mfma_f32_16x16x32_bf16 v[60:63], v[128:131], v[76:79], v[60:63]
    v_and_b32 v211, s10, v225
    v_mfma_f32_16x16x32_bf16 v[56:59], v[128:131], v[72:75], v[56:59]
    buffer_load_dwordx4 a[100:103], v2, s[80:83], s41 offen offset:2048 sc1
    v_mfma_f32_16x16x32_bf16 v[52:55], v[128:131], v[68:71], v[52:55]
    s_waitcnt lgkmcnt(12)
    v_fma_f32 v212, v208, v226, v230
    v_fma_f32 v213, v209, v227, v231
    v_mfma_f32_16x16x32_bf16 v[48:51], v[128:131], v[64:67], v[48:51]
    v_fma_f32 v214, v210, v228, v232
    v_mfma_f32_16x16x32_bf16 v[60:63], v[132:135], v[72:75], v[60:63]
    v_fma_f32 v215, v211, v229, v233
    v_mfma_f32_16x16x32_bf16 v[56:59], v[132:135], v[68:71], v[56:59]
    buffer_load_dwordx4 a[104:107], v2, s[80:83], s41 offen offset:3072 sc1
    v_mfma_f32_16x16x32_bf16 v[52:55], v[132:135], v[64:67], v[52:55]
    ds_read_b64 v[234:235], v246 offset:3584
    ds_read_b128 v[236:239], v247 offset:14336
    v_mfma_f32_16x16x32_bf16 v[60:63], v[136:139], v[68:71], v[60:63]
    s_add_u32 s41, s45, 12288
    v_mfma_f32_16x16x32_bf16 v[56:59], v[136:139], v[64:67], v[56:59]
    buffer_load_dwordx4 a[108:111], v2, s[80:83], s41 offen offset:0 sc1
    v_mfma_f32_16x16x32_bf16 v[60:63], v[140:143], v[64:67], v[60:63]
    ds_read_b128 v[240:243], v247 offset:14368
    s_waitcnt lgkmcnt(14)
    v_mfma_f32_16x16x32_bf16 v[60:63], a[192:195], v[124:127], v[60:63]
    s_mov_b32 s27, 32768
    buffer_load_dwordx4 v[252:255], v5, s[80:83], s27 offen sc1
    s_waitcnt lgkmcnt(13)
    v_mfma_f32_16x16x32_bf16 v[56:59], a[192:195], v[120:123], v[56:59]
    ds_read_b128 v[92:95], v245 offset:3648
    ds_read_b128 v[88:91], v245 offset:3136
    s_waitcnt lgkmcnt(14)
    v_mfma_f32_16x16x32_bf16 v[52:55], a[192:195], v[116:119], v[52:55]
    buffer_load_dwordx4 a[112:115], v2, s[80:83], s41 offen offset:1024 sc1
    s_waitcnt lgkmcnt(13)
    v_mfma_f32_16x16x32_bf16 v[48:51], a[192:195], v[112:115], v[48:51]
    ds_read_b128 v[84:87], v245 offset:2624
    v_mfma_f32_16x16x32_bf16 v[60:63], a[196:199], v[120:123], v[60:63]
    ds_read_b128 v[80:83], v245 offset:2112
    v_mfma_f32_16x16x32_bf16 v[56:59], a[196:199], v[116:119], v[56:59]
    ds_read_b128 v[76:79], v245 offset:1600
    v_mfma_f32_16x16x32_bf16 v[52:55], a[196:199], v[112:115], v[52:55]
    buffer_load_dwordx4 a[116:119], v2, s[80:83], s41 offen offset:2048 sc1
    s_waitcnt lgkmcnt(15)
    v_mfma_f32_16x16x32_bf16 v[48:51], a[196:199], v[108:111], v[48:51]
    ds_read_b128 v[72:75], v245 offset:1088
    v_mfma_f32_16x16x32_bf16 v[60:63], a[200:203], v[116:119], v[60:63]
    ds_read_b128 v[68:71], v245 offset:576
    ds_read_b128 v[64:67], v245 offset:64
    v_mfma_f32_16x16x32_bf16 v[56:59], a[200:203], v[112:115], v[56:59]
    s_add_u32 s41, s46, 0
    v_mfma_f32_16x16x32_bf16 v[52:55], a[200:203], v[108:111], v[52:55]
    buffer_load_dwordx4 a[120:123], v2, s[80:83], s41 offen offset:0 sc1
    s_waitcnt lgkmcnt(15)
    v_mfma_f32_16x16x32_bf16 v[48:51], a[200:203], v[104:107], v[48:51]
    ds_read_b128 v[128:131], v244 offset:384
    v_mfma_f32_16x16x32_bf16 v[60:63], a[204:207], v[112:115], v[60:63]
    ds_read_b128 v[132:135], v244 offset:896
    v_mfma_f32_16x16x32_bf16 v[56:59], a[204:207], v[108:111], v[56:59]
    buffer_load_dwordx4 a[124:127], v2, s[80:83], s41 offen offset:1024 sc1
    v_mfma_f32_16x16x32_bf16 v[52:55], a[204:207], v[104:107], v[52:55]
    ds_read_b128 v[136:139], v244 offset:1408
    ds_read_b128 v[140:143], v244 offset:1920
    v_mfma_f32_16x16x32_bf16 v[48:51], a[204:207], v[100:103], v[48:51]
    s_waitcnt lgkmcnt(14)
    v_lshlrev_b32 v216, 16, v234
    v_mfma_f32_16x16x32_bf16 v[60:63], v[144:147], v[108:111], v[60:63]
    v_and_b32 v217, s10, v234
    v_mfma_f32_16x16x32_bf16 v[56:59], v[144:147], v[104:107], v[56:59]
    buffer_load_dwordx4 a[128:131], v2, s[80:83], s41 offen offset:2048 sc1
    v_mfma_f32_16x16x32_bf16 v[52:55], v[144:147], v[100:103], v[52:55]
    v_lshlrev_b32 v218, 16, v235
    v_mfma_f32_16x16x32_bf16 v[48:51], v[144:147], v[96:99], v[48:51]
    v_and_b32 v219, s10, v235
    v_mfma_f32_16x16x32_bf16 v[60:63], v[148:151], v[104:107], v[60:63]
    s_waitcnt lgkmcnt(12)
    v_fma_f32 v220, v216, v236, v240
    v_fma_f32 v221, v217, v237, v241
    v_mfma_f32_16x16x32_bf16 v[56:59], v[148:151], v[100:103], v[56:59]
    buffer_load_dwordx4 a[132:135], v2, s[80:83], s41 offen offset:3072 sc1
    v_mfma_f32_16x16x32_bf16 v[52:55], v[148:151], v[96:99], v[52:55]
    v_fma_f32 v222, v218, v238, v242
    v_mfma_f32_16x16x32_bf16 v[60:63], v[152:155], v[100:103], v[60:63]
    s_add_u32 s41, s46, 4096
    v_mfma_f32_16x16x32_bf16 v[56:59], v[152:155], v[96:99], v[56:59]
    buffer_load_dwordx4 a[136:139], v2, s[80:83], s41 offen offset:0 sc1
    v_mfma_f32_16x16x32_bf16 v[60:63], v[156:159], v[96:99], v[60:63]
    v_fma_f32 v223, v219, v239, v243
    s_waitcnt lgkmcnt(11)
    v_mfma_f32_16x16x32_bf16 v[60:63], a[208:211], v[92:95], v[60:63]
    ds_read_b128 v[124:127], v245 offset:3584
    s_waitcnt lgkmcnt(11)
    v_mfma_f32_16x16x32_bf16 v[56:59], a[208:211], v[88:91], v[56:59]
    ds_read_b128 v[120:123], v245 offset:3072
    s_waitcnt lgkmcnt(11)
    v_mfma_f32_16x16x32_bf16 v[52:55], a[208:211], v[84:87], v[52:55]
    buffer_load_dwordx4 a[140:143], v2, s[80:83], s41 offen offset:1024 sc1
    s_waitcnt lgkmcnt(10)
    v_mfma_f32_16x16x32_bf16 v[48:51], a[208:211], v[80:83], v[48:51]
    ds_read_b128 v[116:119], v245 offset:2560
    v_mfma_f32_16x16x32_bf16 v[60:63], a[212:215], v[88:91], v[60:63]
    ds_read_b128 v[112:115], v245 offset:2048
    v_mfma_f32_16x16x32_bf16 v[56:59], a[212:215], v[84:87], v[56:59]
    ds_read_b128 v[108:111], v245 offset:1536
    v_mfma_f32_16x16x32_bf16 v[52:55], a[212:215], v[80:83], v[52:55]
    buffer_load_dwordx4 a[144:147], v2, s[80:83], s41 offen offset:2048 sc1
    s_waitcnt lgkmcnt(12)
    v_mfma_f32_16x16x32_bf16 v[48:51], a[212:215], v[76:79], v[48:51]
    ds_read_b128 v[104:107], v245 offset:1024
    v_mfma_f32_16x16x32_bf16 v[60:63], a[216:219], v[84:87], v[60:63]
    ds_read_b128 v[100:103], v245 offset:512
    v_mfma_f32_16x16x32_bf16 v[56:59], a[216:219], v[80:83], v[56:59]
    ds_read_b128 v[96:99], v245 offset:0
    v_mfma_f32_16x16x32_bf16 v[52:55], a[216:219], v[76:79], v[52:55]
    buffer_load_dwordx4 a[148:151], v2, s[80:83], s41 offen offset:3072 sc1
    s_waitcnt lgkmcnt(14)
    v_mfma_f32_16x16x32_bf16 v[48:51], a[216:219], v[72:75], v[48:51]
    ds_read_b128 v[144:147], v244 offset:448
    v_mfma_f32_16x16x32_bf16 v[60:63], a[220:223], v[80:83], v[60:63]
    s_add_u32 s41, s46, 8192
    v_mfma_f32_16x16x32_bf16 v[56:59], a[220:223], v[76:79], v[56:59]
    buffer_load_dwordx4 a[152:155], v2, s[80:83], s41 offen offset:0 sc1
    v_mfma_f32_16x16x32_bf16 v[52:55], a[220:223], v[72:75], v[52:55]
    ds_read_b128 v[148:151], v244 offset:960
    s_waitcnt lgkmcnt(15)
    v_mfma_f32_16x16x32_bf16 v[48:51], a[220:223], v[68:71], v[48:51]
    ds_read_b128 v[152:155], v244 offset:1472
    s_waitcnt lgkmcnt(14)
    v_mfma_f32_16x16x32_bf16 v[60:63], v[128:131], v[76:79], v[60:63]
    ds_read_b128 v[156:159], v244 offset:1984
    v_mfma_f32_16x16x32_bf16 v[56:59], v[128:131], v[72:75], v[56:59]
    buffer_load_dwordx4 a[156:159], v2, s[80:83], s41 offen offset:1024 sc1
    v_mfma_f32_16x16x32_bf16 v[52:55], v[128:131], v[68:71], v[52:55]
    s_cmp_eq_u32 s16, 0
    s_cselect_b32 s13, 0, 0x7ff00000
    s_add_u32 s13, s13, 98304
    s_mov_b64 exec, 1
    buffer_store_dword v6, v2, s[80:83], s13 offen sc1
    s_mov_b64 exec, -1
    v_mfma_f32_16x16x32_bf16 v[48:51], v[128:131], v[64:67], v[48:51]
    v_mov_b32 v28, 0x3f803f80
    s_waitcnt lgkmcnt(14)
    v_mfma_f32_16x16x32_bf16 v[60:63], v[132:135], v[72:75], v[60:63]
    v_mov_b32 v29, 0x3f803f80
    v_mfma_f32_16x16x32_bf16 v[56:59], v[132:135], v[68:71], v[56:59]
    buffer_load_dwordx4 a[160:163], v2, s[80:83], s41 offen offset:2048 sc1
    v_mfma_f32_16x16x32_bf16 v[52:55], v[132:135], v[64:67], v[52:55]
    v_mov_b32 v30, 0x3f803f80
    s_waitcnt lgkmcnt(13)
    v_mfma_f32_16x16x32_bf16 v[60:63], v[136:139], v[68:71], v[60:63]
    v_mov_b32 v31, 0x3f803f80
    v_mfma_f32_16x16x32_bf16 v[56:59], v[136:139], v[64:67], v[56:59]
    buffer_load_dwordx4 a[164:167], v2, s[80:83], s41 offen offset:3072 sc1
    s_waitcnt lgkmcnt(12)
    v_mfma_f32_16x16x32_bf16 v[60:63], v[140:143], v[64:67], v[60:63]
    s_waitcnt lgkmcnt(11)
    v_mfma_f32_16x16x32_bf16 v[60:63], a[224:227], v[124:127], v[60:63]
    s_waitcnt vmcnt(15)
    v_cmp_eq_u64 vcc, s[92:93], v[252:253]
    v_cmp_eq_u64 s[30:31], s[92:93], v[254:255]
    s_nop 0
    s_and_b64 vcc, vcc, s[30:31]
    s_cmp_eq_u64 vcc, -1
    s_cbranch_scc1 L_ok_18
    s_mov_b32 s11, 0x20000
L_poll_19:
    buffer_load_dwordx4 v[252:255], v5, s[80:83], s27 offen sc1
    s_waitcnt vmcnt(0)
    v_cmp_eq_u64 vcc, s[92:93], v[252:253]
    v_cmp_eq_u64 s[30:31], s[92:93], v[254:255]
    s_nop 0
    s_and_b64 vcc, vcc, s[30:31]
    s_cmp_eq_u64 vcc, -1
    s_cbranch_scc1 L_polld_20
    s_sub_u32 s11, s11, 1
    s_cbranch_scc0 L_poll_19
L_polld_20:
L_ok_18:
    s_waitcnt lgkmcnt(10)
    v_mfma_f32_16x16x32_bf16 v[56:59], a[224:227], v[120:123], v[56:59]
    s_add_u32 s24, s49, 0
    s_add_u32 m0, s25, 131072
    s_waitcnt lgkmcnt(9)
    v_mfma_f32_16x16x32_bf16 v[52:55], a[224:227], v[116:119], v[52:55]
    buffer_load_dwordx4 v2, s[80:83], s24 offen offset:0 sc1 lds
    s_waitcnt lgkmcnt(8)
    v_mfma_f32_16x16x32_bf16 v[48:51], a[224:227], v[112:115], v[48:51]
    v_mfma_f32_16x16x32_bf16 v[60:63], a[228:231], v[120:123], v[60:63]
    v_mfma_f32_16x16x32_bf16 v[56:59], a[228:231], v[116:119], v[56:59]
    buffer_load_dwordx4 v2, s[80:83], s24 offen offset:1024 sc1 lds
    v_mfma_f32_16x16x32_bf16 v[52:55], a[228:231], v[112:115], v[52:55]
    s_waitcnt lgkmcnt(7)
    v_mfma_f32_16x16x32_bf16 v[48:51], a[228:231], v[108:111], v[48:51]
    v_mfma_f32_16x16x32_bf16 v[60:63], a[232:235], v[116:119], v[60:63]
    buffer_load_dwordx4 v2, s[80:83], s24 offen offset:2048 sc1 lds
    v_mfma_f32_16x16x32_bf16 v[56:59], a[232:235], v[112:115], v[56:59]
    v_mfma_f32_16x16x32_bf16 v[52:55], a[232:235], v[108:111], v[52:55]
    s_waitcnt lgkmcnt(6)
    v_mfma_f32_16x16x32_bf16 v[48:51], a[232:235], v[104:107], v[48:51]
    v_mfma_f32_16x16x32_bf16 v[60:63], a[236:239], v[112:115], v[60:63]
    buffer_load_dwordx4 v2, s[80:83], s24 offen offset:3072 sc1 lds
    v_mfma_f32_16x16x32_bf16 v[56:59], a[236:239], v[108:111], v[56:59]
    v_mfma_f32_16x16x32_bf16 v[52:55], a[236:239], v[104:107], v[52:55]
    s_add_u32 s24, s50, 0
    s_add_u32 m0, s25, 147456
    s_waitcnt lgkmcnt(5)
    v_mfma_f32_16x16x32_bf16 v[48:51], a[236:239], v[100:103], v[48:51]
    buffer_load_dwordx4 v2, s[80:83], s24 offen offset:0 sc1 lds
    s_waitcnt lgkmcnt(3)
    v_mfma_f32_16x16x32_bf16 v[60:63], v[144:147], v[108:111], v[60:63]
    v_mfma_f32_16x16x32_bf16 v[56:59], v[144:147], v[104:107], v[56:59]
    v_mfma_f32_16x16x32_bf16 v[52:55], v[144:147], v[100:103], v[52:55]
    buffer_load_dwordx4 v2, s[80:83], s24 offen offset:1024 sc1 lds
    v_mfma_f32_16x16x32_bf16 v[48:51], v[144:147], v[96:99], v[48:51]
    s_waitcnt lgkmcnt(2)
    v_mfma_f32_16x16x32_bf16 v[60:63], v[148:151], v[104:107], v[60:63]
    v_mfma_f32_16x16x32_bf16 v[56:59], v[148:151], v[100:103], v[56:59]
    buffer_load_dwordx4 v2, s[80:83], s24 offen offset:2048 sc1 lds
    v_mfma_f32_16x16x32_bf16 v[52:55], v[148:151], v[96:99], v[52:55]
    s_waitcnt lgkmcnt(1)
    v_mfma_f32_16x16x32_bf16 v[60:63], v[152:155], v[100:103], v[60:63]
    v_mfma_f32_16x16x32_bf16 v[56:59], v[152:155], v[96:99], v[56:59]
    s_waitcnt lgkmcnt(0)
    v_mfma_f32_16x16x32_bf16 v[60:63], v[156:159], v[96:99], v[60:63]
    buffer_load_dwordx4 v2, s[80:83], s24 offen offset:3072 sc1 lds
    s_lshl_b32 s12, s16, 7
    s_add_u32 s12, s12, 7079936
    v_pk_fma_f32 v[192:193], v[196:197], v[48:49], v[192:193]
    v_pk_fma_f32 v[194:195], v[198:199], v[50:51], v[194:195]
    v_cvt_pk_bf16_f32 v224, v192, v193
    v_cvt_pk_bf16_f32 v225, v194, v195
    v_pk_fma_f32 v[200:201], v[204:205], v[52:53], v[200:201]
    v_pk_fma_f32 v[202:203], v[206:207], v[54:55], v[202:203]
    v_cvt_pk_bf16_f32 v226, v200, v201
    v_cvt_pk_bf16_f32 v227, v202, v203
    s_nop 0
    v_permlane16_swap_b32 v224, v226
    v_permlane16_swap_b32 v225, v227
    buffer_store_dwordx4 v[224:227], v248, s[80:83], s12 offen sc1
    s_add_u32 s12, s12, 656384
    v_pk_fma_f32 v[208:209], v[212:213], v[56:57], v[208:209]
    v_pk_fma_f32 v[210:211], v[214:215], v[58:59], v[210:211]
    v_cvt_pk_bf16_f32 v228, v208, v209
    v_cvt_pk_bf16_f32 v229, v210, v211
    v_pk_fma_f32 v[216:217], v[220:221], v[60:61], v[216:217]
    v_pk_fma_f32 v[218:219], v[222:223], v[62:63], v[218:219]
    v_cvt_pk_bf16_f32 v230, v216, v217
    v_cvt_pk_bf16_f32 v231, v218, v219
    s_nop 0
    v_permlane16_swap_b32 v228, v230
    v_permlane16_swap_b32 v229, v231
    buffer_store_dwordx4 v[228:231], v248, s[80:83], s12 offen sc1
L_gemm:
    s_nop 4
    s_waitcnt vmcnt(6)
    s_barrier
    ds_read_b64_tr_b16 v[104:105], v8 offset:0
    ds_read_b64_tr_b16 v[106:107], v8 offset:2048
    ds_read_b64_tr_b16 v[108:109], v9 offset:0
    ds_read_b64_tr_b16 v[110:111], v9 offset:2048
    ds_read_b64_tr_b16 v[112:113], v10 offset:0
    ds_read_b64_tr_b16 v[114:115], v10 offset:2048
    ds_read_b64_tr_b16 v[116:117], v11 offset:0
    ds_read_b64_tr_b16 v[118:119], v11 offset:2048
    s_waitcnt lgkmcnt(6)
    v_mfma_f32_16x16x32_bf16 v[80:83], v[104:107], v[104:107], 0
    ds_read_b64_tr_b16 v[120:121], v8 offset:4096
    v_mfma_f32_16x16x32_bf16 v[84:87], v[28:31], v[104:107], 0
    ds_read_b64_tr_b16 v[122:123], v8 offset:6144
    v_mfma_f32_16x16x32_bf16 v[32:35], a[0:3], v[104:107], 0
    ds_read_b64_tr_b16 v[124:125], v9 offset:4096
    v_mfma_f32_16x16x32_bf16 v[36:39], a[4:7], v[104:107], 0
    buffer_load_dwordx4 v[168:171], v167, s[80:83], s87 offen offset:0 sc1
    v_mfma_f32_16x16x32_bf16 v[40:43], a[8:11], v[104:107], 0
    s_waitcnt lgkmcnt(7)
    v_mfma_f32_16x16x32_bf16 v[44:47], a[0:3], v[108:111], 0
    ds_read_b64_tr_b16 v[126:127], v9 offset:6144
    v_mfma_f32_16x16x32_bf16 v[48:51], a[4:7], v[108:111], 0
    ds_read_b64_tr_b16 v[128:129], v10 offset:4096
    v_mfma_f32_16x16x32_bf16 v[52:55], a[8:11], v[108:111], 0
    buffer_load_dwordx4 v[172:175], v167, s[80:83], s87 offen offset:64 sc1
    s_waitcnt lgkmcnt(7)
    v_mfma_f32_16x16x32_bf16 v[56:59], a[0:3], v[112:115], 0
    ds_read_b64_tr_b16 v[130:131], v10 offset:6144
    v_mfma_f32_16x16x32_bf16 v[60:63], a[4:7], v[112:115], 0
    v_mfma_f32_16x16x32_bf16 v[64:67], a[8:11], v[112:115], 0
    ds_read_b64_tr_b16 v[132:133], v11 offset:4096
    s_waitcnt lgkmcnt(7)
    v_mfma_f32_16x16x32_bf16 v[68:71], a[0:3], v[116:119], 0
    ds_read_b64_tr_b16 v[134:135], v11 offset:6144
    v_mfma_f32_16x16x32_bf16 v[72:75], a[4:7], v[116:119], 0
    buffer_load_dwordx4 v[176:179], v167, s[80:83], s87 offen offset:128 sc1
    v_mfma_f32_16x16x32_bf16 v[76:79], a[8:11], v[116:119], 0
    s_waitcnt lgkmcnt(6)
    v_mfma_f32_16x16x32_bf16 v[80:83], v[120:123], v[120:123], v[80:83]
    ds_read_b64_tr_b16 v[104:105], v8 offset:8192
    v_mfma_f32_16x16x32_bf16 v[84:87], v[28:31], v[120:123], v[84:87]
    ds_read_b64_tr_b16 v[106:107], v8 offset:10240
    v_mfma_f32_16x16x32_bf16 v[32:35], a[12:15], v[120:123], v[32:35]
    ds_read_b64_tr_b16 v[108:109], v9 offset:8192
    v_mfma_f32_16x16x32_bf16 v[36:39], a[16:19], v[120:123], v[36:39]
    buffer_load_dwordx4 v[180:183], v166, s[80:83], s87 offen offset:0 sc1
    v_mfma_f32_16x16x32_bf16 v[40:43], a[20:23], v[120:123], v[40:43]
    s_waitcnt lgkmcnt(7)
    v_mfma_f32_16x16x32_bf16 v[44:47], a[12:15], v[124:127], v[44:47]
    ds_read_b64_tr_b16 v[110:111], v9 offset:10240
    v_mfma_f32_16x16x32_bf16 v[48:51], a[16:19], v[124:127], v[48:51]
    ds_read_b64_tr_b16 v[112:113], v10 offset:8192
    v_mfma_f32_16x16x32_bf16 v[52:55], a[20:23], v[124:127], v[52:55]
    buffer_load_dwordx4 v[184:187], v166, s[80:83], s87 offen offset:64 sc1
    s_waitcnt lgkmcnt(7)
    v_mfma_f32_16x16x32_bf16 v[56:59], a[12:15], v[128:131], v[56:59]
    ds_read_b64_tr_b16 v[114:115], v10 offset:10240
    v_mfma_f32_16x16x32_bf16 v[60:63], a[16:19], v[128:131], v[60:63]
    v_mfma_f32_16x16x32_bf16 v[64:67], a[20:23], v[128:131], v[64:67]
    ds_read_b64_tr_b16 v[116:117], v11 offset:8192
    s_waitcnt lgkmcnt(7)
    v_mfma_f32_16x16x32_bf16 v[68:71], a[12:15], v[132:135], v[68:71]
    ds_read_b64_tr_b16 v[118:119], v11 offset:10240
    v_mfma_f32_16x16x32_bf16 v[72:75], a[16:19], v[132:135], v[72:75]
    buffer_load_dwordx4 v[188:191], v166, s[80:83], s87 offen offset:128 sc1
    v_mfma_f32_16x16x32_bf16 v[76:79], a[20:23], v[132:135], v[76:79]
    s_waitcnt lgkmcnt(6)
    v_mfma_f32_16x16x32_bf16 v[80:83], v[104:107], v[104:107], v[80:83]
    ds_read_b64_tr_b16 v[120:121], v8 offset:12288
    v_mfma_f32_16x16x32_bf16 v[84:87], v[28:31], v[104:107], v[84:87]
    ds_read_b64_tr_b16 v[122:123], v8 offset:14336
    v_mfma_f32_16x16x32_bf16 v[32:35], a[24:27], v[104:107], v[32:35]
    s_add_u32 s24, s51, 0
    s_add_u32 m0, s25, 0
    v_mfma_f32_16x16x32_bf16 v[36:39], a[28:31], v[104:107], v[36:39]
    buffer_load_dwordx4 v2, s[80:83], s24 offen offset:0 sc1 lds
    v_mfma_f32_16x16x32_bf16 v[40:43], a[32:35], v[104:107], v[40:43]
    ds_read_b64_tr_b16 v[124:125], v9 offset:12288
    s_waitcnt lgkmcnt(7)
    v_mfma_f32_16x16x32_bf16 v[44:47], a[24:27], v[108:111], v[44:47]
    ds_read_b64_tr_b16 v[126:127], v9 offset:14336
    v_mfma_f32_16x16x32_bf16 v[48:51], a[28:31], v[108:111], v[48:51]
    v_mfma_f32_16x16x32_bf16 v[52:55], a[32:35], v[108:111], v[52:55]
    buffer_load_dwordx4 v2, s[80:83], s24 offen offset:1024 sc1 lds
    s_waitcnt lgkmcnt(6)
    v_mfma_f32_16x16x32_bf16 v[56:59], a[24:27], v[112:115], v[56:59]
    ds_read_b64_tr_b16 v[128:129], v10 offset:12288
    v_mfma_f32_16x16x32_bf16 v[60:63], a[28:31], v[112:115], v[60:63]
    ds_read_b64_tr_b16 v[130:131], v10 offset:14336
    v_mfma_f32_16x16x32_bf16 v[64:67], a[32:35], v[112:115], v[64:67]
    ds_read_b64_tr_b16 v[132:133], v11 offset:12288
    s_waitcnt lgkmcnt(7)
    v_mfma_f32_16x16x32_bf16 v[68:71], a[24:27], v[116:119], v[68:71]
    ds_read_b64_tr_b16 v[134:135], v11 offset:14336
    v_mfma_f32_16x16x32_bf16 v[72:75], a[28:31], v[116:119], v[72:75]
    buffer_load_dwordx4 v2, s[80:83], s24 offen offset:2048 sc1 lds
    v_mfma_f32_16x16x32_bf16 v[76:79], a[32:35], v[116:119], v[76:79]
    s_waitcnt lgkmcnt(6)
    v_mfma_f32_16x16x32_bf16 v[80:83], v[120:123], v[120:123], v[80:83]
    s_waitcnt vmcnt(9)
    s_barrier
    s_mov_b32 s43, 49152
    s_mov_b64 exec, 3
    buffer_atomic_swap v6, v4, s[80:83], s43 offen sc1
    s_mov_b64 exec, -1
    v_mfma_f32_16x16x32_bf16 v[84:87], v[28:31], v[120:123], v[84:87]
    s_barrier
    v_mfma_f32_16x16x32_bf16 v[32:35], a[36:39], v[120:123], v[32:35]
    ds_read_b64_tr_b16 v[104:105], v8 offset:16384
    v_mfma_f32_16x16x32_bf16 v[36:39], a[40:43], v[120:123], v[36:39]
    buffer_load_dwordx4 v2, s[80:83], s24 offen offset:3072 sc1 lds
    v_mfma_f32_16x16x32_bf16 v[40:43], a[44:47], v[120:123], v[40:43]
    ds_read_b64_tr_b16 v[106:107], v8 offset:18432
    s_waitcnt lgkmcnt(6)
    v_mfma_f32_16x16x32_bf16 v[44:47], a[36:39], v[124:127], v[44:47]
    ds_read_b64_tr_b16 v[108:109], v9 offset:16384
    v_mfma_f32_16x16x32_bf16 v[48:51], a[40:43], v[124:127], v[48:51]
    s_add_u32 s24, s52, 0
    s_add_u32 m0, s25, 16384
    v_mfma_f32_16x16x32_bf16 v[52:55], a[44:47], v[124:127], v[52:55]
    buffer_load_dwordx4 v2, s[80:83], s24 offen offset:0 sc1 lds
    s_waitcnt lgkmcnt(5)
    v_mfma_f32_16x16x32_bf16 v[56:59], a[36:39], v[128:131], v[56:59]
    ds_read_b64_tr_b16 v[110:111], v9 offset:18432
    v_mfma_f32_16x16x32_bf16 v[60:63], a[40:43], v[128:131], v[60:63]
    ds_read_b64_tr_b16 v[112:113], v10 offset:16384
    v_mfma_f32_16x16x32_bf16 v[64:67], a[44:47], v[128:131], v[64:67]
    ds_read_b64_tr_b16 v[114:115], v10 offset:18432
    s_waitcnt lgkmcnt(6)
    v_mfma_f32_16x16x32_bf16 v[68:71], a[36:39], v[132:135], v[68:71]
    ds_read_b64_tr_b16 v[116:117], v11 offset:16384
    v_mfma_f32_16x16x32_bf16 v[72:75], a[40:43], v[132:135], v[72:75]
    buffer_load_dwordx4 v2, s[80:83], s24 offen offset:1024 sc1 lds
    v_mfma_f32_16x16x32_bf16 v[76:79], a[44:47], v[132:135], v[76:79]
    ds_read_b64_tr_b16 v[118:119], v11 offset:18432
    s_waitcnt lgkmcnt(6)
    v_mfma_f32_16x16x32_bf16 v[80:83], v[104:107], v[104:107], v[80:83]
    s_mov_b32 s27, 16512
    buffer_load_dwordx4 v[252:255], v24, s[80:83], s27 offen sc1
    v_mfma_f32_16x16x32_bf16 v[84:87], v[28:31], v[104:107], v[84:87]
    ds_read_b64_tr_b16 v[120:121], v8 offset:20480
    v_mfma_f32_16x16x32_bf16 v[32:35], a[48:51], v[104:107], v[32:35]
    ds_read_b64_tr_b16 v[122:123], v8 offset:22528
    v_mfma_f32_16x16x32_bf16 v[36:39], a[52:55], v[104:107], v[36:39]
    buffer_load_dwordx4 v2, s[80:83], s24 offen offset:2048 sc1 lds
    v_mfma_f32_16x16x32_bf16 v[40:43], a[56:59], v[104:107], v[40:43]
    ds_read_b64_tr_b16 v[124:125], v9 offset:20480
    s_waitcnt lgkmcnt(7)
    v_mfma_f32_16x16x32_bf16 v[44:47], a[48:51], v[108:111], v[44:47]
    ds_read_b64_tr_b16 v[126:127], v9 offset:22528
    v_mfma_f32_16x16x32_bf16 v[48:51], a[52:55], v[108:111], v[48:51]
    ds_read_b64_tr_b16 v[128:129], v10 offset:20480
    v_mfma_f32_16x16x32_bf16 v[52:55], a[56:59], v[108:111], v[52:55]
    buffer_load_dwordx4 v2, s[80:83], s24 offen offset:3072 sc1 lds
    s_waitcnt lgkmcnt(7)
    v_mfma_f32_16x16x32_bf16 v[56:59], a[48:51], v[112:115], v[56:59]
    ds_read_b64_tr_b16 v[130:131], v10 offset:22528
    v_mfma_f32_16x16x32_bf16 v[60:63], a[52:55], v[112:115], v[60:63]
    v_mfma_f32_16x16x32_bf16 v[64:67], a[56:59], v[112:115], v[64:67]
    ds_read_b64_tr_b16 v[132:133], v11 offset:20480
    s_waitcnt lgkmcnt(7)
    v_mfma_f32_16x16x32_bf16 v[68:71], a[48:51], v[116:119], v[68:71]
    ds_read_b64_tr_b16 v[134:135], v11 offset:22528
    s_add_u32 s41, s46, 12288
    v_mfma_f32_16x16x32_bf16 v[72:75], a[52:55], v[116:119], v[72:75]
    buffer_load_dwordx4 a[168:171], v2, s[80:83], s41 offen offset:0 sc1
    v_mfma_f32_16x16x32_bf16 v[76:79], a[56:59], v[116:119], v[76:79]
    s_waitcnt lgkmcnt(6)
    v_mfma_f32_16x16x32_bf16 v[32:35], a[60:63], v[120:123], v[32:35]
    ds_read_b64_tr_b16 v[104:105], v8 offset:24576
    ds_read_b64_tr_b16 v[106:107], v8 offset:26624
    v_mfma_f32_16x16x32_bf16 v[36:39], a[64:67], v[120:123], v[36:39]
    ds_read_b64_tr_b16 v[108:109], v9 offset:24576
    ds_read_b64_tr_b16 v[110:111], v9 offset:26624
    v_mfma_f32_16x16x32_bf16 v[40:43], a[68:71], v[120:123], v[40:43]
    buffer_load_dwordx4 a[172:175], v2, s[80:83], s41 offen offset:1024 sc1
    s_waitcnt lgkmcnt(8)
    v_mfma_f32_16x16x32_bf16 v[44:47], a[60:63], v[124:127], v[44:47]
    ds_read_b64_tr_b16 v[112:113], v10 offset:24576
    ds_read_b64_tr_b16 v[114:115], v10 offset:26624
    v_mfma_f32_16x16x32_bf16 v[48:51], a[64:67], v[124:127], v[48:51]
    ds_read_b64_tr_b16 v[116:117], v11 offset:24576
    ds_read_b64_tr_b16 v[118:119], v11 offset:26624
    v_mfma_f32_16x16x32_bf16 v[52:55], a[68:71], v[124:127], v[52:55]
    v_mov_b32 v101, v6
    v_mov_b32 v103, v6
    s_waitcnt lgkmcnt(10)
    v_mfma_f32_16x16x32_bf16 v[56:59], a[60:63], v[128:131], v[56:59]
    buffer_load_dwordx4 a[176:179], v2, s[80:83], s41 offen offset:2048 sc1
    v_mfma_f32_16x16x32_bf16 v[60:63], a[64:67], v[128:131], v[60:63]
    v_mov_b32 v100, v84
    v_cndmask_b32 v102, v80, v81, s[32:33]
    v_mfma_f32_16x16x32_bf16 v[64:67], a[68:71], v[128:131], v[64:67]
    v_cndmask_b32 v102, v102, v82, s[34:35]
    v_cndmask_b32 v102, v102, v83, s[36:37]
    s_waitcnt lgkmcnt(8)
    v_mfma_f32_16x16x32_bf16 v[68:71], a[60:63], v[132:135], v[68:71]
    s_add_u32 s24, s53, 0
    s_add_u32 m0, s25, 32768
    v_mfma_f32_16x16x32_bf16 v[72:75], a[64:67], v[132:135], v[72:75]
    buffer_load_dwordx4 v2, s[80:83], s24 offen offset:0 sc1 lds
    v_mfma_f32_16x16x32_bf16 v[76:79], a[68:71], v[132:135], v[76:79]
    s_add_u32 s43, s48, 0
    s_mov_b32 exec_lo, 0x00f0000f
    s_mov_b32 exec_hi, 0xf0000f00
    buffer_store_dwordx4 v[100:103], v12, s[80:83], s43 offen sc1
    s_mov_b64 exec, -1
    s_waitcnt lgkmcnt(6)
    v_mfma_f32_16x16x32_bf16 v[32:35], a[72:75], v[104:107], v[32:35]
    ds_read_b64_tr_b16 v[120:121], v8 offset:28672
    ds_read_b64_tr_b16 v[122:123], v8 offset:30720
    v_mfma_f32_16x16x32_bf16 v[36:39], a[76:79], v[104:107], v[36:39]
    ds_read_b64_tr_b16 v[124:125], v9 offset:28672
    ds_read_b64_tr_b16 v[126:127], v9 offset:30720
    v_mfma_f32_16x16x32_bf16 v[40:43], a[80:83], v[104:107], v[40:43]
    buffer_load_dwordx4 v2, s[80:83], s24 offen offset:1024 sc1 lds
    s_waitcnt lgkmcnt(8)
    v_mfma_f32_16x16x32_bf16 v[44:47], a[72:75], v[108:111], v[44:47]
    ds_read_b64_tr_b16 v[128:129], v10 offset:28672
    v_mfma_f32_16x16x32_bf16 v[48:51], a[76:79], v[108:111], v[48:51]
    ds_read_b64_tr_b16 v[130:131], v10 offset:30720
    ds_read_b64_tr_b16 v[132:133], v11 offset:28672
    v_mfma_f32_16x16x32_bf16 v[52:55], a[80:83], v[108:111], v[52:55]
    ds_read_b64_tr_b16 v[134:135], v11 offset:30720
    s_waitcnt lgkmcnt(10)
    v_mfma_f32_16x16x32_bf16 v[56:59], a[72:75], v[112:115], v[56:59]
    buffer_load_dwordx4 v2, s[80:83], s24 offen offset:2048 sc1 lds
    v_mfma_f32_16x16x32_bf16 v[60:63], a[76:79], v[112:115], v[60:63]
    s_waitcnt vmcnt(19)
    v_add_f32 v88, v168, v180
    v_add_f32 v89, v169, v181
    v_mfma_f32_16x16x32_bf16 v[64:67], a[80:83], v[112:115], v[64:67]
    v_add_f32 v90, v170, v182
    s_waitcnt lgkmcnt(8)
    v_mfma_f32_16x16x32_bf16 v[68:71], a[72:75], v[116:119], v[68:71]
    v_add_f32 v91, v171, v183
    s_waitcnt vmcnt(18)
    v_add_f32 v92, v172, v184
    v_mfma_f32_16x16x32_bf16 v[72:75], a[76:79], v[116:119], v[72:75]
    buffer_load_dwordx4 v2, s[80:83], s24 offen offset:3072 sc1 lds
    v_mfma_f32_16x16x32_bf16 v[76:79], a[80:83], v[116:119], v[76:79]
    v_add_f32 v93, v173, v185
    s_waitcnt lgkmcnt(6)
    v_mfma_f32_16x16x32_bf16 v[32:35], a[84:87], v[120:123], v[32:35]
    s_waitcnt vmcnt(13)
    s_barrier
    v_add_u32 v8, -131072, v8
    v_mfma_f32_16x16x32_bf16 v[36:39], a[88:91], v[120:123], v[36:39]
    v_add_u32 v9, -131072, v9
    s_add_u32 s41, s47, 0
    v_mfma_f32_16x16x32_bf16 v[40:43], a[92:95], v[120:123], v[40:43]
    buffer_load_dwordx4 a[180:183], v2, s[80:83], s41 offen offset:0 sc1
    s_waitcnt lgkmcnt(4)
    v_mfma_f32_16x16x32_bf16 v[44:47], a[84:87], v[124:127], v[44:47]
    v_add_u32 v10, -131072, v10
    v_add_u32 v11, -131072, v11
    v_mfma_f32_16x16x32_bf16 v[48:51], a[88:91], v[124:127], v[48:51]
    ds_read_b64_tr_b16 v[104:105], v8 offset:0
    ds_read_b64_tr_b16 v[106:107], v8 offset:2048
    v_mfma_f32_16x16x32_bf16 v[52:55], a[92:95], v[124:127], v[52:55]
    ds_read_b64_tr_b16 v[108:109], v9 offset:0
    ds_read_b64_tr_b16 v[110:111], v9 offset:2048
    s_waitcnt lgkmcnt(6)
    v_mfma_f32_16x16x32_bf16 v[56:59], a[84:87], v[128:131], v[56:59]
    buffer_load_dwordx4 a[184:187], v2, s[80:83], s41 offen offset:1024 sc1
    v_mfma_f32_16x16x32_bf16 v[60:63], a[88:91], v[128:131], v[60:63]
    ds_read_b64_tr_b16 v[112:113], v10 offset:0
    ds_read_b64_tr_b16 v[114:115], v10 offset:2048
    v_mfma_f32_16x16x32_bf16 v[64:67], a[92:95], v[128:131], v[64:67]
    ds_read_b64_tr_b16 v[116:117], v11 offset:0
    ds_read_b64_tr_b16 v[118:119], v11 offset:2048
    s_waitcnt lgkmcnt(8)
    v_mfma_f32_16x16x32_bf16 v[68:71], a[84:87], v[132:135], v[68:71]
    v_add_f32 v94, v174, v186
    v_add_f32 v95, v175, v187
    v_mfma_f32_16x16x32_bf16 v[72:75], a[88:91], v[132:135], v[72:75]
    buffer_load_dwordx4 a[188:191], v2, s[80:83], s41 offen offset:2048 sc1
    v_mfma_f32_16x16x32_bf16 v[76:79], a[92:95], v[132:135], v[76:79]
    v_add_f32 v96, v176, v188
    v_add_f32 v97, v177, v189
    v_add_f32 v98, v178, v190
    v_add_f32 v99, v179, v191
    s_waitcnt lgkmcnt(6)
    v_mfma_f32_16x16x32_bf16 v[32:35], a[96:99], v[104:107], v[32:35]
    s_waitcnt vmcnt(13)
    v_cmp_eq_u64 vcc, s[92:93], v[252:253]
    v_cmp_eq_u64 s[30:31], s[92:93], v[254:255]
    s_nop 0
    s_and_b64 vcc, vcc, s[30:31]
    s_cmp_eq_u64 vcc, -1
    s_cbranch_scc1 L_ok_21
    s_mov_b32 s11, 0x20000
L_poll_22:
    buffer_load_dwordx4 v[252:255], v24, s[80:83], s27 offen sc1
    s_waitcnt vmcnt(0)
    v_cmp_eq_u64 vcc, s[92:93], v[252:253]
    v_cmp_eq_u64 s[30:31], s[92:93], v[254:255]
    s_nop 0
    s_and_b64 vcc, vcc, s[30:31]
    s_cmp_eq_u64 vcc, -1
    s_cbranch_scc1 L_polld_23
    s_sub_u32 s11, s11, 1
    s_cbranch_scc0 L_poll_22
L_polld_23:
L_ok_21:
    v_mfma_f32_16x16x32_bf16 v[36:39], a[100:103], v[104:107], v[36:39]
    ds_read_b64_tr_b16 v[120:121], v8 offset:4096
    ds_read_b64_tr_b16 v[122:123], v8 offset:6144
    v_mfma_f32_16x16x32_bf16 v[40:43], a[104:107], v[104:107], v[40:43]
    buffer_load_dwordx4 a[192:195], v2, s[80:83], s41 offen offset:3072 sc1
    s_waitcnt lgkmcnt(6)
    v_mfma_f32_16x16x32_bf16 v[44:47], a[96:99], v[108:111], v[44:47]
    ds_read_b64_tr_b16 v[124:125], v9 offset:4096
    ds_read_b64_tr_b16 v[126:127], v9 offset:6144
    v_mfma_f32_16x16x32_bf16 v[48:51], a[100:103], v[108:111], v[48:51]
    ds_read_b64_tr_b16 v[128:129], v10 offset:4096
    ds_read_b64_tr_b16 v[130:131], v10 offset:6144
    v_mfma_f32_16x16x32_bf16 v[52:55], a[104:107], v[108:111], v[52:55]
    ds_read_b64_tr_b16 v[132:133], v11 offset:4096
    s_add_u32 s41, s47, 4096
    s_waitcnt lgkmcnt(9)
    v_mfma_f32_16x16x32_bf16 v[56:59], a[96:99], v[112:115], v[56:59]
    buffer_load_dwordx4 a[196:199], v2, s[80:83], s41 offen offset:0 sc1
    v_mfma_f32_16x16x32_bf16 v[60:63], a[100:103], v[112:115], v[60:63]
    ds_read_b64_tr_b16 v[134:135], v11 offset:6144
    v_add_f32_dpp v88, v88, v88 row_ror:8 row_mask:0xf bank_mask:0xf
    v_mfma_f32_16x16x32_bf16 v[64:67], a[104:107], v[112:115], v[64:67]
    v_add_f32_dpp v89, v89, v89 row_ror:8 row_mask:0xf bank_mask:0xf
    v_add_f32_dpp v90, v90, v90 row_ror:8 row_mask:0xf bank_mask:0xf
    s_waitcnt lgkmcnt(8)
    v_mfma_f32_16x16x32_bf16 v[68:71], a[96:99], v[116:119], v[68:71]
    v_add_f32_dpp v91, v91, v91 row_ror:8 row_mask:0xf bank_mask:0xf
    v_add_f32_dpp v92, v92, v92 row_ror:8 row_mask:0xf bank_mask:0xf
    v_mfma_f32_16x16x32_bf16 v[72:75], a[100:103], v[116:119], v[72:75]
    buffer_load_dwordx4 a[200:203], v2, s[80:83], s41 offen offset:1024 sc1
    v_mfma_f32_16x16x32_bf16 v[76:79], a[104:107], v[116:119], v[76:79]
    v_add_f32_dpp v93, v93, v93 row_ror:8 row_mask:0xf bank_mask:0xf
    s_waitcnt lgkmcnt(6)
    v_mfma_f32_16x16x32_bf16 v[32:35], a[108:111], v[120:123], v[32:35]
    ds_read_b64_tr_b16 v[104:105], v8 offset:8192
    ds_read_b64_tr_b16 v[106:107], v8 offset:10240
    v_mfma_f32_16x16x32_bf16 v[36:39], a[112:115], v[120:123], v[36:39]
    ds_read_b64_tr_b16 v[108:109], v9 offset:8192
    ds_read_b64_tr_b16 v[110:111], v9 offset:10240
    v_mfma_f32_16x16x32_bf16 v[40:43], a[116:119], v[120:123], v[40:43]
    buffer_load_dwordx4 a[204:207], v2, s[80:83], s41 offen offset:2048 sc1
    s_waitcnt lgkmcnt(8)
    v_mfma_f32_16x16x32_bf16 v[44:47], a[108:111], v[124:127], v[44:47]
    ds_read_b64_tr_b16 v[112:113], v10 offset:8192
    v_mfma_f32_16x16x32_bf16 v[48:51], a[112:115], v[124:127], v[48:51]
    ds_read_b64_tr_b16 v[114:115], v10 offset:10240
    ds_read_b64_tr_b16 v[116:117], v11 offset:8192
    v_mfma_f32_16x16x32_bf16 v[52:55], a[116:119], v[124:127], v[52:55]
    ds_read_b64_tr_b16 v[118:119], v11 offset:10240
    v_add_f32_dpp v94, v94, v94 row_ror:8 row_mask:0xf bank_mask:0xf
    s_waitcnt lgkmcnt(10)
    v_mfma_f32_16x16x32_bf16 v[56:59], a[108:111], v[128:131], v[56:59]
    buffer_load_dwordx4 a[208:211], v2, s[80:83], s41 offen offset:3072 sc1
    v_mfma_f32_16x16x32_bf16 v[60:63], a[112:115], v[128:131], v[60:63]
    v_add_f32_dpp v95, v95, v95 row_ror:8 row_mask:0xf bank_mask:0xf
    v_mfma_f32_16x16x32_bf16 v[64:67], a[116:119], v[128:131], v[64:67]
    v_add_f32_dpp v96, v96, v96 row_ror:8 row_mask:0xf bank_mask:0xf
    v_add_f32_dpp v97, v97, v97 row_ror:8 row_mask:0xf bank_mask:0xf
    s_waitcnt lgkmcnt(8)
    v_mfma_f32_16x16x32_bf16 v[68:71], a[108:111], v[132:135], v[68:71]
    v_add_f32_dpp v98, v98, v98 row_ror:8 row_mask:0xf bank_mask:0xf
    s_add_u32 s41, s47, 8192
    v_mfma_f32_16x16x32_bf16 v[72:75], a[112:115], v[132:135], v[72:75]
    buffer_load_dwordx4 a[212:215], v2, s[80:83], s41 offen offset:0 sc1
    v_mfma_f32_16x16x32_bf16 v[76:79], a[116:119], v[132:135], v[76:79]
    v_add_f32_dpp v99, v99, v99 row_ror:8 row_mask:0xf bank_mask:0xf
    s_waitcnt lgkmcnt(6)
    v_mfma_f32_16x16x32_bf16 v[32:35], a[120:123], v[104:107], v[32:35]
    s_mov_b32 s27, 49152
    buffer_load_dwordx4 v[252:255], v5, s[80:83], s27 offen sc1
    v_mfma_f32_16x16x32_bf16 v[36:39], a[124:127], v[104:107], v[36:39]
    ds_read_b64_tr_b16 v[120:121], v8 offset:12288
    ds_read_b64_tr_b16 v[122:123], v8 offset:14336
    v_mfma_f32_16x16x32_bf16 v[40:43], a[128:131], v[104:107], v[40:43]
    buffer_load_dwordx4 a[216:219], v2, s[80:83], s41 offen offset:1024 sc1
    s_waitcnt lgkmcnt(6)
    v_mfma_f32_16x16x32_bf16 v[44:47], a[120:123], v[108:111], v[44:47]
    ds_read_b64_tr_b16 v[124:125], v9 offset:12288
    ds_read_b64_tr_b16 v[126:127], v9 offset:14336
    v_mfma_f32_16x16x32_bf16 v[48:51], a[124:127], v[108:111], v[48:51]
    ds_read_b64_tr_b16 v[128:129], v10 offset:12288
    ds_read_b64_tr_b16 v[130:131], v10 offset:14336
    v_mfma_f32_16x16x32_bf16 v[52:55], a[128:131], v[108:111], v[52:55]
    ds_read_b64_tr_b16 v[132:133], v11 offset:12288
    s_waitcnt lgkmcnt(9)
    v_mfma_f32_16x16x32_bf16 v[56:59], a[120:123], v[112:115], v[56:59]
    buffer_load_dwordx4 a[220:223], v2, s[80:83], s41 offen offset:2048 sc1
    v_mfma_f32_16x16x32_bf16 v[60:63], a[124:127], v[112:115], v[60:63]
    ds_read_b64_tr_b16 v[134:135], v11 offset:14336
    v_add_f32_dpp v88, v88, v88 row_ror:4 row_mask:0xf bank_mask:0xf
    v_mfma_f32_16x16x32_bf16 v[64:67], a[128:131], v[112:115], v[64:67]
    v_add_f32_dpp v89, v89, v89 row_ror:4 row_mask:0xf bank_mask:0xf
    v_add_f32_dpp v90, v90, v90 row_ror:4 row_mask:0xf bank_mask:0xf
    s_waitcnt lgkmcnt(8)
    v_mfma_f32_16x16x32_bf16 v[68:71], a[120:123], v[116:119], v[68:71]
    v_add_f32_dpp v91, v91, v91 row_ror:4 row_mask:0xf bank_mask:0xf
    v_add_f32_dpp v92, v92, v92 row_ror:4 row_mask:0xf bank_mask:0xf
    v_mfma_f32_16x16x32_bf16 v[72:75], a[124:127], v[116:119], v[72:75]
    buffer_load_dwordx4 a[224:227], v2, s[80:83], s41 offen offset:3072 sc1
    v_mfma_f32_16x16x32_bf16 v[76:79], a[128:131], v[116:119], v[76:79]
    v_add_f32_dpp v93, v93, v93 row_ror:4 row_mask:0xf bank_mask:0xf
    s_waitcnt lgkmcnt(6)
    v_mfma_f32_16x16x32_bf16 v[32:35], a[132:135], v[120:123], v[32:35]
    s_waitcnt vmcnt(21)
    s_barrier
    ds_read_b64_tr_b16 v[104:105], v8 offset:16384
    v_mfma_f32_16x16x32_bf16 v[36:39], a[136:139], v[120:123], v[36:39]
    ds_read_b64_tr_b16 v[106:107], v8 offset:18432
    s_add_u32 s41, s47, 12288
    v_mfma_f32_16x16x32_bf16 v[40:43], a[140:143], v[120:123], v[40:43]
    buffer_load_dwordx4 a[228:231], v2, s[80:83], s41 offen offset:0 sc1
    s_waitcnt lgkmcnt(6)
    v_mfma_f32_16x16x32_bf16 v[44:47], a[132:135], v[124:127], v[44:47]
    ds_read_b64_tr_b16 v[108:109], v9 offset:16384
    ds_read_b64_tr_b16 v[110:111], v9 offset:18432
    v_mfma_f32_16x16x32_bf16 v[48:51], a[136:139], v[124:127], v[48:51]
    ds_read_b64_tr_b16 v[112:113], v10 offset:16384
    ds_read_b64_tr_b16 v[114:115], v10 offset:18432
    v_mfma_f32_16x16x32_bf16 v[52:55], a[140:143], v[124:127], v[52:55]
    ds_read_b64_tr_b16 v[116:117], v11 offset:16384
    s_waitcnt lgkmcnt(9)
    v_mfma_f32_16x16x32_bf16 v[56:59], a[132:135], v[128:131], v[56:59]
    buffer_load_dwordx4 a[232:235], v2, s[80:83], s41 offen offset:1024 sc1
    v_mfma_f32_16x16x32_bf16 v[60:63], a[136:139], v[128:131], v[60:63]
    ds_read_b64_tr_b16 v[118:119], v11 offset:18432
    v_add_f32_dpp v94, v94, v94 row_ror:4 row_mask:0xf bank_mask:0xf
    v_mfma_f32_16x16x32_bf16 v[64:67], a[140:143], v[128:131], v[64:67]
    v_add_f32_dpp v95, v95, v95 row_ror:4 row_mask:0xf bank_mask:0xf
    v_add_f32_dpp v96, v96, v96 row_ror:4 row_mask:0xf bank_mask:0xf
    s_waitcnt lgkmcnt(8)
    v_mfma_f32_16x16x32_bf16 v[68:71], a[132:135], v[132:135], v[68:71]
    v_add_f32_dpp v97, v97, v97 row_ror:4 row_mask:0xf bank_mask:0xf
    v_add_f32_dpp v98, v98, v98 row_ror:4 row_mask:0xf bank_mask:0xf
    v_mfma_f32_16x16x32_bf16 v[72:75], a[136:139], v[132:135], v[72:75]
    buffer_load_dwordx4 a[236:239], v2, s[80:83], s41 offen offset:2048 sc1
    v_mfma_f32_16x16x32_bf16 v[76:79], a[140:143], v[132:135], v[76:79]
    v_add_f32_dpp v99, v99, v99 row_ror:4 row_mask:0xf bank_mask:0xf
    s_waitcnt lgkmcnt(6)
    v_mfma_f32_16x16x32_bf16 v[32:35], a[144:147], v[104:107], v[32:35]
    ds_read_b64_tr_b16 v[120:121], v8 offset:20480
    ds_read_b64_tr_b16 v[122:123], v8 offset:22528
    v_mfma_f32_16x16x32_bf16 v[36:39], a[148:151], v[104:107], v[36:39]
    ds_read_b64_tr_b16 v[124:125], v9 offset:20480
    s_add_u32 s42, s54, 0
    v_mfma_f32_16x16x32_bf16 v[40:43], a[152:155], v[104:107], v[40:43]
    buffer_load_dwordx4 v[148:151], v2, s[80:83], s42 offen offset:0 sc1
    s_waitcnt lgkmcnt(7)
    v_mfma_f32_16x16x32_bf16 v[44:47], a[144:147], v[108:111], v[44:47]
    ds_read_b64_tr_b16 v[126:127], v9 offset:22528
    ds_read_b64_tr_b16 v[128:129], v10 offset:20480
    v_mfma_f32_16x16x32_bf16 v[48:51], a[148:151], v[108:111], v[48:51]
    ds_read_b64_tr_b16 v[130:131], v10 offset:22528
    v_mfma_f32_16x16x32_bf16 v[52:55], a[152:155], v[108:111], v[52:55]
    ds_read_b64_tr_b16 v[132:133], v11 offset:20480
    ds_read_b64_tr_b16 v[134:135], v11 offset:22528
    s_waitcnt lgkmcnt(10)
    v_mfma_f32_16x16x32_bf16 v[56:59], a[144:147], v[112:115], v[56:59]
    buffer_load_dwordx4 v[152:155], v2, s[80:83], s42 offen offset:1024 sc1
    v_mfma_f32_16x16x32_bf16 v[60:63], a[148:151], v[112:115], v[60:63]
    v_add_f32_dpp v88, v88, v88 row_ror:2 row_mask:0xf bank_mask:0xf
    v_add_f32_dpp v89, v89, v89 row_ror:2 row_mask:0xf bank_mask:0xf
    v_mfma_f32_16x16x32_bf16 v[64:67], a[152:155], v[112:115], v[64:67]
    v_add_f32_dpp v90, v90, v90 row_ror:2 row_mask:0xf bank_mask:0xf
    s_waitcnt lgkmcnt(8)
    v_mfma_f32_16x16x32_bf16 v[68:71], a[144:147], v[116:119], v[68:71]
    v_add_f32_dpp v91, v91, v91 row_ror:2 row_mask:0xf bank_mask:0xf
    v_add_f32_dpp v92, v92, v92 row_ror:2 row_mask:0xf bank_mask:0xf
    v_mfma_f32_16x16x32_bf16 v[72:75], a[148:151], v[116:119], v[72:75]
    buffer_load_dwordx4 v[156:159], v2, s[80:83], s42 offen offset:2048 sc1
    v_mfma_f32_16x16x32_bf16 v[76:79], a[152:155], v[116:119], v[76:79]
    v_add_f32_dpp v93, v93, v93 row_ror:2 row_mask:0xf bank_mask:0xf
    s_waitcnt lgkmcnt(6)
    v_mfma_f32_16x16x32_bf16 v[32:35], a[156:159], v[120:123], v[32:35]
    buffer_load_dwordx4 v[80:83], v13, s[80:83], s94 offen sc1
    v_mfma_f32_16x16x32_bf16 v[36:39], a[160:163], v[120:123], v[36:39]
    ds_read_b64_tr_b16 v[104:105], v8 offset:24576
    ds_read_b64_tr_b16 v[106:107], v8 offset:26624
    v_mfma_f32_16x16x32_bf16 v[40:43], a[164:167], v[120:123], v[40:43]
    buffer_load_dwordx4 v[160:163], v2, s[80:83], s42 offen offset:3072 sc1
    s_waitcnt lgkmcnt(6)
    v_mfma_f32_16x16x32_bf16 v[44:47], a[156:159], v[124:127], v[44:47]
    ds_read_b64_tr_b16 v[108:109], v9 offset:24576
    ds_read_b64_tr_b16 v[110:111], v9 offset:26624
    v_mfma_f32_16x16x32_bf16 v[48:51], a[160:163], v[124:127], v[48:51]
    ds_read_b64_tr_b16 v[112:113], v10 offset:24576
    ds_read_b64_tr_b16 v[114:115], v10 offset:26624
    v_mfma_f32_16x16x32_bf16 v[52:55], a[164:167], v[124:127], v[52:55]
    ds_read_b64_tr_b16 v[116:117], v11 offset:24576
    s_add_u32 s42, s54, 4096
    s_waitcnt lgkmcnt(9)
    v_mfma_f32_16x16x32_bf16 v[56:59], a[156:159], v[128:131], v[56:59]
    buffer_load_dwordx4 v[164:167], v2, s[80:83], s42 offen offset:0 sc1
    v_mfma_f32_16x16x32_bf16 v[60:63], a[160:163], v[128:131], v[60:63]
    ds_read_b64_tr_b16 v[118:119], v11 offset:26624
    v_add_f32_dpp v94, v94, v94 row_ror:2 row_mask:0xf bank_mask:0xf
    v_mfma_f32_16x16x32_bf16 v[64:67], a[164:167], v[128:131], v[64:67]
    v_add_f32_dpp v95, v95, v95 row_ror:2 row_mask:0xf bank_mask:0xf
    v_add_f32_dpp v96, v96, v96 row_ror:2 row_mask:0xf bank_mask:0xf
    s_waitcnt lgkmcnt(8)
    v_mfma_f32_16x16x32_bf16 v[68:71], a[156:159], v[132:135], v[68:71]
    v_add_f32_dpp v97, v97, v97 row_ror:2 row_mask:0xf bank_mask:0xf
    v_add_f32_dpp v98, v98, v98 row_ror:2 row_mask:0xf bank_mask:0xf
    v_mfma_f32_16x16x32_bf16 v[72:75], a[160:163], v[132:135], v[72:75]
    buffer_load_dwordx4 v[168:171], v2, s[80:83], s42 offen offset:1024 sc1
    v_mfma_f32_16x16x32_bf16 v[76:79], a[164:167], v[132:135], v[76:79]
    v_add_f32_dpp v99, v99, v99 row_ror:2 row_mask:0xf bank_mask:0xf
    s_waitcnt vmcnt(30) lgkmcnt(6)
    v_mfma_f32_16x16x32_bf16 v[32:35], a[168:171], v[104:107], v[32:35]
    s_waitcnt vmcnt(13)
    v_cmp_eq_u64 vcc, s[92:93], v[252:253]
    v_cmp_eq_u64 s[30:31], s[92:93], v[254:255]
    s_nop 0
    s_and_b64 vcc, vcc, s[30:31]
    s_cmp_eq_u64 vcc, -1
    s_cbranch_scc1 L_ok_24
    s_mov_b32 s11, 0x20000
L_poll_25:
    buffer_load_dwordx4 v[252:255], v5, s[80:83], s27 offen sc1
    s_waitcnt vmcnt(0)
    v_cmp_eq_u64 vcc, s[92:93], v[252:253]
    v_cmp_eq_u64 s[30:31], s[92:93], v[254:255]
    s_nop 0
    s_and_b64 vcc, vcc, s[30:31]
    s_cmp_eq_u64 vcc, -1
    s_cbranch_scc1 L_polld_26
    s_sub_u32 s11, s11, 1
    s_cbranch_scc0 L_poll_25
L_polld_26:
L_ok_24:
    v_mfma_f32_16x16x32_bf16 v[36:39], a[172:175], v[104:107], v[36:39]
    s_add_u32 s24, s49, 1312768
    s_add_u32 m0, s25, 49152
    v_mfma_f32_16x16x32_bf16 v[40:43], a[176:179], v[104:107], v[40:43]
    buffer_load_dwordx4 v2, s[80:83], s24 offen offset:0 sc1 lds
    s_waitcnt lgkmcnt(4)
    v_mfma_f32_16x16x32_bf16 v[44:47], a[168:171], v[108:111], v[44:47]
    ds_read_b64_tr_b16 v[120:121], v8 offset:28672
    ds_read_b64_tr_b16 v[122:123], v8 offset:30720
    v_mfma_f32_16x16x32_bf16 v[48:51], a[172:175], v[108:111], v[48:51]
    ds_read_b64_tr_b16 v[124:125], v9 offset:28672
    ds_read_b64_tr_b16 v[126:127], v9 offset:30720
    v_mfma_f32_16x16x32_bf16 v[52:55], a[176:179], v[108:111], v[52:55]
    ds_read_b64_tr_b16 v[128:129], v10 offset:28672
    ds_read_b64_tr_b16 v[130:131], v10 offset:30720
    s_waitcnt lgkmcnt(8)
    v_mfma_f32_16x16x32_bf16 v[56:59], a[168:171], v[112:115], v[56:59]
    buffer_load_dwordx4 v2, s[80:83], s24 offen offset:1024 sc1 lds
    v_mfma_f32_16x16x32_bf16 v[60:63], a[172:175], v[112:115], v[60:63]
    ds_read_b64_tr_b16 v[132:133], v11 offset:28672
    ds_read_b64_tr_b16 v[134:135], v11 offset:30720
    v_mfma_f32_16x16x32_bf16 v[64:67], a[176:179], v[112:115], v[64:67]
    v_add_f32_dpp v88, v88, v88 row_ror:1 row_mask:0xf bank_mask:0xf
    v_add_f32_dpp v89, v89, v89 row_ror:1 row_mask:0xf bank_mask:0xf
    s_waitcnt lgkmcnt(8)
    v_mfma_f32_16x16x32_bf16 v[68:71], a[168:171], v[116:119], v[68:71]
    v_add_f32_dpp v90, v90, v90 row_ror:1 row_mask:0xf bank_mask:0xf
    v_add_f32_dpp v91, v91, v91 row_ror:1 row_mask:0xf bank_mask:0xf
    v_mfma_f32_16x16x32_bf16 v[72:75], a[172:175], v[116:119], v[72:75]
    buffer_load_dwordx4 v2, s[80:83], s24 offen offset:2048 sc1 lds
    v_mfma_f32_16x16x32_bf16 v[76:79], a[176:179], v[116:119], v[76:79]
    v_add_f32_dpp v92, v92, v92 row_ror:1 row_mask:0xf bank_mask:0xf
    v_add_f32_dpp v93, v93, v93 row_ror:1 row_mask:0xf bank_mask:0xf
    s_add_u32 s12, s84, 131072
    s_sub_u32 s14, s12, 163840
    s_min_u32 s12, s12, s14
    s_add_u32 s13, s85, 131072
    s_sub_u32 s14, s13, 163840
    s_min_u32 s13, s13, s14
    v_add_u32 v14, s12, v17
    v_xor_b32 v15, 32, v14
    s_and_b32 s14, s3, 1
    s_lshl_b32 s14, s14, 5
    v_xor_b32 v16, s14, v17
    v_add_u32 v16, s13, v16
    s_waitcnt lgkmcnt(6)
    v_mfma_f32_16x16x32_bf16 v[32:35], a[180:183], v[120:123], v[32:35]
    s_barrier
    ds_read_b64_tr_b16 v[104:105], v8 offset:32768
    v_mfma_f32_16x16x32_bf16 v[36:39], a[184:187], v[120:123], v[36:39]
    ds_read_b64_tr_b16 v[106:107], v8 offset:34816
    ds_read_b64_tr_b16 v[108:109], v9 offset:32768
    v_mfma_f32_16x16x32_bf16 v[40:43], a[188:191], v[120:123], v[40:43]
    buffer_load_dwordx4 v2, s[80:83], s24 offen offset:3072 sc1 lds
    s_waitcnt lgkmcnt(7)
    v_mfma_f32_16x16x32_bf16 v[44:47], a[180:183], v[124:127], v[44:47]
    ds_read_b64_tr_b16 v[110:111], v9 offset:34816
    ds_read_b64_tr_b16 v[112:113], v10 offset:32768
    v_mfma_f32_16x16x32_bf16 v[48:51], a[184:187], v[124:127], v[48:51]
    ds_read_b64_tr_b16 v[114:115], v10 offset:34816
    ds_read_b64_tr_b16 v[116:117], v11 offset:32768
    v_mfma_f32_16x16x32_bf16 v[52:55], a[188:191], v[124:127], v[52:55]
    s_add_u32 s24, s50, 1312768
    s_add_u32 m0, s25, 65536
    s_waitcnt lgkmcnt(9)
    v_mfma_f32_16x16x32_bf16 v[56:59], a[180:183], v[128:131], v[56:59]
    buffer_load_dwordx4 v2, s[80:83], s24 offen offset:0 sc1 lds
    v_mfma_f32_16x16x32_bf16 v[60:63], a[184:187], v[128:131], v[60:63]
    ds_read_b64_tr_b16 v[118:119], v11 offset:34816
    v_add_f32_dpp v94, v94, v94 row_ror:1 row_mask:0xf bank_mask:0xf
    v_mfma_f32_16x16x32_bf16 v[64:67], a[188:191], v[128:131], v[64:67]
    v_add_f32_dpp v95, v95, v95 row_ror:1 row_mask:0xf bank_mask:0xf
    v_add_f32_dpp v96, v96, v96 row_ror:1 row_mask:0xf bank_mask:0xf
    s_waitcnt lgkmcnt(8)
    v_mfma_f32_16x16x32_bf16 v[68:71], a[180:183], v[132:135], v[68:71]
    v_add_f32_dpp v97, v97, v97 row_ror:1 row_mask:0xf bank_mask:0xf
    v_add_f32_dpp v98, v98, v98 row_ror:1 row_mask:0xf bank_mask:0xf
    v_mfma_f32_16x16x32_bf16 v[72:75], a[184:187], v[132:135], v[72:75]
    buffer_load_dwordx4 v2, s[80:83], s24 offen offset:1024 sc1 lds
    v_mfma_f32_16x16x32_bf16 v[76:79], a[188:191], v[132:135], v[76:79]
    v_add_f32_dpp v99, v99, v99 row_ror:1 row_mask:0xf bank_mask:0xf
    s_waitcnt lgkmcnt(6)
    v_mfma_f32_16x16x32_bf16 v[32:35], a[192:195], v[104:107], v[32:35]
    ds_read_b64_tr_b16 v[120:121], v8 offset:36864
    ds_read_b64_tr_b16 v[122:123], v8 offset:38912
    v_mfma_f32_16x16x32_bf16 v[36:39], a[196:199], v[104:107], v[36:39]
    ds_read_b64_tr_b16 v[124:125], v9 offset:36864
    v_mfma_f32_16x16x32_bf16 v[40:43], a[200:203], v[104:107], v[40:43]
    buffer_load_dwordx4 v2, s[80:83], s24 offen offset:2048 sc1 lds
    s_waitcnt lgkmcnt(7)
    v_mfma_f32_16x16x32_bf16 v[44:47], a[192:195], v[108:111], v[44:47]
    ds_read_b64_tr_b16 v[126:127], v9 offset:38912
    ds_read_b64_tr_b16 v[128:129], v10 offset:36864
    v_mfma_f32_16x16x32_bf16 v[48:51], a[196:199], v[108:111], v[48:51]
    ds_read_b64_tr_b16 v[130:131], v10 offset:38912
    v_mfma_f32_16x16x32_bf16 v[52:55], a[200:203], v[108:111], v[52:55]
    ds_read_b64_tr_b16 v[132:133], v11 offset:36864
    s_waitcnt lgkmcnt(9)
    v_mfma_f32_16x16x32_bf16 v[56:59], a[192:195], v[112:115], v[56:59]
    buffer_load_dwordx4 v2, s[80:83], s24 offen offset:3072 sc1 lds
    v_mfma_f32_16x16x32_bf16 v[60:63], a[196:199], v[112:115], v[60:63]
    ds_read_b64_tr_b16 v[134:135], v11 offset:38912
    ds_read_b64_tr_b16 v[136:137], v14
    v_mfma_f32_16x16x32_bf16 v[64:67], a[200:203], v[112:115], v[64:67]
    ds_read_b64_tr_b16 v[138:139], v15
    s_waitcnt lgkmcnt(10)
    v_mfma_f32_16x16x32_bf16 v[68:71], a[192:195], v[116:119], v[68:71]
    s_add_u32 s24, s51, 1312768
    s_add_u32 m0, s25, 81920
    v_mfma_f32_16x16x32_bf16 v[72:75], a[196:199], v[116:119], v[72:75]
    buffer_load_dwordx4 v2, s[80:83], s24 offen offset:0 sc1 lds
    v_mfma_f32_16x16x32_bf16 v[76:79], a[200:203], v[116:119], v[76:79]
    ds_read_b64_tr_b16 v[140:141], v16
    s_waitcnt lgkmcnt(9)
    v_mfma_f32_16x16x32_bf16 v[32:35], a[204:207], v[120:123], v[32:35]
    s_waitcnt vmcnt(12)
    v_cmp_eq_u32 vcc, s92, v81
    v_cmp_eq_u32 s[30:31], s92, v83
    s_nop 0
    s_and_b64 vcc, vcc, s[30:31]
    s_cmp_eq_u64 vcc, -1
    s_cbranch_scc1 L_gok_27
    s_mov_b32 s11, 0x20000
L_gl_28:
    buffer_load_dwordx4 v[80:83], v13, s[80:83], s94 offen sc1
    s_waitcnt vmcnt(0)
    v_cmp_eq_u32 vcc, s92, v81
    v_cmp_eq_u32 s[30:31], s92, v83
    s_nop 0
    s_and_b64 vcc, vcc, s[30:31]
    s_cmp_eq_u64 vcc, -1
    s_cbranch_scc1 L_gok_27
    s_sub_u32 s11, s11, 1
    s_cbranch_scc0 L_gl_28
L_gok_27:
    v_mfma_f32_16x16x32_bf16 v[36:39], a[208:211], v[120:123], v[36:39]
    ds_read_b64_tr_b16 v[104:105], v8 offset:40960
    ds_read_b64_tr_b16 v[106:107], v8 offset:43008
    v_mfma_f32_16x16x32_bf16 v[40:43], a[212:215], v[120:123], v[40:43]
    buffer_load_dwordx4 v2, s[80:83], s24 offen offset:1024 sc1 lds
    s_waitcnt lgkmcnt(9)
    v_mfma_f32_16x16x32_bf16 v[44:47], a[204:207], v[124:127], v[44:47]
    ds_read_b64_tr_b16 v[108:109], v9 offset:40960
    ds_read_b64_tr_b16 v[110:111], v9 offset:43008
    v_mfma_f32_16x16x32_bf16 v[48:51], a[208:211], v[124:127], v[48:51]
    ds_read_b64_tr_b16 v[112:113], v10 offset:40960
    ds_read_b64_tr_b16 v[114:115], v10 offset:43008
    v_mfma_f32_16x16x32_bf16 v[52:55], a[212:215], v[124:127], v[52:55]
    ds_read_b64_tr_b16 v[116:117], v11 offset:40960
    ds_read_b64_tr_b16 v[118:119], v11 offset:43008
    s_waitcnt lgkmcnt(13)
    v_mfma_f32_16x16x32_bf16 v[56:59], a[204:207], v[128:131], v[56:59]
    buffer_load_dwordx4 v2, s[80:83], s24 offen offset:2048 sc1 lds
    v_mfma_f32_16x16x32_bf16 v[60:63], a[208:211], v[128:131], v[60:63]
    v_permlane32_swap_b32 v80, v82
    v_add_f32 v80, v80, v82
    v_mfma_f32_16x16x32_bf16 v[64:67], a[212:215], v[128:131], v[64:67]
    v_mov_b32 v81, v80
    s_add_u32 s94, s94, 262144
    s_waitcnt lgkmcnt(11)
    v_mfma_f32_16x16x32_bf16 v[68:71], a[204:207], v[132:135], v[68:71]
    v_permlane16_swap_b32 v80, v81
    v_add_f32 v80, v80, v81
    v_mfma_f32_16x16x32_bf16 v[72:75], a[208:211], v[132:135], v[72:75]
    buffer_load_dwordx4 v2, s[80:83], s24 offen offset:3072 sc1 lds
    v_mfma_f32_16x16x32_bf16 v[76:79], a[212:215], v[132:135], v[76:79]
    v_mov_b32 v81, v80
    s_nop 0
    s_nop 0
    v_permlane32_swap_b32 v80, v81
    s_waitcnt lgkmcnt(6)
    v_mfma_f32_16x16x32_bf16 v[32:35], a[216:219], v[104:107], v[32:35]
    ds_read_b64_tr_b16 v[120:121], v8 offset:45056
    ds_read_b64_tr_b16 v[122:123], v8 offset:47104
    v_mfma_f32_16x16x32_bf16 v[36:39], a[220:223], v[104:107], v[36:39]
    s_add_u32 s24, s52, 1312768
    s_add_u32 m0, s25, 98304
    v_mfma_f32_16x16x32_bf16 v[40:43], a[224:227], v[104:107], v[40:43]
    buffer_load_dwordx4 v2, s[80:83], s24 offen offset:0 sc1 lds
    s_waitcnt lgkmcnt(6)
    v_mfma_f32_16x16x32_bf16 v[44:47], a[216:219], v[108:111], v[44:47]
    ds_read_b64_tr_b16 v[124:125], v9 offset:45056
    ds_read_b64_tr_b16 v[126:127], v9 offset:47104
    v_mfma_f32_16x16x32_bf16 v[48:51], a[220:223], v[108:111], v[48:51]
    ds_read_b64_tr_b16 v[128:129], v10 offset:45056
    ds_read_b64_tr_b16 v[130:131], v10 offset:47104
    v_mfma_f32_16x16x32_bf16 v[52:55], a[224:227], v[108:111], v[52:55]
    ds_read_b64_tr_b16 v[132:133], v11 offset:45056
    ds_read_b64_tr_b16 v[134:135], v11 offset:47104
    s_waitcnt lgkmcnt(10)
    v_mfma_f32_16x16x32_bf16 v[56:59], a[216:219], v[112:115], v[56:59]
    buffer_load_dwordx4 v2, s[80:83], s24 offen offset:1024 sc1 lds
    v_mfma_f32_16x16x32_bf16 v[60:63], a[220:223], v[112:115], v[60:63]
    v_mul_f32 v84, 0xbacccccd, v80
    v_mul_f32 v81, 0x3acccccd, v81
    v_mfma_f32_16x16x32_bf16 v[64:67], a[224:227], v[112:115], v[64:67]
    v_fma_f32 v81, -v84, v84, v81
    v_max_f32 v81, 0, v81
    s_waitcnt lgkmcnt(8)
    v_mfma_f32_16x16x32_bf16 v[68:71], a[216:219], v[116:119], v[68:71]
    v_add_f32 v86, 0x3727c5ac, v81
    v_rsq_f32 v85, v86
    v_mfma_f32_16x16x32_bf16 v[72:75], a[220:223], v[116:119], v[72:75]
    buffer_load_dwordx4 v2, s[80:83], s24 offen offset:2048 sc1 lds
    v_mfma_f32_16x16x32_bf16 v[76:79], a[224:227], v[116:119], v[76:79]
    v_mov_b32 v87, 0
    v_mul_f32 v85, 0xbfb8aa3b, v85
    s_mov_b64 exec, 0xffff
    ds_write_b128 v19, v[84:87]
    s_mov_b64 exec, -1
    s_waitcnt lgkmcnt(7)
    v_mfma_f32_16x16x32_bf16 v[32:35], a[228:231], v[120:123], v[32:35]
    s_waitcnt vmcnt(11)
    s_waitcnt lgkmcnt(0)
    s_barrier
    ds_read_b128 v[104:107], v19
    v_mfma_f32_16x16x32_bf16 v[44:47], a[228:231], v[124:127], v[44:47]
    ds_read_b128 v[108:111], v20
    ds_read_b128 v[112:115], v21
    v_mfma_f32_16x16x32_bf16 v[56:59], a[228:231], v[128:131], v[56:59]
    buffer_load_dwordx4 v2, s[80:83], s24 offen offset:3072 sc1 lds
    v_mfma_f32_16x16x32_bf16 v[68:71], a[228:231], v[132:135], v[68:71]
    ds_read_b128 v[116:119], v22
    v_mfma_f32_16x16x32_bf16 v[36:39], a[232:235], v[120:123], v[36:39]
    v_add_u32 v8, 49152, v8
    v_add_u32 v9, 49152, v9
    v_mfma_f32_16x16x32_bf16 v[48:51], a[232:235], v[124:127], v[48:51]
    s_add_u32 s24, s53, 1312768
    s_add_u32 m0, s25, 114688
    v_mfma_f32_16x16x32_bf16 v[60:63], a[232:235], v[128:131], v[60:63]
    buffer_load_dwordx4 v2, s[80:83], s24 offen offset:0 sc1 lds
    v_mfma_f32_16x16x32_bf16 v[72:75], a[232:235], v[132:135], v[72:75]
    v_add_u32 v10, 49152, v10
    v_add_u32 v11, 49152, v11
    v_mfma_f32_16x16x32_bf16 v[40:43], a[236:239], v[120:123], v[40:43]
    v_add_u32 v19, -81920, v19
    v_mfma_f32_16x16x32_bf16 v[52:55], a[236:239], v[124:127], v[52:55]
    v_add_u32 v20, -81920, v20
    v_add_u32 v21, -81920, v21
    v_mfma_f32_16x16x32_bf16 v[64:67], a[236:239], v[128:131], v[64:67]
    buffer_load_dwordx4 v2, s[80:83], s24 offen offset:1024 sc1 lds
    v_mfma_f32_16x16x32_bf16 v[76:79], a[236:239], v[132:135], v[76:79]
    v_add_u32 v22, -81920, v22
    s_waitcnt lgkmcnt(3)
    v_pk_fma_f32 v[32:33], v[88:89], v[104:105], v[32:33] op_sel_hi:[1,0,1]
    v_pk_mul_f32 v[120:121], v[32:33], v[104:105] op_sel:[0,1] op_sel_hi:[1,1]
    s_waitcnt lgkmcnt(2)
    v_pk_fma_f32 v[44:45], v[88:89], v[108:109], v[44:45] op_sel_hi:[1,0,1]
    v_pk_mul_f32 v[122:123], v[44:45], v[108:109] op_sel:[0,1] op_sel_hi:[1,1]
    s_waitcnt lgkmcnt(1)
    v_pk_fma_f32 v[56:57], v[88:89], v[112:113], v[56:57] op_sel_hi:[1,0,1]
    v_pk_mul_f32 v[124:125], v[56:57], v[112:113] op_sel:[0,1] op_sel_hi:[1,1]
    s_waitcnt lgkmcnt(0)
    v_pk_fma_f32 v[68:69], v[88:89], v[116:117], v[68:69] op_sel_hi:[1,0,1]
    v_pk_mul_f32 v[126:127], v[68:69], v[116:117] op_sel:[0,1] op_sel_hi:[1,1]
    v_exp_f32 v120, v120
    v_pk_fma_f32 v[34:35], v[90:91], v[104:105], v[34:35] op_sel_hi:[1,0,1]
    v_exp_f32 v121, v121
    buffer_load_dwordx4 v2, s[80:83], s24 offen offset:2048 sc1 lds
    v_pk_mul_f32 v[32:33], v[32:33], v[34:35]
    v_exp_f32 v122, v122
    v_pk_fma_f32 v[46:47], v[90:91], v[108:109], v[46:47] op_sel_hi:[1,0,1]
    v_exp_f32 v123, v123
    v_pk_mul_f32 v[44:45], v[44:45], v[46:47]
    v_exp_f32 v124, v124
    v_pk_fma_f32 v[58:59], v[90:91], v[112:113], v[58:59] op_sel_hi:[1,0,1]
    v_exp_f32 v125, v125
    v_pk_mul_f32 v[56:57], v[56:57], v[58:59]
    v_exp_f32 v126, v126
    v_pk_fma_f32 v[70:71], v[90:91], v[116:117], v[70:71] op_sel_hi:[1,0,1]
    v_exp_f32 v127, v127
    v_pk_mul_f32 v[68:69], v[68:69], v[70:71]
    v_pk_fma_f32 v[120:121], v[120:121], v[106:107], v[106:107] op_sel_hi:[1,0,0]
    buffer_load_dwordx4 v2, s[80:83], s24 offen offset:3072 sc1 lds
    v_pk_fma_f32 v[122:123], v[122:123], v[110:111], v[110:111] op_sel_hi:[1,0,0]
    v_pk_fma_f32 v[124:125], v[124:125], v[114:115], v[114:115] op_sel_hi:[1,0,0]
    v_pk_fma_f32 v[126:127], v[126:127], v[118:119], v[118:119] op_sel_hi:[1,0,0]
    v_rcp_f32 v120, v120
    v_rcp_f32 v121, v121
    v_rcp_f32 v122, v122
    v_pk_mul_f32 v[32:33], v[32:33], v[120:121]
    v_rcp_f32 v123, v123
    v_cvt_pk_bf16_f32 v80, v32, v33
    v_rcp_f32 v124, v124
    v_pk_mul_f32 v[44:45], v[44:45], v[122:123]
    v_rcp_f32 v125, v125
    v_cvt_pk_bf16_f32 v81, v44, v45
    v_rcp_f32 v126, v126
    v_pk_mul_f32 v[56:57], v[56:57], v[124:125]
    buffer_load_dwordx4 v[172:175], v2, s[80:83], s42 offen offset:2048 sc1
    v_rcp_f32 v127, v127
    v_cvt_pk_bf16_f32 v82, v56, v57
    v_pk_mul_f32 v[68:69], v[68:69], v[126:127]
    v_cvt_pk_bf16_f32 v83, v68, v69
    v_permlane32_swap_b32 v80, v82
    s_nop 0
    v_permlane32_swap_b32 v81, v83
    s_nop 1
    v_permlane16_swap_b32 v80, v81
    v_permlane16_swap_b32 v82, v83
    buffer_store_dwordx4 v[80:83], v23, s[80:83], s22 offen offset:0 sc1
    v_pk_fma_f32 v[36:37], v[92:93], v[104:105], v[36:37] op_sel_hi:[1,0,1]
    v_pk_mul_f32 v[120:121], v[36:37], v[104:105] op_sel:[0,1] op_sel_hi:[1,1]
    v_pk_fma_f32 v[48:49], v[92:93], v[108:109], v[48:49] op_sel_hi:[1,0,1]
    v_pk_mul_f32 v[122:123], v[48:49], v[108:109] op_sel:[0,1] op_sel_hi:[1,1]
    v_pk_fma_f32 v[60:61], v[92:93], v[112:113], v[60:61] op_sel_hi:[1,0,1]
    v_pk_mul_f32 v[124:125], v[60:61], v[112:113] op_sel:[0,1] op_sel_hi:[1,1]
    v_pk_fma_f32 v[72:73], v[92:93], v[116:117], v[72:73] op_sel_hi:[1,0,1]
    v_pk_mul_f32 v[126:127], v[72:73], v[116:117] op_sel:[0,1] op_sel_hi:[1,1]
    v_exp_f32 v120, v120
    v_pk_fma_f32 v[38:39], v[94:95], v[104:105], v[38:39] op_sel_hi:[1,0,1]
    v_exp_f32 v121, v121
    buffer_load_dwordx4 v[176:179], v2, s[80:83], s42 offen offset:3072 sc1
    v_pk_mul_f32 v[36:37], v[36:37], v[38:39]
    v_exp_f32 v122, v122
    v_pk_fma_f32 v[50:51], v[94:95], v[108:109], v[50:51] op_sel_hi:[1,0,1]
    v_exp_f32 v123, v123
    v_pk_mul_f32 v[48:49], v[48:49], v[50:51]
    v_exp_f32 v124, v124
    v_pk_fma_f32 v[62:63], v[94:95], v[112:113], v[62:63] op_sel_hi:[1,0,1]
    v_exp_f32 v125, v125
    v_pk_mul_f32 v[60:61], v[60:61], v[62:63]
    v_exp_f32 v126, v126
    v_pk_fma_f32 v[74:75], v[94:95], v[116:117], v[74:75] op_sel_hi:[1,0,1]
    v_exp_f32 v127, v127
    v_pk_mul_f32 v[72:73], v[72:73], v[74:75]
    s_add_u32 s42, s54, 8192
    v_pk_fma_f32 v[120:121], v[120:121], v[106:107], v[106:107] op_sel_hi:[1,0,0]
    buffer_load_dwordx4 v[180:183], v2, s[80:83], s42 offen offset:0 sc1
    v_pk_fma_f32 v[122:123], v[122:123], v[110:111], v[110:111] op_sel_hi:[1,0,0]
    v_pk_fma_f32 v[124:125], v[124:125], v[114:115], v[114:115] op_sel_hi:[1,0,0]
    v_pk_fma_f32 v[126:127], v[126:127], v[118:119], v[118:119] op_sel_hi:[1,0,0]
    v_rcp_f32 v120, v120
    v_rcp_f32 v121, v121
    v_rcp_f32 v122, v122
    v_pk_mul_f32 v[36:37], v[36:37], v[120:121]
    v_rcp_f32 v123, v123
    v_cvt_pk_bf16_f32 v84, v36, v37
    v_rcp_f32 v124, v124
    v_pk_mul_f32 v[48:49], v[48:49], v[122:123]
    v_rcp_f32 v125, v125
    v_cvt_pk_bf16_f32 v85, v48, v49
    v_rcp_f32 v126, v126
    v_pk_mul_f32 v[60:61], v[60:61], v[124:125]
    buffer_load_dwordx4 v[184:187], v2, s[80:83], s42 offen offset:1024 sc1
    v_rcp_f32 v127, v127
    v_cvt_pk_bf16_f32 v86, v60, v61
    v_pk_mul_f32 v[72:73], v[72:73], v[126:127]
    v_cvt_pk_bf16_f32 v87, v72, v73
    v_permlane32_swap_b32 v84, v86
    s_nop 0
    v_permlane32_swap_b32 v85, v87
    s_nop 1
    v_permlane16_swap_b32 v84, v85
    v_permlane16_swap_b32 v86, v87
    buffer_store_dwordx4 v[84:87], v23, s[80:83], s22 offen offset:256 sc1
    v_pk_fma_f32 v[40:41], v[96:97], v[104:105], v[40:41] op_sel_hi:[1,0,1]
    v_pk_mul_f32 v[120:121], v[40:41], v[104:105] op_sel:[0,1] op_sel_hi:[1,1]
    v_pk_fma_f32 v[52:53], v[96:97], v[108:109], v[52:53] op_sel_hi:[1,0,1]
    v_pk_mul_f32 v[122:123], v[52:53], v[108:109] op_sel:[0,1] op_sel_hi:[1,1]
    v_pk_fma_f32 v[64:65], v[96:97], v[112:113], v[64:65] op_sel_hi:[1,0,1]
    v_pk_mul_f32 v[124:125], v[64:65], v[112:113] op_sel:[0,1] op_sel_hi:[1,1]
    v_pk_fma_f32 v[76:77], v[96:97], v[116:117], v[76:77] op_sel_hi:[1,0,1]
    v_pk_mul_f32 v[126:127], v[76:77], v[116:117] op_sel:[0,1] op_sel_hi:[1,1]
    v_exp_f32 v120, v120
    v_pk_fma_f32 v[42:43], v[98:99], v[104:105], v[42:43] op_sel_hi:[1,0,1]
    v_exp_f32 v121, v121
    buffer_load_dwordx4 v[188:191], v2, s[80:83], s42 offen offset:2048 sc1
    v_pk_mul_f32 v[40:41], v[40:41], v[42:43]
    v_exp_f32 v122, v122
    v_pk_fma_f32 v[54:55], v[98:99], v[108:109], v[54:55] op_sel_hi:[1,0,1]
    v_exp_f32 v123, v123
    v_pk_mul_f32 v[52:53], v[52:53], v[54:55]
    v_exp_f32 v124, v124
    v_pk_fma_f32 v[66:67], v[98:99], v[112:113], v[66:67] op_sel_hi:[1,0,1]
    v_exp_f32 v125, v125
    v_pk_mul_f32 v[64:65], v[64:65], v[66:67]
    v_exp_f32 v126, v126
    v_pk_fma_f32 v[78:79], v[98:99], v[116:117], v[78:79] op_sel_hi:[1,0,1]
    v_exp_f32 v127, v127
    v_pk_mul_f32 v[76:77], v[76:77], v[78:79]
    v_pk_fma_f32 v[120:121], v[120:121], v[106:107], v[106:107] op_sel_hi:[1,0,0]
    buffer_load_dwordx4 v[192:195], v2, s[80:83], s42 offen offset:3072 sc1
    v_pk_fma_f32 v[122:123], v[122:123], v[110:111], v[110:111] op_sel_hi:[1,0,0]
    v_pk_fma_f32 v[124:125], v[124:125], v[114:115], v[114:115] op_sel_hi:[1,0,0]
    v_pk_fma_f32 v[126:127], v[126:127], v[118:119], v[118:119] op_sel_hi:[1,0,0]
    v_rcp_f32 v120, v120
    v_rcp_f32 v121, v121
    v_rcp_f32 v122, v122
    v_pk_mul_f32 v[40:41], v[40:41], v[120:121]
    v_rcp_f32 v123, v123
    v_cvt_pk_bf16_f32 v80, v40, v41
    v_rcp_f32 v124, v124
    v_pk_mul_f32 v[52:53], v[52:53], v[122:123]
    v_rcp_f32 v125, v125
    v_cvt_pk_bf16_f32 v81, v52, v53
    v_rcp_f32 v126, v126
    s_add_u32 s42, s54, 12288
    v_pk_mul_f32 v[64:65], v[64:65], v[124:125]
    buffer_load_dwordx4 v[196:199], v2, s[80:83], s42 offen offset:0 sc1
    v_rcp_f32 v127, v127
    v_cvt_pk_bf16_f32 v82, v64, v65
    v_pk_mul_f32 v[76:77], v[76:77], v[126:127]
    v_cvt_pk_bf16_f32 v83, v76, v77
    v_permlane32_swap_b32 v80, v82
    ds_read_b64_tr_b16 v[104:105], v8 offset:0
    ds_read_b64_tr_b16 v[106:107], v8 offset:2048
    ds_read_b64_tr_b16 v[108:109], v9 offset:0
    ds_read_b64_tr_b16 v[110:111], v9 offset:2048
    ds_read_b64_tr_b16 v[112:113], v10 offset:0
    ds_read_b64_tr_b16 v[114:115], v10 offset:2048
    ds_read_b64_tr_b16 v[116:117], v11 offset:0
    ds_read_b64_tr_b16 v[118:119], v11 offset:2048
    v_permlane32_swap_b32 v81, v83
    s_nop 1
    v_permlane16_swap_b32 v80, v81
    v_permlane16_swap_b32 v82, v83
    buffer_store_dwordx4 v[80:83], v23, s[80:83], s22 offen offset:512 sc1
    s_add_u32 s22, s22, 3162112
    s_nop 1
    s_waitcnt lgkmcnt(6)
    v_mfma_f32_16x16x32_bf16 v[80:83], v[104:107], v[104:107], 0
    ds_read_b64_tr_b16 v[120:121], v8 offset:4096
    v_mfma_f32_16x16x32_bf16 v[84:87], v[28:31], v[104:107], 0
    ds_read_b64_tr_b16 v[122:123], v8 offset:6144
    v_mfma_f32_16x16x32_bf16 v[32:35], a[0:3], v[104:107], 0
    ds_read_b64_tr_b16 v[124:125], v9 offset:4096
    v_mfma_f32_16x16x32_bf16 v[36:39], a[4:7], v[104:107], 0
    buffer_load_dwordx4 v[200:203], v2, s[80:83], s42 offen offset:1024 sc1
    v_mfma_f32_16x16x32_bf16 v[40:43], a[8:11], v[104:107], 0
    s_waitcnt lgkmcnt(7)
    v_mfma_f32_16x16x32_bf16 v[44:47], a[0:3], v[108:111], 0
    ds_read_b64_tr_b16 v[126:127], v9 offset:6144
    v_mfma_f32_16x16x32_bf16 v[48:51], a[4:7], v[108:111], 0
    ds_read_b64_tr_b16 v[128:129], v10 offset:4096
    v_mfma_f32_16x16x32_bf16 v[52:55], a[8:11], v[108:111], 0
    buffer_load_dwordx4 v[204:207], v2, s[80:83], s42 offen offset:2048 sc1
    s_waitcnt lgkmcnt(7)
    v_mfma_f32_16x16x32_bf16 v[56:59], a[0:3], v[112:115], 0
    ds_read_b64_tr_b16 v[130:131], v10 offset:6144
    v_mfma_f32_16x16x32_bf16 v[60:63], a[4:7], v[112:115], 0
    v_mfma_f32_16x16x32_bf16 v[64:67], a[8:11], v[112:115], 0
    ds_read_b64_tr_b16 v[132:133], v11 offset:4096
    s_waitcnt lgkmcnt(7)
    v_mfma_f32_16x16x32_bf16 v[68:71], a[0:3], v[116:119], 0
    ds_read_b64_tr_b16 v[134:135], v11 offset:6144
    v_mfma_f32_16x16x32_bf16 v[72:75], a[4:7], v[116:119], 0
    buffer_load_dwordx4 v[208:211], v2, s[80:83], s42 offen offset:3072 sc1
    v_mfma_f32_16x16x32_bf16 v[76:79], a[8:11], v[116:119], 0
    s_waitcnt lgkmcnt(6)
    v_mfma_f32_16x16x32_bf16 v[80:83], v[120:123], v[120:123], v[80:83]
    ds_read_b64_tr_b16 v[104:105], v8 offset:8192
    v_mfma_f32_16x16x32_bf16 v[84:87], v[28:31], v[120:123], v[84:87]
    ds_read_b64_tr_b16 v[106:107], v8 offset:10240
    v_mfma_f32_16x16x32_bf16 v[32:35], a[12:15], v[120:123], v[32:35]
    s_add_u32 s42, s54, 16384
    v_mfma_f32_16x16x32_bf16 v[36:39], a[16:19], v[120:123], v[36:39]
    buffer_load_dwordx4 v[212:215], v2, s[80:83], s42 offen offset:0 sc1
    v_mfma_f32_16x16x32_bf16 v[40:43], a[20:23], v[120:123], v[40:43]
    ds_read_b64_tr_b16 v[108:109], v9 offset:8192
    s_waitcnt lgkmcnt(7)
    v_mfma_f32_16x16x32_bf16 v[44:47], a[12:15], v[124:127], v[44:47]
    ds_read_b64_tr_b16 v[110:111], v9 offset:10240
    v_mfma_f32_16x16x32_bf16 v[48:51], a[16:19], v[124:127], v[48:51]
    ds_read_b64_tr_b16 v[112:113], v10 offset:8192
    v_mfma_f32_16x16x32_bf16 v[52:55], a[20:23], v[124:127], v[52:55]
    buffer_load_dwordx4 v[216:219], v2, s[80:83], s42 offen offset:1024 sc1
    s_waitcnt lgkmcnt(7)
    v_mfma_f32_16x16x32_bf16 v[56:59], a[12:15], v[128:131], v[56:59]
    v_mfma_f32_16x16x32_bf16 v[60:63], a[16:19], v[128:131], v[60:63]
    ds_read_b64_tr_b16 v[114:115], v10 offset:10240
    v_mfma_f32_16x16x32_bf16 v[64:67], a[20:23], v[128:131], v[64:67]
    ds_read_b64_tr_b16 v[116:117], v11 offset:8192
    s_waitcnt lgkmcnt(7)
    v_mfma_f32_16x16x32_bf16 v[68:71], a[12:15], v[132:135], v[68:71]
    ds_read_b64_tr_b16 v[118:119], v11 offset:10240
    v_mfma_f32_16x16x32_bf16 v[72:75], a[16:19], v[132:135], v[72:75]
    buffer_load_dwordx4 v[220:223], v2, s[80:83], s42 offen offset:2048 sc1
    v_mfma_f32_16x16x32_bf16 v[76:79], a[20:23], v[132:135], v[76:79]
    s_waitcnt lgkmcnt(6)
    v_mfma_f32_16x16x32_bf16 v[80:83], v[104:107], v[104:107], v[80:83]
    ds_read_b64_tr_b16 v[120:121], v8 offset:12288
    v_mfma_f32_16x16x32_bf16 v[84:87], v[28:31], v[104:107], v[84:87]
    ds_read_b64_tr_b16 v[122:123], v8 offset:14336
    v_mfma_f32_16x16x32_bf16 v[32:35], a[24:27], v[104:107], v[32:35]
    ds_read_b64_tr_b16 v[124:125], v9 offset:12288
    v_mfma_f32_16x16x32_bf16 v[36:39], a[28:31], v[104:107], v[36:39]
    buffer_load_dwordx4 v[224:227], v2, s[80:83], s42 offen offset:3072 sc1
    v_mfma_f32_16x16x32_bf16 v[40:43], a[32:35], v[104:107], v[40:43]
    ds_read_b64_tr_b16 v[126:127], v9 offset:14336
    s_waitcnt lgkmcnt(8)
    v_mfma_f32_16x16x32_bf16 v[44:47], a[24:27], v[108:111], v[44:47]
    v_mfma_f32_16x16x32_bf16 v[48:51], a[28:31], v[108:111], v[48:51]
    ds_read_b64_tr_b16 v[128:129], v10 offset:12288
    s_add_u32 s42, s55, 0
    v_mfma_f32_16x16x32_bf16 v[52:55], a[32:35], v[108:111], v[52:55]
    buffer_load_dwordx4 v[228:231], v2, s[80:83], s42 offen offset:0 sc1
    s_waitcnt lgkmcnt(7)
    v_mfma_f32_16x16x32_bf16 v[56:59], a[24:27], v[112:115], v[56:59]
    v_mfma_f32_16x16x32_bf16 v[60:63], a[28:31], v[112:115], v[60:63]
    ds_read_b64_tr_b16 v[130:131], v10 offset:14336
    v_mfma_f32_16x16x32_bf16 v[64:67], a[32:35], v[112:115], v[64:67]
    ds_read_b64_tr_b16 v[132:133], v11 offset:12288
    s_waitcnt lgkmcnt(7)
    v_mfma_f32_16x16x32_bf16 v[68:71], a[24:27], v[116:119], v[68:71]
    ds_read_b64_tr_b16 v[134:135], v11 offset:14336
    v_mfma_f32_16x16x32_bf16 v[72:75], a[28:31], v[116:119], v[72:75]
    buffer_load_dwordx4 v[232:235], v2, s[80:83], s42 offen offset:1024 sc1
    v_mfma_f32_16x16x32_bf16 v[76:79], a[32:35], v[116:119], v[76:79]
    s_waitcnt lgkmcnt(6)
    v_mfma_f32_16x16x32_bf16 v[80:83], v[120:123], v[120:123], v[80:83]
    s_waitcnt vmcnt(31)
    s_barrier
    v_mfma_f32_16x16x32_bf16 v[84:87], v[28:31], v[120:123], v[84:87]
    ds_read_b64_tr_b16 v[104:105], v8 offset:16384
    v_mfma_f32_16x16x32_bf16 v[32:35], a[36:39], v[120:123], v[32:35]
    ds_read_b64_tr_b16 v[106:107], v8 offset:18432
    v_mfma_f32_16x16x32_bf16 v[36:39], a[40:43], v[120:123], v[36:39]
    buffer_load_dwordx4 v[236:239], v2, s[80:83], s42 offen offset:2048 sc1
    v_mfma_f32_16x16x32_bf16 v[40:43], a[44:47], v[120:123], v[40:43]
    ds_read_b64_tr_b16 v[108:109], v9 offset:16384
    s_waitcnt lgkmcnt(7)
    v_mfma_f32_16x16x32_bf16 v[44:47], a[36:39], v[124:127], v[44:47]
    ds_read_b64_tr_b16 v[110:111], v9 offset:18432
    v_mfma_f32_16x16x32_bf16 v[48:51], a[40:43], v[124:127], v[48:51]
    ds_read_b64_tr_b16 v[112:113], v10 offset:16384
    v_mfma_f32_16x16x32_bf16 v[52:55], a[44:47], v[124:127], v[52:55]
    buffer_load_dwordx4 v[240:243], v2, s[80:83], s42 offen offset:3072 sc1
    s_waitcnt lgkmcnt(7)
    v_mfma_f32_16x16x32_bf16 v[56:59], a[36:39], v[128:131], v[56:59]
    v_mfma_f32_16x16x32_bf16 v[60:63], a[40:43], v[128:131], v[60:63]
    ds_read_b64_tr_b16 v[114:115], v10 offset:18432
    v_mfma_f32_16x16x32_bf16 v[64:67], a[44:47], v[128:131], v[64:67]
    ds_read_b64_tr_b16 v[116:117], v11 offset:16384
    s_waitcnt lgkmcnt(7)
    v_mfma_f32_16x16x32_bf16 v[68:71], a[36:39], v[132:135], v[68:71]
    ds_read_b64_tr_b16 v[118:119], v11 offset:18432
    s_add_u32 s42, s55, 4096
    v_mfma_f32_16x16x32_bf16 v[72:75], a[40:43], v[132:135], v[72:75]
    buffer_load_dwordx4 v[244:247], v2, s[80:83], s42 offen offset:0 sc1
    v_mfma_f32_16x16x32_bf16 v[76:79], a[44:47], v[132:135], v[76:79]
    s_waitcnt lgkmcnt(6)
    v_mfma_f32_16x16x32_bf16 v[80:83], v[104:107], v[104:107], v[80:83]
    ds_read_b64_tr_b16 v[120:121], v8 offset:20480
    v_mfma_f32_16x16x32_bf16 v[84:87], v[28:31], v[104:107], v[84:87]
    ds_read_b64_tr_b16 v[122:123], v8 offset:22528
    v_mfma_f32_16x16x32_bf16 v[32:35], a[48:51], v[104:107], v[32:35]
    ds_read_b64_tr_b16 v[124:125], v9 offset:20480
    v_mfma_f32_16x16x32_bf16 v[36:39], a[52:55], v[104:107], v[36:39]
    buffer_load_dwordx4 v[248:251], v2, s[80:83], s42 offen offset:1024 sc1
    v_mfma_f32_16x16x32_bf16 v[40:43], a[56:59], v[104:107], v[40:43]
    s_waitcnt lgkmcnt(7)
    v_mfma_f32_16x16x32_bf16 v[44:47], a[48:51], v[108:111], v[44:47]
    ds_read_b64_tr_b16 v[126:127], v9 offset:22528
    v_mfma_f32_16x16x32_bf16 v[48:51], a[52:55], v[108:111], v[48:51]
    ds_read_b64_tr_b16 v[128:129], v10 offset:20480
    v_mfma_f32_16x16x32_bf16 v[52:55], a[56:59], v[108:111], v[52:55]
    buffer_load_dwordx4 a[240:243], v2, s[80:83], s42 offen offset:2048 sc1
    s_waitcnt lgkmcnt(7)
    v_mfma_f32_16x16x32_bf16 v[56:59], a[48:51], v[112:115], v[56:59]
    ds_read_b64_tr_b16 v[130:131], v10 offset:22528
    v_mfma_f32_16x16x32_bf16 v[60:63], a[52:55], v[112:115], v[60:63]
    v_mfma_f32_16x16x32_bf16 v[64:67], a[56:59], v[112:115], v[64:67]
    ds_read_b64_tr_b16 v[132:133], v11 offset:20480
    s_waitcnt lgkmcnt(7)
    v_mfma_f32_16x16x32_bf16 v[68:71], a[48:51], v[116:119], v[68:71]
    ds_read_b64_tr_b16 v[134:135], v11 offset:22528
    v_mfma_f32_16x16x32_bf16 v[72:75], a[52:55], v[116:119], v[72:75]
    buffer_load_dwordx4 a[244:247], v2, s[80:83], s42 offen offset:3072 sc1
    v_mfma_f32_16x16x32_bf16 v[76:79], a[56:59], v[116:119], v[76:79]
    s_waitcnt lgkmcnt(6)
    v_mfma_f32_16x16x32_bf16 v[32:35], a[60:63], v[120:123], v[32:35]
    s_waitcnt vmcnt(15)
    s_barrier
    s_mov_b32 s43, 65536
    s_mov_b64 exec, 1
    buffer_atomic_swap v6, v3, s[80:83], s43 offen sc1
    s_mov_b64 exec, -1
    v_mfma_f32_16x16x32_bf16 v[36:39], a[64:67], v[120:123], v[36:39]
    ds_read_b64_tr_b16 v[104:105], v8 offset:24576
    s_add_u32 s42, s55, 8192
    v_mfma_f32_16x16x32_bf16 v[40:43], a[68:71], v[120:123], v[40:43]
    buffer_load_dwordx4 a[248:251], v2, s[80:83], s42 offen offset:0 sc1
    s_waitcnt lgkmcnt(5)
    v_mfma_f32_16x16x32_bf16 v[44:47], a[60:63], v[124:127], v[44:47]
    ds_read_b64_tr_b16 v[106:107], v8 offset:26624
    ds_read_b64_tr_b16 v[108:109], v9 offset:24576
    v_mfma_f32_16x16x32_bf16 v[48:51], a[64:67], v[124:127], v[48:51]
    ds_read_b64_tr_b16 v[110:111], v9 offset:26624
    ds_read_b64_tr_b16 v[112:113], v10 offset:24576
    v_mfma_f32_16x16x32_bf16 v[52:55], a[68:71], v[124:127], v[52:55]
    ds_read_b64_tr_b16 v[114:115], v10 offset:26624
    ds_read_b64_tr_b16 v[116:117], v11 offset:24576
    s_waitcnt lgkmcnt(9)
    v_mfma_f32_16x16x32_bf16 v[56:59], a[60:63], v[128:131], v[56:59]
    buffer_load_dwordx4 a[252:255], v2, s[80:83], s42 offen offset:1024 sc1
    v_mfma_f32_16x16x32_bf16 v[60:63], a[64:67], v[128:131], v[60:63]
    ds_read_b64_tr_b16 v[118:119], v11 offset:26624
    v_mov_b32 v101, v6
    v_mfma_f32_16x16x32_bf16 v[64:67], a[68:71], v[128:131], v[64:67]
    v_mov_b32 v103, v6
    v_mov_b32 v100, v84
    s_waitcnt lgkmcnt(8)
    v_mfma_f32_16x16x32_bf16 v[68:71], a[60:63], v[132:135], v[68:71]
    v_cndmask_b32 v102, v80, v81, s[32:33]
    v_cndmask_b32 v102, v102, v82, s[34:35]
    v_mfma_f32_16x16x32_bf16 v[72:75], a[64:67], v[132:135], v[72:75]
    buffer_load_dwordx4 a[0:3], v2, s[80:83], s42 offen offset:2048 sc1
    v_mfma_f32_16x16x32_bf16 v[76:79], a[68:71], v[132:135], v[76:79]
    v_cndmask_b32 v102, v102, v83, s[36:37]
    s_add_u32 s43, s48, 262144
    s_mov_b32 exec_lo, 0x00f0000f
    s_mov_b32 exec_hi, 0xf0000f00
    buffer_store_dwordx4 v[100:103], v12, s[80:83], s43 offen sc1
    s_mov_b64 exec, -1
    s_waitcnt lgkmcnt(6)
    v_mfma_f32_16x16x32_bf16 v[32:35], a[72:75], v[104:107], v[32:35]
    ds_read_b64_tr_b16 v[120:121], v8 offset:28672
    v_mfma_f32_16x16x32_bf16 v[36:39], a[76:79], v[104:107], v[36:39]
    ds_read_b64_tr_b16 v[122:123], v8 offset:30720
    v_mfma_f32_16x16x32_bf16 v[40:43], a[80:83], v[104:107], v[40:43]
    buffer_load_dwordx4 a[4:7], v2, s[80:83], s42 offen offset:3072 sc1
    s_waitcnt lgkmcnt(6)
    v_mfma_f32_16x16x32_bf16 v[44:47], a[72:75], v[108:111], v[44:47]
    ds_read_b64_tr_b16 v[124:125], v9 offset:28672
    v_mfma_f32_16x16x32_bf16 v[48:51], a[76:79], v[108:111], v[48:51]
    ds_read_b64_tr_b16 v[126:127], v9 offset:30720
    v_mfma_f32_16x16x32_bf16 v[52:55], a[80:83], v[108:111], v[52:55]
    ds_read_b64_tr_b16 v[128:129], v10 offset:28672
    s_add_u32 s42, s55, 12288
    s_waitcnt lgkmcnt(7)
    v_mfma_f32_16x16x32_bf16 v[56:59], a[72:75], v[112:115], v[56:59]
    buffer_load_dwordx4 a[8:11], v2, s[80:83], s42 offen offset:0 sc1
    v_mfma_f32_16x16x32_bf16 v[60:63], a[76:79], v[112:115], v[60:63]
    ds_read_b64_tr_b16 v[130:131], v10 offset:30720
    v_mfma_f32_16x16x32_bf16 v[64:67], a[80:83], v[112:115], v[64:67]
    ds_read_b64_tr_b16 v[132:133], v11 offset:28672
    s_waitcnt lgkmcnt(7)
    v_mfma_f32_16x16x32_bf16 v[68:71], a[72:75], v[116:119], v[68:71]
    ds_read_b64_tr_b16 v[134:135], v11 offset:30720
    v_mfma_f32_16x16x32_bf16 v[72:75], a[76:79], v[116:119], v[72:75]
    buffer_load_dwordx4 a[12:15], v2, s[80:83], s42 offen offset:1024 sc1
    v_mfma_f32_16x16x32_bf16 v[76:79], a[80:83], v[116:119], v[76:79]
    s_waitcnt lgkmcnt(6)
    v_mfma_f32_16x16x32_bf16 v[32:35], a[84:87], v[120:123], v[32:35]
    s_barrier
    ds_read_b64_tr_b16 v[104:105], v8 offset:32768
    v_mfma_f32_16x16x32_bf16 v[36:39], a[88:91], v[120:123], v[36:39]
    ds_read_b64_tr_b16 v[106:107], v8 offset:34816
    v_mfma_f32_16x16x32_bf16 v[40:43], a[92:95], v[120:123], v[40:43]
    buffer_load_dwordx4 a[16:19], v2, s[80:83], s42 offen offset:2048 sc1
    s_waitcnt lgkmcnt(6)
    v_mfma_f32_16x16x32_bf16 v[44:47], a[84:87], v[124:127], v[44:47]
    ds_read_b64_tr_b16 v[108:109], v9 offset:32768
    v_mfma_f32_16x16x32_bf16 v[48:51], a[88:91], v[124:127], v[48:51]
    ds_read_b64_tr_b16 v[110:111], v9 offset:34816
    v_mfma_f32_16x16x32_bf16 v[52:55], a[92:95], v[124:127], v[52:55]
    ds_read_b64_tr_b16 v[112:113], v10 offset:32768
    s_waitcnt lgkmcnt(7)
    v_mfma_f32_16x16x32_bf16 v[56:59], a[84:87], v[128:131], v[56:59]
    buffer_load_dwordx4 a[20:23], v2, s[80:83], s42 offen offset:3072 sc1
    v_mfma_f32_16x16x32_bf16 v[60:63], a[88:91], v[128:131], v[60:63]
    ds_read_b64_tr_b16 v[114:115], v10 offset:34816
    v_mfma_f32_16x16x32_bf16 v[64:67], a[92:95], v[128:131], v[64:67]
    ds_read_b64_tr_b16 v[116:117], v11 offset:32768
    s_waitcnt lgkmcnt(7)
    v_mfma_f32_16x16x32_bf16 v[68:71], a[84:87], v[132:135], v[68:71]
    s_add_u32 s42, s55, 16384
    v_mfma_f32_16x16x32_bf16 v[72:75], a[88:91], v[132:135], v[72:75]
    buffer_load_dwordx4 a[24:27], v2, s[80:83], s42 offen offset:0 sc1
    v_mfma_f32_16x16x32_bf16 v[76:79], a[92:95], v[132:135], v[76:79]
    ds_read_b64_tr_b16 v[118:119], v11 offset:34816
    s_waitcnt lgkmcnt(6)
    v_mfma_f32_16x16x32_bf16 v[32:35], a[96:99], v[104:107], v[32:35]
    ds_read_b64_tr_b16 v[120:121], v8 offset:36864
    v_mfma_f32_16x16x32_bf16 v[36:39], a[100:103], v[104:107], v[36:39]
    ds_read_b64_tr_b16 v[122:123], v8 offset:38912
    v_mfma_f32_16x16x32_bf16 v[40:43], a[104:107], v[104:107], v[40:43]
    buffer_load_dwordx4 a[28:31], v2, s[80:83], s42 offen offset:1024 sc1
    s_waitcnt lgkmcnt(6)
    v_mfma_f32_16x16x32_bf16 v[44:47], a[96:99], v[108:111], v[44:47]
    ds_read_b64_tr_b16 v[124:125], v9 offset:36864
    v_mfma_f32_16x16x32_bf16 v[48:51], a[100:103], v[108:111], v[48:51]
    ds_read_b64_tr_b16 v[126:127], v9 offset:38912
    v_mfma_f32_16x16x32_bf16 v[52:55], a[104:107], v[108:111], v[52:55]
    ds_read_b64_tr_b16 v[128:129], v10 offset:36864
    s_waitcnt lgkmcnt(7)
    v_mfma_f32_16x16x32_bf16 v[56:59], a[96:99], v[112:115], v[56:59]
    buffer_load_dwordx4 a[32:35], v2, s[80:83], s42 offen offset:2048 sc1
    v_mfma_f32_16x16x32_bf16 v[60:63], a[100:103], v[112:115], v[60:63]
    ds_read_b64_tr_b16 v[130:131], v10 offset:38912
    v_mfma_f32_16x16x32_bf16 v[64:67], a[104:107], v[112:115], v[64:67]
    ds_read_b64_tr_b16 v[132:133], v11 offset:36864
    s_waitcnt lgkmcnt(7)
    v_mfma_f32_16x16x32_bf16 v[68:71], a[96:99], v[116:119], v[68:71]
    ds_read_b64_tr_b16 v[134:135], v11 offset:38912
    v_mfma_f32_16x16x32_bf16 v[72:75], a[100:103], v[116:119], v[72:75]
    buffer_load_dwordx4 a[36:39], v2, s[80:83], s42 offen offset:3072 sc1
    v_mfma_f32_16x16x32_bf16 v[76:79], a[104:107], v[116:119], v[76:79]
    s_waitcnt lgkmcnt(6)
    v_mfma_f32_16x16x32_bf16 v[32:35], a[108:111], v[120:123], v[32:35]
    v_add_u32 v8, 40960, v8
    v_add_u32 v9, 40960, v9
    v_mfma_f32_16x16x32_bf16 v[36:39], a[112:115], v[120:123], v[36:39]
    v_add_u32 v10, 40960, v10
    s_add_u32 s42, s56, 0
    v_mfma_f32_16x16x32_bf16 v[40:43], a[116:119], v[120:123], v[40:43]
    buffer_load_dwordx4 a[40:43], v2, s[80:83], s42 offen offset:0 sc1
    s_waitcnt lgkmcnt(4)
    v_mfma_f32_16x16x32_bf16 v[44:47], a[108:111], v[124:127], v[44:47]
    v_add_u32 v11, 40960, v11
    v_mfma_f32_16x16x32_bf16 v[48:51], a[112:115], v[124:127], v[48:51]
    ds_read_b64_tr_b16 v[104:105], v8 offset:0
    v_mfma_f32_16x16x32_bf16 v[52:55], a[116:119], v[124:127], v[52:55]
    ds_read_b64_tr_b16 v[106:107], v8 offset:2048
    ds_read_b64_tr_b16 v[108:109], v9 offset:0
    s_waitcnt lgkmcnt(5)
    v_mfma_f32_16x16x32_bf16 v[56:59], a[108:111], v[128:131], v[56:59]
    buffer_load_dwordx4 a[44:47], v2, s[80:83], s42 offen offset:1024 sc1
    v_mfma_f32_16x16x32_bf16 v[60:63], a[112:115], v[128:131], v[60:63]
    ds_read_b64_tr_b16 v[110:111], v9 offset:2048
    v_mfma_f32_16x16x32_bf16 v[64:67], a[116:119], v[128:131], v[64:67]
    ds_read_b64_tr_b16 v[112:113], v10 offset:0
    ds_read_b64_tr_b16 v[114:115], v10 offset:2048
    s_waitcnt lgkmcnt(6)
    v_mfma_f32_16x16x32_bf16 v[68:71], a[108:111], v[132:135], v[68:71]
    ds_read_b64_tr_b16 v[116:117], v11 offset:0
    v_mfma_f32_16x16x32_bf16 v[72:75], a[112:115], v[132:135], v[72:75]
    buffer_load_dwordx4 a[48:51], v2, s[80:83], s42 offen offset:2048 sc1
    v_mfma_f32_16x16x32_bf16 v[76:79], a[116:119], v[132:135], v[76:79]
    ds_read_b64_tr_b16 v[118:119], v11 offset:2048
    s_waitcnt lgkmcnt(6)
    v_mfma_f32_16x16x32_bf16 v[32:35], a[120:123], v[104:107], v[32:35]
    s_mov_b32 s27, 65536
    buffer_load_dwordx4 v[252:255], v7, s[80:83], s27 offen sc1
    v_mfma_f32_16x16x32_bf16 v[36:39], a[124:127], v[104:107], v[36:39]
    ds_read_b64_tr_b16 v[120:121], v8 offset:4096
    ds_read_b64_tr_b16 v[122:123], v8 offset:6144
    v_mfma_f32_16x16x32_bf16 v[40:43], a[128:131], v[104:107], v[40:43]
    buffer_load_dwordx4 a[52:55], v2, s[80:83], s42 offen offset:3072 sc1
    s_waitcnt lgkmcnt(6)
    v_mfma_f32_16x16x32_bf16 v[44:47], a[120:123], v[108:111], v[44:47]
    ds_read_b64_tr_b16 v[124:125], v9 offset:4096
    v_mfma_f32_16x16x32_bf16 v[48:51], a[124:127], v[108:111], v[48:51]
    ds_read_b64_tr_b16 v[126:127], v9 offset:6144
    v_mfma_f32_16x16x32_bf16 v[52:55], a[128:131], v[108:111], v[52:55]
    s_add_u32 s42, s56, 4096
    s_waitcnt lgkmcnt(6)
    v_mfma_f32_16x16x32_bf16 v[56:59], a[120:123], v[112:115], v[56:59]
    buffer_load_dwordx4 a[56:59], v2, s[80:83], s42 offen offset:0 sc1
    v_mfma_f32_16x16x32_bf16 v[60:63], a[124:127], v[112:115], v[60:63]
    ds_read_b64_tr_b16 v[128:129], v10 offset:4096
    v_mfma_f32_16x16x32_bf16 v[64:67], a[128:131], v[112:115], v[64:67]
    ds_read_b64_tr_b16 v[130:131], v10 offset:6144
    s_waitcnt lgkmcnt(6)
    v_mfma_f32_16x16x32_bf16 v[68:71], a[120:123], v[116:119], v[68:71]
    ds_read_b64_tr_b16 v[132:133], v11 offset:4096
    v_mfma_f32_16x16x32_bf16 v[72:75], a[124:127], v[116:119], v[72:75]
    buffer_load_dwordx4 a[60:63], v2, s[80:83], s42 offen offset:1024 sc1
    v_mfma_f32_16x16x32_bf16 v[76:79], a[128:131], v[116:119], v[76:79]
    ds_read_b64_tr_b16 v[134:135], v11 offset:6144
    s_waitcnt lgkmcnt(6)
    v_mfma_f32_16x16x32_bf16 v[32:35], a[132:135], v[120:123], v[32:35]
    s_barrier
    ds_read_b64_tr_b16 v[104:105], v8 offset:8192
    v_mfma_f32_16x16x32_bf16 v[36:39], a[136:139], v[120:123], v[36:39]
    ds_read_b64_tr_b16 v[106:107], v8 offset:10240
    v_mfma_f32_16x16x32_bf16 v[40:43], a[140:143], v[120:123], v[40:43]
    buffer_load_dwordx4 a[64:67], v2, s[80:83], s42 offen offset:2048 sc1
    s_waitcnt lgkmcnt(6)
    v_mfma_f32_16x16x32_bf16 v[44:47], a[132:135], v[124:127], v[44:47]
    ds_read_b64_tr_b16 v[108:109], v9 offset:8192
    v_mfma_f32_16x16x32_bf16 v[48:51], a[136:139], v[124:127], v[48:51]
    ds_read_b64_tr_b16 v[110:111], v9 offset:10240
    v_mfma_f32_16x16x32_bf16 v[52:55], a[140:143], v[124:127], v[52:55]
    ds_read_b64_tr_b16 v[112:113], v10 offset:8192
    s_waitcnt lgkmcnt(7)
    v_mfma_f32_16x16x32_bf16 v[56:59], a[132:135], v[128:131], v[56:59]
    buffer_load_dwordx4 a[68:71], v2, s[80:83], s42 offen offset:3072 sc1
    v_mfma_f32_16x16x32_bf16 v[60:63], a[136:139], v[128:131], v[60:63]
    ds_read_b64_tr_b16 v[114:115], v10 offset:10240
    v_mfma_f32_16x16x32_bf16 v[64:67], a[140:143], v[128:131], v[64:67]
    ds_read_b64_tr_b16 v[116:117], v11 offset:8192
    s_waitcnt lgkmcnt(7)
    v_mfma_f32_16x16x32_bf16 v[68:71], a[132:135], v[132:135], v[68:71]
    s_add_u32 s42, s56, 8192
    v_mfma_f32_16x16x32_bf16 v[72:75], a[136:139], v[132:135], v[72:75]
    buffer_load_dwordx4 a[72:75], v2, s[80:83], s42 offen offset:0 sc1
    v_mfma_f32_16x16x32_bf16 v[76:79], a[140:143], v[132:135], v[76:79]
    ds_read_b64_tr_b16 v[118:119], v11 offset:10240
    s_waitcnt lgkmcnt(6)
    v_mfma_f32_16x16x32_bf16 v[32:35], a[144:147], v[104:107], v[32:35]
    ds_read_b64_tr_b16 v[120:121], v8 offset:12288
    v_mfma_f32_16x16x32_bf16 v[36:39], a[148:151], v[104:107], v[36:39]
    ds_read_b64_tr_b16 v[122:123], v8 offset:14336
    v_mfma_f32_16x16x32_bf16 v[40:43], a[152:155], v[104:107], v[40:43]
    buffer_load_dwordx4 a[76:79], v2, s[80:83], s42 offen offset:1024 sc1
    s_waitcnt lgkmcnt(6)
    v_mfma_f32_16x16x32_bf16 v[44:47], a[144:147], v[108:111], v[44:47]
    ds_read_b64_tr_b16 v[124:125], v9 offset:12288
    v_mfma_f32_16x16x32_bf16 v[48:51], a[148:151], v[108:111], v[48:51]
    ds_read_b64_tr_b16 v[126:127], v9 offset:14336
    v_mfma_f32_16x16x32_bf16 v[52:55], a[152:155], v[108:111], v[52:55]
    ds_read_b64_tr_b16 v[128:129], v10 offset:12288
    s_waitcnt lgkmcnt(7)
    v_mfma_f32_16x16x32_bf16 v[56:59], a[144:147], v[112:115], v[56:59]
    buffer_load_dwordx4 a[80:83], v2, s[80:83], s42 offen offset:2048 sc1
    v_mfma_f32_16x16x32_bf16 v[60:63], a[148:151], v[112:115], v[60:63]
    ds_read_b64_tr_b16 v[130:131], v10 offset:14336
    v_mfma_f32_16x16x32_bf16 v[64:67], a[152:155], v[112:115], v[64:67]
    ds_read_b64_tr_b16 v[132:133], v11 offset:12288
    s_waitcnt lgkmcnt(7)
    v_mfma_f32_16x16x32_bf16 v[68:71], a[144:147], v[116:119], v[68:71]
    ds_read_b64_tr_b16 v[134:135], v11 offset:14336
    v_mfma_f32_16x16x32_bf16 v[72:75], a[148:151], v[116:119], v[72:75]
    buffer_load_dwordx4 a[84:87], v2, s[80:83], s42 offen offset:3072 sc1
    v_mfma_f32_16x16x32_bf16 v[76:79], a[152:155], v[116:119], v[76:79]
    s_waitcnt lgkmcnt(6)
    v_mfma_f32_16x16x32_bf16 v[32:35], a[156:159], v[120:123], v[32:35]
    buffer_load_dwordx4 v[80:83], v13, s[80:83], s94 offen sc1
    v_mfma_f32_16x16x32_bf16 v[36:39], a[160:163], v[120:123], v[36:39]
    ds_read_b64_tr_b16 v[104:105], v8 offset:16384
    s_add_u32 s42, s56, 12288
    v_mfma_f32_16x16x32_bf16 v[40:43], a[164:167], v[120:123], v[40:43]
    buffer_load_dwordx4 a[88:91], v2, s[80:83], s42 offen offset:0 sc1
    s_waitcnt lgkmcnt(5)
    v_mfma_f32_16x16x32_bf16 v[44:47], a[156:159], v[124:127], v[44:47]
    ds_read_b64_tr_b16 v[106:107], v8 offset:18432
    v_mfma_f32_16x16x32_bf16 v[48:51], a[160:163], v[124:127], v[48:51]
    ds_read_b64_tr_b16 v[108:109], v9 offset:16384
    v_mfma_f32_16x16x32_bf16 v[52:55], a[164:167], v[124:127], v[52:55]
    ds_read_b64_tr_b16 v[110:111], v9 offset:18432
    s_waitcnt lgkmcnt(6)
    v_mfma_f32_16x16x32_bf16 v[56:59], a[156:159], v[128:131], v[56:59]
    buffer_load_dwordx4 a[92:95], v2, s[80:83], s42 offen offset:1024 sc1
    v_mfma_f32_16x16x32_bf16 v[60:63], a[160:163], v[128:131], v[60:63]
    ds_read_b64_tr_b16 v[112:113], v10 offset:16384
    v_mfma_f32_16x16x32_bf16 v[64:67], a[164:167], v[128:131], v[64:67]
    ds_read_b64_tr_b16 v[114:115], v10 offset:18432
    s_waitcnt lgkmcnt(6)
    v_mfma_f32_16x16x32_bf16 v[68:71], a[156:159], v[132:135], v[68:71]
    ds_read_b64_tr_b16 v[116:117], v11 offset:16384
    v_mfma_f32_16x16x32_bf16 v[72:75], a[160:163], v[132:135], v[72:75]
    buffer_load_dwordx4 a[96:99], v2, s[80:83], s42 offen offset:2048 sc1
    v_mfma_f32_16x16x32_bf16 v[76:79], a[164:167], v[132:135], v[76:79]
    ds_read_b64_tr_b16 v[118:119], v11 offset:18432
    s_waitcnt lgkmcnt(6)
    v_mfma_f32_16x16x32_bf16 v[32:35], a[168:171], v[104:107], v[32:35]
    s_waitcnt vmcnt(13)
    v_cmp_eq_u64 vcc, s[92:93], v[252:253]
    v_cmp_eq_u64 s[30:31], s[92:93], v[254:255]
    s_nop 0
    s_and_b64 vcc, vcc, s[30:31]
    s_cmp_eq_u64 vcc, -1
    s_cbranch_scc1 L_ok_29
    s_mov_b32 s11, 0x20000
L_poll_30:
    buffer_load_dwordx4 v[252:255], v7, s[80:83], s27 offen sc1
    s_waitcnt vmcnt(0)
    v_cmp_eq_u64 vcc, s[92:93], v[252:253]
    v_cmp_eq_u64 s[30:31], s[92:93], v[254:255]
    s_nop 0
    s_and_b64 vcc, vcc, s[30:31]
    s_cmp_eq_u64 vcc, -1
    s_cbranch_scc1 L_polld_31
    s_sub_u32 s11, s11, 1
    s_cbranch_scc0 L_poll_30
L_polld_31:
L_ok_29:
    v_mfma_f32_16x16x32_bf16 v[36:39], a[172:175], v[104:107], v[36:39]
    ds_read_b64_tr_b16 v[120:121], v8 offset:20480
    s_add_u32 s86, s57, 0
    v_mfma_f32_16x16x32_bf16 v[40:43], a[176:179], v[104:107], v[40:43]
    buffer_load_dwordx4 a[120:123], v2, s[80:83], s86 offen offset:0 sc1
    s_waitcnt lgkmcnt(5)
    v_mfma_f32_16x16x32_bf16 v[44:47], a[168:171], v[108:111], v[44:47]
    ds_read_b64_tr_b16 v[122:123], v8 offset:22528
    ds_read_b64_tr_b16 v[124:125], v9 offset:20480
    v_mfma_f32_16x16x32_bf16 v[48:51], a[172:175], v[108:111], v[48:51]
    ds_read_b64_tr_b16 v[126:127], v9 offset:22528
    ds_read_b64_tr_b16 v[128:129], v10 offset:20480
    v_mfma_f32_16x16x32_bf16 v[52:55], a[176:179], v[108:111], v[52:55]
    ds_read_b64_tr_b16 v[130:131], v10 offset:22528
    ds_read_b64_tr_b16 v[132:133], v11 offset:20480
    s_waitcnt lgkmcnt(9)
    v_mfma_f32_16x16x32_bf16 v[56:59], a[168:171], v[112:115], v[56:59]
    buffer_load_dwordx4 a[124:127], v2, s[80:83], s86 offen offset:1024 sc1
    v_mfma_f32_16x16x32_bf16 v[60:63], a[172:175], v[112:115], v[60:63]
    ds_read_b64_tr_b16 v[134:135], v11 offset:22528
    s_add_u32 s12, s84, 49152
    v_mfma_f32_16x16x32_bf16 v[64:67], a[176:179], v[112:115], v[64:67]
    s_add_u32 s13, s85, 49152
    v_add_u32 v14, s12, v17
    s_waitcnt lgkmcnt(8)
    v_mfma_f32_16x16x32_bf16 v[68:71], a[168:171], v[116:119], v[68:71]
    v_xor_b32 v15, 32, v14
    s_and_b32 s14, s3, 1
    v_mfma_f32_16x16x32_bf16 v[72:75], a[172:175], v[116:119], v[72:75]
    buffer_load_dwordx4 a[128:131], v2, s[80:83], s86 offen offset:2048 sc1
    v_mfma_f32_16x16x32_bf16 v[76:79], a[176:179], v[116:119], v[76:79]
    s_lshl_b32 s14, s14, 5
    v_xor_b32 v16, s14, v17
    v_add_u32 v16, s13, v16
    s_waitcnt lgkmcnt(6)
    v_mfma_f32_16x16x32_bf16 v[32:35], a[180:183], v[120:123], v[32:35]
    s_barrier
    ds_read_b64_tr_b16 v[104:105], v8 offset:24576
    v_mfma_f32_16x16x32_bf16 v[36:39], a[184:187], v[120:123], v[36:39]
    ds_read_b64_tr_b16 v[106:107], v8 offset:26624
    v_mfma_f32_16x16x32_bf16 v[40:43], a[188:191], v[120:123], v[40:43]
    buffer_load_dwordx4 a[132:135], v2, s[80:83], s86 offen offset:3072 sc1
    s_waitcnt lgkmcnt(6)
    v_mfma_f32_16x16x32_bf16 v[44:47], a[180:183], v[124:127], v[44:47]
    ds_read_b64_tr_b16 v[108:109], v9 offset:24576
    v_mfma_f32_16x16x32_bf16 v[48:51], a[184:187], v[124:127], v[48:51]
    ds_read_b64_tr_b16 v[110:111], v9 offset:26624
    v_mfma_f32_16x16x32_bf16 v[52:55], a[188:191], v[124:127], v[52:55]
    s_add_u32 s86, s58, 0
    s_waitcnt lgkmcnt(6)
    v_mfma_f32_16x16x32_bf16 v[56:59], a[180:183], v[128:131], v[56:59]
    buffer_load_dwordx4 a[136:139], v2, s[80:83], s86 offen offset:0 sc1
    v_mfma_f32_16x16x32_bf16 v[60:63], a[184:187], v[128:131], v[60:63]
    ds_read_b64_tr_b16 v[112:113], v10 offset:24576
    v_mfma_f32_16x16x32_bf16 v[64:67], a[188:191], v[128:131], v[64:67]
    ds_read_b64_tr_b16 v[114:115], v10 offset:26624
    s_waitcnt lgkmcnt(6)
    v_mfma_f32_16x16x32_bf16 v[68:71], a[180:183], v[132:135], v[68:71]
    ds_read_b64_tr_b16 v[116:117], v11 offset:24576
    v_mfma_f32_16x16x32_bf16 v[72:75], a[184:187], v[132:135], v[72:75]
    buffer_load_dwordx4 a[140:143], v2, s[80:83], s86 offen offset:1024 sc1
    v_mfma_f32_16x16x32_bf16 v[76:79], a[188:191], v[132:135], v[76:79]
    ds_read_b64_tr_b16 v[118:119], v11 offset:26624
    s_waitcnt lgkmcnt(6)
    v_mfma_f32_16x16x32_bf16 v[32:35], a[192:195], v[104:107], v[32:35]
    ds_read_b64_tr_b16 v[120:121], v8 offset:28672
    ds_read_b64_tr_b16 v[122:123], v8 offset:30720
    v_mfma_f32_16x16x32_bf16 v[36:39], a[196:199], v[104:107], v[36:39]
    ds_read_b64_tr_b16 v[124:125], v9 offset:28672
    v_mfma_f32_16x16x32_bf16 v[40:43], a[200:203], v[104:107], v[40:43]
    buffer_load_dwordx4 a[144:147], v2, s[80:83], s86 offen offset:2048 sc1
    s_waitcnt lgkmcnt(7)
    v_mfma_f32_16x16x32_bf16 v[44:47], a[192:195], v[108:111], v[44:47]
    ds_read_b64_tr_b16 v[126:127], v9 offset:30720
    v_mfma_f32_16x16x32_bf16 v[48:51], a[196:199], v[108:111], v[48:51]
    ds_read_b64_tr_b16 v[128:129], v10 offset:28672
    ds_read_b64_tr_b16 v[130:131], v10 offset:30720
    v_mfma_f32_16x16x32_bf16 v[52:55], a[200:203], v[108:111], v[52:55]
    ds_read_b64_tr_b16 v[132:133], v11 offset:28672
    s_waitcnt lgkmcnt(9)
    v_mfma_f32_16x16x32_bf16 v[56:59], a[192:195], v[112:115], v[56:59]
    buffer_load_dwordx4 a[148:151], v2, s[80:83], s86 offen offset:3072 sc1
    v_mfma_f32_16x16x32_bf16 v[60:63], a[196:199], v[112:115], v[60:63]
    ds_read_b64_tr_b16 v[134:135], v11 offset:30720
    v_mfma_f32_16x16x32_bf16 v[64:67], a[200:203], v[112:115], v[64:67]
    ds_read_b64_tr_b16 v[142:143], v14
    ds_read_b64_tr_b16 v[144:145], v15
    s_waitcnt lgkmcnt(10)
    v_mfma_f32_16x16x32_bf16 v[68:71], a[192:195], v[116:119], v[68:71]
    s_add_u32 s86, s59, 0
    v_mfma_f32_16x16x32_bf16 v[72:75], a[196:199], v[116:119], v[72:75]
    buffer_load_dwordx4 a[152:155], v2, s[80:83], s86 offen offset:0 sc1
    v_mfma_f32_16x16x32_bf16 v[76:79], a[200:203], v[116:119], v[76:79]
    ds_read_b64_tr_b16 v[146:147], v16
    s_waitcnt lgkmcnt(9)
    v_mfma_f32_16x16x32_bf16 v[32:35], a[204:207], v[120:123], v[32:35]
    s_waitcnt vmcnt(12)
    v_cmp_eq_u32 vcc, s92, v81
    v_cmp_eq_u32 s[30:31], s92, v83
    s_nop 0
    s_and_b64 vcc, vcc, s[30:31]
    s_cmp_eq_u64 vcc, -1
    s_cbranch_scc1 L_gok_32
    s_mov_b32 s11, 0x20000
L_gl_33:
    buffer_load_dwordx4 v[80:83], v13, s[80:83], s94 offen sc1
    s_waitcnt vmcnt(0)
    v_cmp_eq_u32 vcc, s92, v81
    v_cmp_eq_u32 s[30:31], s92, v83
    s_nop 0
    s_and_b64 vcc, vcc, s[30:31]
    s_cmp_eq_u64 vcc, -1
    s_cbranch_scc1 L_gok_32
    s_sub_u32 s11, s11, 1
    s_cbranch_scc0 L_gl_33
L_gok_32:
    v_mfma_f32_16x16x32_bf16 v[36:39], a[208:211], v[120:123], v[36:39]
    ds_read_b64_tr_b16 v[104:105], v8 offset:32768
    ds_read_b64_tr_b16 v[106:107], v8 offset:34816
    v_mfma_f32_16x16x32_bf16 v[40:43], a[212:215], v[120:123], v[40:43]
    buffer_load_dwordx4 a[156:159], v2, s[80:83], s86 offen offset:1024 sc1
    s_waitcnt lgkmcnt(9)
    v_mfma_f32_16x16x32_bf16 v[44:47], a[204:207], v[124:127], v[44:47]
    ds_read_b64_tr_b16 v[108:109], v9 offset:32768
    ds_read_b64_tr_b16 v[110:111], v9 offset:34816
    v_mfma_f32_16x16x32_bf16 v[48:51], a[208:211], v[124:127], v[48:51]
    ds_read_b64_tr_b16 v[112:113], v10 offset:32768
    ds_read_b64_tr_b16 v[114:115], v10 offset:34816
    v_mfma_f32_16x16x32_bf16 v[52:55], a[212:215], v[124:127], v[52:55]
    ds_read_b64_tr_b16 v[116:117], v11 offset:32768
    ds_read_b64_tr_b16 v[118:119], v11 offset:34816
    s_waitcnt lgkmcnt(13)
    v_mfma_f32_16x16x32_bf16 v[56:59], a[204:207], v[128:131], v[56:59]
    buffer_load_dwordx4 a[160:163], v2, s[80:83], s86 offen offset:2048 sc1
    v_mfma_f32_16x16x32_bf16 v[60:63], a[208:211], v[128:131], v[60:63]
    v_permlane32_swap_b32 v80, v82
    v_add_f32 v80, v80, v82
    v_mfma_f32_16x16x32_bf16 v[64:67], a[212:215], v[128:131], v[64:67]
    v_mov_b32 v81, v80
    s_add_u32 s94, s94, 262144
    s_waitcnt lgkmcnt(11)
    v_mfma_f32_16x16x32_bf16 v[68:71], a[204:207], v[132:135], v[68:71]
    v_permlane16_swap_b32 v80, v81
    v_add_f32 v80, v80, v81
    v_mfma_f32_16x16x32_bf16 v[72:75], a[208:211], v[132:135], v[72:75]
    buffer_load_dwordx4 a[164:167], v2, s[80:83], s86 offen offset:3072 sc1
    v_mfma_f32_16x16x32_bf16 v[76:79], a[212:215], v[132:135], v[76:79]
    v_mov_b32 v81, v80
    s_nop 0
    s_nop 0
    v_permlane32_swap_b32 v80, v81
    s_waitcnt lgkmcnt(6)
    v_mfma_f32_16x16x32_bf16 v[32:35], a[216:219], v[104:107], v[32:35]
    ds_read_b64_tr_b16 v[120:121], v8 offset:36864
    ds_read_b64_tr_b16 v[122:123], v8 offset:38912
    v_mfma_f32_16x16x32_bf16 v[36:39], a[220:223], v[104:107], v[36:39]
    ds_read_b64_tr_b16 v[124:125], v9 offset:36864
    ds_read_b64_tr_b16 v[126:127], v9 offset:38912
    v_mfma_f32_16x16x32_bf16 v[40:43], a[224:227], v[104:107], v[40:43]
    buffer_load_dwordx4 a[100:103], v2, s[80:83], s42 offen offset:3072 sc1
    s_waitcnt lgkmcnt(8)
    v_mfma_f32_16x16x32_bf16 v[44:47], a[216:219], v[108:111], v[44:47]
    ds_read_b64_tr_b16 v[128:129], v10 offset:36864
    ds_read_b64_tr_b16 v[130:131], v10 offset:38912
    v_mfma_f32_16x16x32_bf16 v[48:51], a[220:223], v[108:111], v[48:51]
    ds_read_b64_tr_b16 v[132:133], v11 offset:36864
    ds_read_b64_tr_b16 v[134:135], v11 offset:38912
    v_mfma_f32_16x16x32_bf16 v[52:55], a[224:227], v[108:111], v[52:55]
    v_mul_f32 v84, 0xbacccccd, v80
    s_add_u32 s42, s56, 16384
    s_waitcnt lgkmcnt(10)
    v_mfma_f32_16x16x32_bf16 v[56:59], a[216:219], v[112:115], v[56:59]
    buffer_load_dwordx4 a[104:107], v2, s[80:83], s42 offen offset:0 sc1
    v_mfma_f32_16x16x32_bf16 v[60:63], a[220:223], v[112:115], v[60:63]
    v_mul_f32 v81, 0x3acccccd, v81
    v_fma_f32 v81, -v84, v84, v81
    v_mfma_f32_16x16x32_bf16 v[64:67], a[224:227], v[112:115], v[64:67]
    v_max_f32 v81, 0, v81
    v_add_f32 v86, 0x3727c5ac, v81
    s_waitcnt lgkmcnt(8)
    v_mfma_f32_16x16x32_bf16 v[68:71], a[216:219], v[116:119], v[68:71]
    v_rsq_f32 v85, v86
    v_mov_b32 v87, 0
    v_mfma_f32_16x16x32_bf16 v[72:75], a[220:223], v[116:119], v[72:75]
    buffer_load_dwordx4 a[108:111], v2, s[80:83], s42 offen offset:1024 sc1
    v_mfma_f32_16x16x32_bf16 v[76:79], a[224:227], v[116:119], v[76:79]
    v_mul_f32 v85, 0xbfb8aa3b, v85
    s_mov_b64 exec, 0xffff
    ds_write_b128 v19, v[84:87]
    s_mov_b64 exec, -1
    s_waitcnt lgkmcnt(7)
    v_mfma_f32_16x16x32_bf16 v[32:35], a[228:231], v[120:123], v[32:35]
    s_waitcnt lgkmcnt(0)
    s_barrier
    v_mfma_f32_16x16x32_bf16 v[44:47], a[228:231], v[124:127], v[44:47]
    ds_read_b128 v[104:107], v19
    v_mfma_f32_16x16x32_bf16 v[56:59], a[228:231], v[128:131], v[56:59]
    buffer_load_dwordx4 a[112:115], v2, s[80:83], s42 offen offset:2048 sc1
    v_mfma_f32_16x16x32_bf16 v[68:71], a[228:231], v[132:135], v[68:71]
    v_mfma_f32_16x16x32_bf16 v[36:39], a[232:235], v[120:123], v[36:39]
    ds_read_b128 v[108:111], v20
    v_mfma_f32_16x16x32_bf16 v[48:51], a[232:235], v[124:127], v[48:51]
    v_mfma_f32_16x16x32_bf16 v[60:63], a[232:235], v[128:131], v[60:63]
    buffer_load_dwordx4 a[116:119], v2, s[80:83], s42 offen offset:3072 sc1
    v_mfma_f32_16x16x32_bf16 v[72:75], a[232:235], v[132:135], v[72:75]
    ds_read_b128 v[112:115], v21
    v_mfma_f32_16x16x32_bf16 v[40:43], a[236:239], v[120:123], v[40:43]
    ds_read_b128 v[116:119], v22
    v_mfma_f32_16x16x32_bf16 v[52:55], a[236:239], v[124:127], v[52:55]
    s_add_u32 s86, s57, 49408
    v_mfma_f32_16x16x32_bf16 v[64:67], a[236:239], v[128:131], v[64:67]
    buffer_load_dwordx4 a[168:171], v2, s[80:83], s86 offen offset:0 sc1
    v_mfma_f32_16x16x32_bf16 v[76:79], a[236:239], v[132:135], v[76:79]
    s_waitcnt lgkmcnt(3)
    v_pk_fma_f32 v[32:33], v[88:89], v[104:105], v[32:33] op_sel_hi:[1,0,1]
    v_pk_mul_f32 v[120:121], v[32:33], v[104:105] op_sel:[0,1] op_sel_hi:[1,1]
    s_waitcnt lgkmcnt(2)
    v_pk_fma_f32 v[44:45], v[88:89], v[108:109], v[44:45] op_sel_hi:[1,0,1]
    v_pk_mul_f32 v[122:123], v[44:45], v[108:109] op_sel:[0,1] op_sel_hi:[1,1]
    s_waitcnt lgkmcnt(1)
    v_pk_fma_f32 v[56:57], v[88:89], v[112:113], v[56:57] op_sel_hi:[1,0,1]
    v_pk_mul_f32 v[124:125], v[56:57], v[112:113] op_sel:[0,1] op_sel_hi:[1,1]
    s_waitcnt lgkmcnt(0)
    v_pk_fma_f32 v[68:69], v[88:89], v[116:117], v[68:69] op_sel_hi:[1,0,1]
    v_pk_mul_f32 v[126:127], v[68:69], v[116:117] op_sel:[0,1] op_sel_hi:[1,1]
    v_exp_f32 v120, v120
    v_pk_fma_f32 v[34:35], v[90:91], v[104:105], v[34:35] op_sel_hi:[1,0,1]
    v_exp_f32 v121, v121
    buffer_load_dwordx4 a[172:175], v2, s[80:83], s86 offen offset:1024 sc1
    v_pk_mul_f32 v[32:33], v[32:33], v[34:35]
    v_exp_f32 v122, v122
    v_pk_fma_f32 v[46:47], v[90:91], v[108:109], v[46:47] op_sel_hi:[1,0,1]
    v_exp_f32 v123, v123
    v_pk_mul_f32 v[44:45], v[44:45], v[46:47]
    v_exp_f32 v124, v124
    v_pk_fma_f32 v[58:59], v[90:91], v[112:113], v[58:59] op_sel_hi:[1,0,1]
    v_exp_f32 v125, v125
    v_pk_mul_f32 v[56:57], v[56:57], v[58:59]
    v_exp_f32 v126, v126
    v_pk_fma_f32 v[70:71], v[90:91], v[116:117], v[70:71] op_sel_hi:[1,0,1]
    v_exp_f32 v127, v127
    v_pk_mul_f32 v[68:69], v[68:69], v[70:71]
    v_pk_fma_f32 v[120:121], v[120:121], v[106:107], v[106:107] op_sel_hi:[1,0,0]
    buffer_load_dwordx4 a[176:179], v2, s[80:83], s86 offen offset:2048 sc1
    v_pk_fma_f32 v[122:123], v[122:123], v[110:111], v[110:111] op_sel_hi:[1,0,0]
    v_pk_fma_f32 v[124:125], v[124:125], v[114:115], v[114:115] op_sel_hi:[1,0,0]
    v_pk_fma_f32 v[126:127], v[126:127], v[118:119], v[118:119] op_sel_hi:[1,0,0]
    v_rcp_f32 v120, v120
    v_rcp_f32 v121, v121
    v_rcp_f32 v122, v122
    v_pk_mul_f32 v[32:33], v[32:33], v[120:121]
    v_rcp_f32 v123, v123
    v_cvt_pk_bf16_f32 v80, v32, v33
    v_rcp_f32 v124, v124
    v_pk_mul_f32 v[44:45], v[44:45], v[122:123]
    v_rcp_f32 v125, v125
    v_cvt_pk_bf16_f32 v81, v44, v45
    v_rcp_f32 v126, v126
    v_pk_mul_f32 v[56:57], v[56:57], v[124:125]
    buffer_load_dwordx4 a[180:183], v2, s[80:83], s86 offen offset:3072 sc1
    v_rcp_f32 v127, v127
    v_cvt_pk_bf16_f32 v82, v56, v57
    v_pk_mul_f32 v[68:69], v[68:69], v[126:127]
    v_cvt_pk_bf16_f32 v83, v68, v69
    v_permlane32_swap_b32 v80, v82
    s_nop 0
    v_permlane32_swap_b32 v81, v83
    s_nop 1
    v_permlane16_swap_b32 v80, v81
    v_permlane16_swap_b32 v82, v83
    buffer_store_dwordx4 v[80:83], v23, s[80:83], s22 offen offset:0 sc1
    v_pk_fma_f32 v[36:37], v[92:93], v[104:105], v[36:37] op_sel_hi:[1,0,1]
    v_pk_mul_f32 v[120:121], v[36:37], v[104:105] op_sel:[0,1] op_sel_hi:[1,1]
    v_pk_fma_f32 v[48:49], v[92:93], v[108:109], v[48:49] op_sel_hi:[1,0,1]
    v_pk_mul_f32 v[122:123], v[48:49], v[108:109] op_sel:[0,1] op_sel_hi:[1,1]
    v_pk_fma_f32 v[60:61], v[92:93], v[112:113], v[60:61] op_sel_hi:[1,0,1]
    v_pk_mul_f32 v[124:125], v[60:61], v[112:113] op_sel:[0,1] op_sel_hi:[1,1]
    v_pk_fma_f32 v[72:73], v[92:93], v[116:117], v[72:73] op_sel_hi:[1,0,1]
    v_pk_mul_f32 v[126:127], v[72:73], v[116:117] op_sel:[0,1] op_sel_hi:[1,1]
    v_exp_f32 v120, v120
    v_pk_fma_f32 v[38:39], v[94:95], v[104:105], v[38:39] op_sel_hi:[1,0,1]
    s_add_u32 s86, s58, 49408
    v_exp_f32 v121, v121
    buffer_load_dwordx4 a[184:187], v2, s[80:83], s86 offen offset:0 sc1
    v_pk_mul_f32 v[36:37], v[36:37], v[38:39]
    v_exp_f32 v122, v122
    v_pk_fma_f32 v[50:51], v[94:95], v[108:109], v[50:51] op_sel_hi:[1,0,1]
    v_exp_f32 v123, v123
    v_pk_mul_f32 v[48:49], v[48:49], v[50:51]
    v_exp_f32 v124, v124
    v_pk_fma_f32 v[62:63], v[94:95], v[112:113], v[62:63] op_sel_hi:[1,0,1]
    v_exp_f32 v125, v125
    v_pk_mul_f32 v[60:61], v[60:61], v[62:63]
    v_exp_f32 v126, v126
    v_pk_fma_f32 v[74:75], v[94:95], v[116:117], v[74:75] op_sel_hi:[1,0,1]
    v_exp_f32 v127, v127
    v_pk_mul_f32 v[72:73], v[72:73], v[74:75]
    v_pk_fma_f32 v[120:121], v[120:121], v[106:107], v[106:107] op_sel_hi:[1,0,0]
    buffer_load_dwordx4 a[188:191], v2, s[80:83], s86 offen offset:1024 sc1
    v_pk_fma_f32 v[122:123], v[122:123], v[110:111], v[110:111] op_sel_hi:[1,0,0]
    v_pk_fma_f32 v[124:125], v[124:125], v[114:115], v[114:115] op_sel_hi:[1,0,0]
    v_pk_fma_f32 v[126:127], v[126:127], v[118:119], v[118:119] op_sel_hi:[1,0,0]
    v_rcp_f32 v120, v120
    v_rcp_f32 v121, v121
    v_rcp_f32 v122, v122
    v_pk_mul_f32 v[36:37], v[36:37], v[120:121]
    v_rcp_f32 v123, v123
    v_cvt_pk_bf16_f32 v84, v36, v37
    v_rcp_f32 v124, v124
    v_pk_mul_f32 v[48:49], v[48:49], v[122:123]
    v_rcp_f32 v125, v125
    v_cvt_pk_bf16_f32 v85, v48, v49
    v_rcp_f32 v126, v126
    v_pk_mul_f32 v[60:61], v[60:61], v[124:125]
    buffer_load_dwordx4 a[192:195], v2, s[80:83], s86 offen offset:2048 sc1
    v_rcp_f32 v127, v127
    v_cvt_pk_bf16_f32 v86, v60, v61
    v_pk_mul_f32 v[72:73], v[72:73], v[126:127]
    v_cvt_pk_bf16_f32 v87, v72, v73
    v_permlane32_swap_b32 v84, v86
    s_nop 0
    v_permlane32_swap_b32 v85, v87
    s_nop 1
    v_permlane16_swap_b32 v84, v85
    v_permlane16_swap_b32 v86, v87
    buffer_store_dwordx4 v[84:87], v23, s[80:83], s22 offen offset:256 sc1
    v_pk_fma_f32 v[40:41], v[96:97], v[104:105], v[40:41] op_sel_hi:[1,0,1]
    v_pk_mul_f32 v[120:121], v[40:41], v[104:105] op_sel:[0,1] op_sel_hi:[1,1]
    v_pk_fma_f32 v[52:53], v[96:97], v[108:109], v[52:53] op_sel_hi:[1,0,1]
    v_pk_mul_f32 v[122:123], v[52:53], v[108:109] op_sel:[0,1] op_sel_hi:[1,1]
    v_pk_fma_f32 v[64:65], v[96:97], v[112:113], v[64:65] op_sel_hi:[1,0,1]
    v_pk_mul_f32 v[124:125], v[64:65], v[112:113] op_sel:[0,1] op_sel_hi:[1,1]
    v_pk_fma_f32 v[76:77], v[96:97], v[116:117], v[76:77] op_sel_hi:[1,0,1]
    v_pk_mul_f32 v[126:127], v[76:77], v[116:117] op_sel:[0,1] op_sel_hi:[1,1]
    v_exp_f32 v120, v120
    v_pk_fma_f32 v[42:43], v[98:99], v[104:105], v[42:43] op_sel_hi:[1,0,1]
    v_exp_f32 v121, v121
    buffer_load_dwordx4 a[196:199], v2, s[80:83], s86 offen offset:3072 sc1
    v_pk_mul_f32 v[40:41], v[40:41], v[42:43]
    v_exp_f32 v122, v122
    v_pk_fma_f32 v[54:55], v[98:99], v[108:109], v[54:55] op_sel_hi:[1,0,1]
    v_exp_f32 v123, v123
    v_pk_mul_f32 v[52:53], v[52:53], v[54:55]
    v_exp_f32 v124, v124
    v_pk_fma_f32 v[66:67], v[98:99], v[112:113], v[66:67] op_sel_hi:[1,0,1]
    v_exp_f32 v125, v125
    v_pk_mul_f32 v[64:65], v[64:65], v[66:67]
    v_exp_f32 v126, v126
    v_pk_fma_f32 v[78:79], v[98:99], v[116:117], v[78:79] op_sel_hi:[1,0,1]
    v_exp_f32 v127, v127
    v_pk_mul_f32 v[76:77], v[76:77], v[78:79]
    s_add_u32 s86, s59, 49408
    v_pk_fma_f32 v[120:121], v[120:121], v[106:107], v[106:107] op_sel_hi:[1,0,0]
    buffer_load_dwordx4 a[200:203], v2, s[80:83], s86 offen offset:0 sc1
    v_pk_fma_f32 v[122:123], v[122:123], v[110:111], v[110:111] op_sel_hi:[1,0,0]
    v_pk_fma_f32 v[124:125], v[124:125], v[114:115], v[114:115] op_sel_hi:[1,0,0]
    v_pk_fma_f32 v[126:127], v[126:127], v[118:119], v[118:119] op_sel_hi:[1,0,0]
    v_rcp_f32 v120, v120
    v_rcp_f32 v121, v121
    v_rcp_f32 v122, v122
    v_pk_mul_f32 v[40:41], v[40:41], v[120:121]
    v_rcp_f32 v123, v123
    v_cvt_pk_bf16_f32 v80, v40, v41
    v_rcp_f32 v124, v124
    v_pk_mul_f32 v[52:53], v[52:53], v[122:123]
    v_rcp_f32 v125, v125
    v_cvt_pk_bf16_f32 v81, v52, v53
    v_rcp_f32 v126, v126
    v_pk_mul_f32 v[64:65], v[64:65], v[124:125]
    buffer_load_dwordx4 a[204:207], v2, s[80:83], s86 offen offset:1024 sc1
    v_rcp_f32 v127, v127
    v_cvt_pk_bf16_f32 v82, v64, v65
    v_pk_mul_f32 v[76:77], v[76:77], v[126:127]
    v_cvt_pk_bf16_f32 v83, v76, v77
    v_permlane32_swap_b32 v80, v82
    s_nop 0
    v_permlane32_swap_b32 v81, v83
    s_nop 1
    v_permlane16_swap_b32 v80, v81
    v_permlane16_swap_b32 v82, v83
    buffer_store_dwordx4 v[80:83], v23, s[80:83], s22 offen offset:512 sc1
    s_add_u32 s22, s22, 3162112
    s_nop 1
    s_waitcnt vmcnt(29)
    v_mfma_f32_16x16x32_bf16 v[32:35], v[148:151], a[120:123], 0
    v_mfma_f32_16x16x32_bf16 v[36:39], v[152:155], a[120:123], 0
    v_mfma_f32_16x16x32_bf16 v[40:43], v[156:159], a[120:123], 0
    v_mfma_f32_16x16x32_bf16 v[44:47], v[160:163], a[120:123], 0
    buffer_load_dwordx4 a[208:211], v2, s[80:83], s86 offen offset:2048 sc1
    v_mfma_f32_16x16x32_bf16 v[48:51], v[164:167], a[120:123], 0
    s_waitcnt vmcnt(29)
    v_mfma_f32_16x16x32_bf16 v[32:35], v[168:171], a[124:127], v[32:35]
    v_mfma_f32_16x16x32_bf16 v[36:39], v[172:175], a[124:127], v[36:39]
    v_mfma_f32_16x16x32_bf16 v[40:43], v[176:179], a[124:127], v[40:43]
    v_mfma_f32_16x16x32_bf16 v[44:47], v[180:183], a[124:127], v[44:47]
    buffer_load_dwordx4 a[212:215], v2, s[80:83], s86 offen offset:3072 sc1
    v_mfma_f32_16x16x32_bf16 v[48:51], v[184:187], a[124:127], v[48:51]
    s_waitcnt vmcnt(29)
    v_mfma_f32_16x16x32_bf16 v[32:35], v[188:191], a[128:131], v[32:35]
    v_mfma_f32_16x16x32_bf16 v[36:39], v[192:195], a[128:131], v[36:39]
    v_mfma_f32_16x16x32_bf16 v[40:43], v[196:199], a[128:131], v[40:43]
    v_mfma_f32_16x16x32_bf16 v[44:47], v[200:203], a[128:131], v[44:47]
    v_mfma_f32_16x16x32_bf16 v[48:51], v[204:207], a[128:131], v[48:51]
    s_waitcnt vmcnt(28)
    v_mfma_f32_16x16x32_bf16 v[32:35], v[208:211], a[132:135], v[32:35]
    v_mfma_f32_16x16x32_bf16 v[36:39], v[212:215], a[132:135], v[36:39]
    v_mfma_f32_16x16x32_bf16 v[40:43], v[216:219], a[132:135], v[40:43]
    v_mfma_f32_16x16x32_bf16 v[44:47], v[220:223], a[132:135], v[44:47]
    v_mfma_f32_16x16x32_bf16 v[48:51], v[224:227], a[132:135], v[48:51]
    s_waitcnt vmcnt(27)
    v_mfma_f32_16x16x32_bf16 v[32:35], v[228:231], a[136:139], v[32:35]
    v_mfma_f32_16x16x32_bf16 v[36:39], v[232:235], a[136:139], v[36:39]
    v_mfma_f32_16x16x32_bf16 v[40:43], v[236:239], a[136:139], v[40:43]
    v_mfma_f32_16x16x32_bf16 v[44:47], v[240:243], a[136:139], v[44:47]
    v_mfma_f32_16x16x32_bf16 v[48:51], v[244:247], a[136:139], v[48:51]
    s_waitcnt vmcnt(26)
    v_mfma_f32_16x16x32_bf16 v[32:35], v[248:251], a[140:143], v[32:35]
    v_mfma_f32_16x16x32_bf16 v[36:39], a[240:243], a[140:143], v[36:39]
    v_mfma_f32_16x16x32_bf16 v[40:43], a[244:247], a[140:143], v[40:43]
    v_mfma_f32_16x16x32_bf16 v[44:47], a[248:251], a[140:143], v[44:47]
    v_mfma_f32_16x16x32_bf16 v[48:51], a[252:255], a[140:143], v[48:51]
    s_waitcnt vmcnt(25)
    v_mfma_f32_16x16x32_bf16 v[32:35], a[0:3], a[144:147], v[32:35]
    v_mfma_f32_16x16x32_bf16 v[36:39], a[4:7], a[144:147], v[36:39]
    v_mfma_f32_16x16x32_bf16 v[40:43], a[8:11], a[144:147], v[40:43]
    v_mfma_f32_16x16x32_bf16 v[44:47], a[12:15], a[144:147], v[44:47]
    v_mfma_f32_16x16x32_bf16 v[48:51], a[16:19], a[144:147], v[48:51]
    s_waitcnt vmcnt(24)
    v_mfma_f32_16x16x32_bf16 v[32:35], a[20:23], a[148:151], v[32:35]
    v_mfma_f32_16x16x32_bf16 v[36:39], a[24:27], a[148:151], v[36:39]
    v_mfma_f32_16x16x32_bf16 v[40:43], a[28:31], a[148:151], v[40:43]
    v_mfma_f32_16x16x32_bf16 v[44:47], a[32:35], a[148:151], v[44:47]
    v_mfma_f32_16x16x32_bf16 v[48:51], a[36:39], a[148:151], v[48:51]
    s_waitcnt vmcnt(23)
    v_mfma_f32_16x16x32_bf16 v[32:35], a[40:43], a[152:155], v[32:35]
    v_lshlrev_b32 v104, 16, v136
    v_and_b32 v105, s10, v136
    v_mfma_f32_16x16x32_bf16 v[36:39], a[44:47], a[152:155], v[36:39]
    v_lshlrev_b32 v106, 16, v137
    v_mfma_f32_16x16x32_bf16 v[40:43], a[48:51], a[152:155], v[40:43]
    v_and_b32 v107, s10, v137
    v_mfma_f32_16x16x32_bf16 v[44:47], a[52:55], a[152:155], v[44:47]
    v_lshlrev_b32 v108, 16, v140
    v_mfma_f32_16x16x32_bf16 v[48:51], a[56:59], a[152:155], v[48:51]
    v_and_b32 v109, s10, v140
    s_waitcnt vmcnt(22)
    v_mfma_f32_16x16x32_bf16 v[32:35], a[60:63], a[156:159], v[32:35]
    v_lshlrev_b32 v110, 16, v141
    v_mfma_f32_16x16x32_bf16 v[36:39], a[64:67], a[156:159], v[36:39]
    v_and_b32 v111, s10, v141
    v_mfma_f32_16x16x32_bf16 v[40:43], a[68:71], a[156:159], v[40:43]
    s_add_u32 s12, s95, 0
    v_mfma_f32_16x16x32_bf16 v[44:47], a[72:75], a[156:159], v[44:47]
    s_add_u32 s13, s100, 128
    v_mfma_f32_16x16x32_bf16 v[48:51], a[76:79], a[156:159], v[48:51]
    s_cmp_eq_u32 s3, 0
    s_cselect_b32 s13, s13, 0x7ff00000
    s_waitcnt vmcnt(21)
    v_mfma_f32_16x16x32_bf16 v[32:35], a[80:83], a[160:163], v[32:35]
    s_waitcnt vmcnt(2)
    s_barrier
    s_mov_b32 s43, 81920
    s_mov_b64 exec, 1
    buffer_atomic_swap v6, v3, s[80:83], s43 offen sc1
    s_mov_b64 exec, -1
    v_mfma_f32_16x16x32_bf16 v[36:39], a[84:87], a[160:163], v[36:39]
    v_lshlrev_b32 v112, 16, v138
    v_and_b32 v113, s10, v138
    v_mfma_f32_16x16x32_bf16 v[40:43], a[88:91], a[160:163], v[40:43]
    v_lshlrev_b32 v114, 16, v139
    v_mfma_f32_16x16x32_bf16 v[44:47], a[92:95], a[160:163], v[44:47]
    v_and_b32 v115, s10, v139
    v_mfma_f32_16x16x32_bf16 v[48:51], a[96:99], a[160:163], v[48:51]
    v_lshlrev_b32 v116, 16, v140
    v_mfma_f32_16x16x32_bf16 v[32:35], a[100:103], a[164:167], v[32:35]
    v_and_b32 v117, s10, v140
    v_lshlrev_b32 v118, 16, v141
    v_mfma_f32_16x16x32_bf16 v[36:39], a[104:107], a[164:167], v[36:39]
    v_and_b32 v119, s10, v141
    v_mfma_f32_16x16x32_bf16 v[40:43], a[108:111], a[164:167], v[40:43]
    s_add_u32 s14, s95, 20480
    v_mfma_f32_16x16x32_bf16 v[44:47], a[112:115], a[164:167], v[44:47]
    s_add_u32 s15, s100, 20608
    v_mfma_f32_16x16x32_bf16 v[48:51], a[116:119], a[164:167], v[48:51]
    s_cmp_eq_u32 s3, 1
    s_cselect_b32 s15, s15, 0x7ff00000
    v_mfma_f32_16x16x32_bf16 v[52:55], v[148:151], a[168:171], 0
    v_mfma_f32_16x16x32_bf16 v[52:55], v[168:171], a[172:175], v[52:55]
    v_mfma_f32_16x16x32_bf16 v[52:55], v[188:191], a[176:179], v[52:55]
    ds_write_b128 v25, v[32:35] offset:0
    v_mfma_f32_16x16x32_bf16 v[52:55], v[208:211], a[180:183], v[52:55]
    v_mfma_f32_16x16x32_bf16 v[52:55], v[228:231], a[184:187], v[52:55]
    v_mfma_f32_16x16x32_bf16 v[52:55], v[248:251], a[188:191], v[52:55]
    v_mfma_f32_16x16x32_bf16 v[52:55], a[0:3], a[192:195], v[52:55]
    ds_write_b128 v25, v[36:39] offset:1024
    v_mfma_f32_16x16x32_bf16 v[52:55], a[20:23], a[196:199], v[52:55]
    v_mfma_f32_16x16x32_bf16 v[52:55], a[40:43], a[200:203], v[52:55]
    v_mfma_f32_16x16x32_bf16 v[52:55], a[60:63], a[204:207], v[52:55]
    s_waitcnt vmcnt(2)
    v_mfma_f32_16x16x32_bf16 v[52:55], a[80:83], a[208:211], v[52:55]
    ds_write_b128 v25, v[40:43] offset:2048
    s_waitcnt vmcnt(1)
    v_mfma_f32_16x16x32_bf16 v[52:55], a[100:103], a[212:215], v[52:55]
    v_mfma_f32_16x16x32_bf16 v[56:59], v[152:155], a[168:171], 0
    v_mfma_f32_16x16x32_bf16 v[56:59], v[172:175], a[172:175], v[56:59]
    v_mfma_f32_16x16x32_bf16 v[56:59], v[192:195], a[176:179], v[56:59]
    ds_write_b128 v25, v[44:47] offset:3072
    v_mfma_f32_16x16x32_bf16 v[56:59], v[212:215], a[180:183], v[56:59]
    v_mfma_f32_16x16x32_bf16 v[56:59], v[232:235], a[184:187], v[56:59]
    v_mfma_f32_16x16x32_bf16 v[56:59], a[240:243], a[188:191], v[56:59]
    v_mfma_f32_16x16x32_bf16 v[56:59], a[4:7], a[192:195], v[56:59]
    ds_write_b128 v25, v[48:51] offset:4096
    v_mfma_f32_16x16x32_bf16 v[56:59], a[24:27], a[196:199], v[56:59]
    v_mfma_f32_16x16x32_bf16 v[56:59], a[44:47], a[200:203], v[56:59]
    v_mfma_f32_16x16x32_bf16 v[56:59], a[64:67], a[204:207], v[56:59]
    v_mfma_f32_16x16x32_bf16 v[56:59], a[84:87], a[208:211], v[56:59]
    ds_write_b128 v25, v[52:55] offset:20480
    v_mfma_f32_16x16x32_bf16 v[56:59], a[104:107], a[212:215], v[56:59]
    v_mfma_f32_16x16x32_bf16 v[60:63], v[156:159], a[168:171], 0
    s_waitcnt lgkmcnt(0)
    s_barrier
    v_mfma_f32_16x16x32_bf16 v[60:63], v[176:179], a[172:175], v[60:63]
    ds_read_b128 v[72:75], v26 offset:0
    v_mfma_f32_16x16x32_bf16 v[60:63], v[196:199], a[176:179], v[60:63]
    ds_read_b128 v[76:79], v26 offset:5120
    v_mfma_f32_16x16x32_bf16 v[60:63], v[216:219], a[180:183], v[60:63]
    ds_read_b128 v[80:83], v26 offset:10240
    v_mfma_f32_16x16x32_bf16 v[60:63], v[236:239], a[184:187], v[60:63]
    ds_read_b128 v[84:87], v26 offset:15360
    v_mfma_f32_16x16x32_bf16 v[60:63], a[244:247], a[188:191], v[60:63]
    v_mfma_f32_16x16x32_bf16 v[60:63], a[8:11], a[192:195], v[60:63]
    ds_read_b128 v[88:91], v2 offset:4096
    v_mfma_f32_16x16x32_bf16 v[60:63], a[28:31], a[196:199], v[60:63]
    ds_read_b128 v[92:95], v2 offset:9216
    v_mfma_f32_16x16x32_bf16 v[60:63], a[48:51], a[200:203], v[60:63]
    ds_write_b128 v25, v[56:59] offset:21504
    v_mfma_f32_16x16x32_bf16 v[60:63], a[68:71], a[204:207], v[60:63]
    ds_read_b128 v[96:99], v2 offset:14336
    v_mfma_f32_16x16x32_bf16 v[60:63], a[88:91], a[208:211], v[60:63]
    ds_read_b128 v[100:103], v2 offset:19456
    v_mfma_f32_16x16x32_bf16 v[60:63], a[108:111], a[212:215], v[60:63]
    v_mfma_f32_16x16x32_bf16 v[64:67], v[160:163], a[168:171], 0
    s_waitcnt lgkmcnt(8)
    v_add_f32 v104, v104, v72
    v_add_f32 v105, v105, v73
    v_mfma_f32_16x16x32_bf16 v[64:67], v[180:183], a[172:175], v[64:67]
    v_add_f32 v106, v106, v74
    v_add_f32 v107, v107, v75
    v_mfma_f32_16x16x32_bf16 v[64:67], v[200:203], a[176:179], v[64:67]
    s_waitcnt lgkmcnt(7)
    v_add_f32 v104, v104, v76
    v_add_f32 v105, v105, v77
    v_mfma_f32_16x16x32_bf16 v[64:67], v[220:223], a[180:183], v[64:67]
    v_add_f32 v106, v106, v78
    v_mfma_f32_16x16x32_bf16 v[64:67], v[240:243], a[184:187], v[64:67]
    v_add_f32 v107, v107, v79
    s_waitcnt lgkmcnt(6)
    v_add_f32 v104, v104, v80
    v_mfma_f32_16x16x32_bf16 v[64:67], a[248:251], a[188:191], v[64:67]
    v_add_f32 v105, v105, v81
    v_add_f32 v106, v106, v82
    v_mfma_f32_16x16x32_bf16 v[64:67], a[12:15], a[192:195], v[64:67]
    v_add_f32 v107, v107, v83
    s_waitcnt lgkmcnt(5)
    v_add_f32 v104, v104, v84
    v_mfma_f32_16x16x32_bf16 v[64:67], a[32:35], a[196:199], v[64:67]
    v_add_f32 v105, v105, v85
    v_mfma_f32_16x16x32_bf16 v[64:67], a[52:55], a[200:203], v[64:67]
    ds_write_b128 v25, v[60:63] offset:22528
    v_mfma_f32_16x16x32_bf16 v[64:67], a[72:75], a[204:207], v[64:67]
    v_add_f32 v106, v106, v86
    v_add_f32 v107, v107, v87
    v_mfma_f32_16x16x32_bf16 v[64:67], a[92:95], a[208:211], v[64:67]
    v_cvt_pk_bf16_f32 v72, v104, v105
    v_cvt_pk_bf16_f32 v73, v106, v107
    v_mfma_f32_16x16x32_bf16 v[64:67], a[112:115], a[212:215], v[64:67]
    buffer_store_dwordx2 v[72:73], v27, s[76:79], s12 offen
    v_mfma_f32_16x16x32_bf16 v[68:71], v[164:167], a[168:171], 0
    s_waitcnt lgkmcnt(5)
    v_add_f32 v108, v108, v88
    v_add_f32 v109, v109, v89
    v_mfma_f32_16x16x32_bf16 v[68:71], v[184:187], a[172:175], v[68:71]
    v_add_f32 v110, v110, v90
    v_add_f32 v111, v111, v91
    v_mfma_f32_16x16x32_bf16 v[68:71], v[204:207], a[176:179], v[68:71]
    s_waitcnt lgkmcnt(4)
    v_add_f32 v108, v108, v92
    v_add_f32 v109, v109, v93
    v_mfma_f32_16x16x32_bf16 v[68:71], v[224:227], a[180:183], v[68:71]
    v_add_f32 v110, v110, v94
    v_mfma_f32_16x16x32_bf16 v[68:71], v[244:247], a[184:187], v[68:71]
    v_add_f32 v111, v111, v95
    s_waitcnt lgkmcnt(2)
    v_add_f32 v108, v108, v96
    v_mfma_f32_16x16x32_bf16 v[68:71], a[252:255], a[188:191], v[68:71]
    v_add_f32 v109, v109, v97
    v_add_f32 v110, v110, v98
    v_mfma_f32_16x16x32_bf16 v[68:71], a[16:19], a[192:195], v[68:71]
    v_add_f32 v111, v111, v99
    s_waitcnt lgkmcnt(1)
    v_add_f32 v108, v108, v100
    v_mfma_f32_16x16x32_bf16 v[68:71], a[36:39], a[196:199], v[68:71]
    v_add_f32 v109, v109, v101
    v_mfma_f32_16x16x32_bf16 v[68:71], a[56:59], a[200:203], v[68:71]
    ds_write_b128 v25, v[64:67] offset:23552
    v_mfma_f32_16x16x32_bf16 v[68:71], a[76:79], a[204:207], v[68:71]
    v_add_f32 v110, v110, v102
    v_add_f32 v111, v111, v103
    v_mfma_f32_16x16x32_bf16 v[68:71], a[96:99], a[208:211], v[68:71]
    v_cvt_pk_bf16_f32 v88, v108, v109
    v_cvt_pk_bf16_f32 v89, v110, v111
    v_mfma_f32_16x16x32_bf16 v[68:71], a[116:119], a[212:215], v[68:71]
    buffer_store_dwordx2 v[88:89], v27, s[76:79], s13 offen
    s_mov_b32 s27, 81920
    buffer_load_dwordx4 v[252:255], v7, s[80:83], s27 offen sc1
    s_nop 4
    ds_write_b128 v25, v[68:71] offset:24576
    s_waitcnt lgkmcnt(0)
    s_barrier
    ds_read_b128 v[72:75], v26 offset:20480
    ds_read_b128 v[76:79], v26 offset:25600
    ds_read_b128 v[80:83], v26 offset:30720
    ds_read_b128 v[84:87], v26 offset:35840
    ds_read_b128 v[88:91], v2 offset:24576
    ds_read_b128 v[92:95], v2 offset:29696
    ds_read_b128 v[96:99], v2 offset:34816
    ds_read_b128 v[100:103], v2 offset:39936
    s_waitcnt lgkmcnt(7)
    v_pk_add_f32 v[112:113], v[112:113], v[72:73]
    v_pk_add_f32 v[114:115], v[114:115], v[74:75]
    s_waitcnt lgkmcnt(5)
    v_pk_add_f32 v[76:77], v[76:77], v[80:81]
    v_pk_add_f32 v[78:79], v[78:79], v[82:83]
    s_waitcnt lgkmcnt(4)
    v_pk_add_f32 v[112:113], v[112:113], v[84:85]
    v_pk_add_f32 v[114:115], v[114:115], v[86:87]
    v_pk_add_f32 v[112:113], v[112:113], v[76:77]
    v_pk_add_f32 v[114:115], v[114:115], v[78:79]
    v_cvt_pk_bf16_f32 v72, v112, v113
    v_cvt_pk_bf16_f32 v73, v114, v115
    buffer_store_dwordx2 v[72:73], v27, s[76:79], s14 offen
    s_waitcnt lgkmcnt(3)
    v_pk_add_f32 v[116:117], v[116:117], v[88:89]
    v_pk_add_f32 v[118:119], v[118:119], v[90:91]
    s_waitcnt lgkmcnt(1)
    v_pk_add_f32 v[92:93], v[92:93], v[96:97]
    v_pk_add_f32 v[94:95], v[94:95], v[98:99]
    s_waitcnt lgkmcnt(0)
    v_pk_add_f32 v[116:117], v[116:117], v[100:101]
    v_pk_add_f32 v[118:119], v[118:119], v[102:103]
    v_pk_add_f32 v[116:117], v[116:117], v[92:93]
    v_pk_add_f32 v[118:119], v[118:119], v[94:95]
    v_cvt_pk_bf16_f32 v88, v116, v117
    v_cvt_pk_bf16_f32 v89, v118, v119
    buffer_store_dwordx2 v[88:89], v27, s[76:79], s15 offen
    s_waitcnt vmcnt(2)
    v_cmp_eq_u64 vcc, s[92:93], v[252:253]
    v_cmp_eq_u64 s[30:31], s[92:93], v[254:255]
    s_nop 0
    s_and_b64 vcc, vcc, s[30:31]
    s_cmp_eq_u64 vcc, -1
    s_cbranch_scc1 L_ok_34
    s_mov_b32 s11, 0x20000
L_poll_35:
    buffer_load_dwordx4 v[252:255], v7, s[80:83], s27 offen sc1
    s_waitcnt vmcnt(0)
    v_cmp_eq_u64 vcc, s[92:93], v[252:253]
    v_cmp_eq_u64 s[30:31], s[92:93], v[254:255]
    s_nop 0
    s_and_b64 vcc, vcc, s[30:31]
    s_cmp_eq_u64 vcc, -1
    s_cbranch_scc1 L_polld_36
    s_sub_u32 s11, s11, 1
    s_cbranch_scc0 L_poll_35
L_polld_36:
L_ok_34:
    s_add_u32 s86, s57, 3162112
    buffer_load_dwordx4 a[120:123], v2, s[80:83], s86 offen offset:0 sc1
    buffer_load_dwordx4 a[124:127], v2, s[80:83], s86 offen offset:1024 sc1
    buffer_load_dwordx4 a[128:131], v2, s[80:83], s86 offen offset:2048 sc1
    buffer_load_dwordx4 a[132:135], v2, s[80:83], s86 offen offset:3072 sc1
    s_add_u32 s86, s58, 3162112
    buffer_load_dwordx4 a[136:139], v2, s[80:83], s86 offen offset:0 sc1
    buffer_load_dwordx4 a[140:143], v2, s[80:83], s86 offen offset:1024 sc1
    buffer_load_dwordx4 a[144:147], v2, s[80:83], s86 offen offset:2048 sc1
    buffer_load_dwordx4 a[148:151], v2, s[80:83], s86 offen offset:3072 sc1
    s_waitcnt vmcnt(7)
    v_mfma_f32_16x16x32_bf16 v[32:35], v[148:151], a[120:123], 0
    v_mfma_f32_16x16x32_bf16 v[36:39], v[152:155], a[120:123], 0
    s_add_u32 s86, s59, 3162112
    v_mfma_f32_16x16x32_bf16 v[40:43], v[156:159], a[120:123], 0
    buffer_load_dwordx4 a[152:155], v2, s[80:83], s86 offen offset:0 sc1
    v_mfma_f32_16x16x32_bf16 v[44:47], v[160:163], a[120:123], 0
    v_mfma_f32_16x16x32_bf16 v[48:51], v[164:167], a[120:123], 0
    s_waitcnt vmcnt(7)
    v_mfma_f32_16x16x32_bf16 v[32:35], v[168:171], a[124:127], v[32:35]
    buffer_load_dwordx4 a[156:159], v2, s[80:83], s86 offen offset:1024 sc1
    v_mfma_f32_16x16x32_bf16 v[36:39], v[172:175], a[124:127], v[36:39]
    v_mfma_f32_16x16x32_bf16 v[40:43], v[176:179], a[124:127], v[40:43]
    v_mfma_f32_16x16x32_bf16 v[44:47], v[180:183], a[124:127], v[44:47]
    v_mfma_f32_16x16x32_bf16 v[48:51], v[184:187], a[124:127], v[48:51]
    buffer_load_dwordx4 a[160:163], v2, s[80:83], s86 offen offset:2048 sc1
    s_waitcnt vmcnt(8)
    v_mfma_f32_16x16x32_bf16 v[32:35], v[188:191], a[128:131], v[32:35]
    v_mfma_f32_16x16x32_bf16 v[36:39], v[192:195], a[128:131], v[36:39]
    v_mfma_f32_16x16x32_bf16 v[40:43], v[196:199], a[128:131], v[40:43]
    buffer_load_dwordx4 a[164:167], v2, s[80:83], s86 offen offset:3072 sc1
    v_mfma_f32_16x16x32_bf16 v[44:47], v[200:203], a[128:131], v[44:47]
    v_mfma_f32_16x16x32_bf16 v[48:51], v[204:207], a[128:131], v[48:51]
    s_add_u32 s86, s57, 3211520
    s_waitcnt vmcnt(8)
    v_mfma_f32_16x16x32_bf16 v[32:35], v[208:211], a[132:135], v[32:35]
    buffer_load_dwordx4 a[168:171], v2, s[80:83], s86 offen offset:0 sc1
    v_mfma_f32_16x16x32_bf16 v[36:39], v[212:215], a[132:135], v[36:39]
    v_mfma_f32_16x16x32_bf16 v[40:43], v[216:219], a[132:135], v[40:43]
    v_mfma_f32_16x16x32_bf16 v[44:47], v[220:223], a[132:135], v[44:47]
    v_mfma_f32_16x16x32_bf16 v[48:51], v[224:227], a[132:135], v[48:51]
    buffer_load_dwordx4 a[172:175], v2, s[80:83], s86 offen offset:1024 sc1
    s_waitcnt vmcnt(9)
    v_mfma_f32_16x16x32_bf16 v[32:35], v[228:231], a[136:139], v[32:35]
    v_mfma_f32_16x16x32_bf16 v[36:39], v[232:235], a[136:139], v[36:39]
    v_mfma_f32_16x16x32_bf16 v[40:43], v[236:239], a[136:139], v[40:43]
    buffer_load_dwordx4 a[176:179], v2, s[80:83], s86 offen offset:2048 sc1
    v_mfma_f32_16x16x32_bf16 v[44:47], v[240:243], a[136:139], v[44:47]
    v_mfma_f32_16x16x32_bf16 v[48:51], v[244:247], a[136:139], v[48:51]
    s_waitcnt vmcnt(9)
    v_mfma_f32_16x16x32_bf16 v[32:35], v[248:251], a[140:143], v[32:35]
    buffer_load_dwordx4 a[180:183], v2, s[80:83], s86 offen offset:3072 sc1
    v_mfma_f32_16x16x32_bf16 v[36:39], a[240:243], a[140:143], v[36:39]
    v_mfma_f32_16x16x32_bf16 v[40:43], a[244:247], a[140:143], v[40:43]
    v_mfma_f32_16x16x32_bf16 v[44:47], a[248:251], a[140:143], v[44:47]
    s_add_u32 s86, s58, 3211520
    v_mfma_f32_16x16x32_bf16 v[48:51], a[252:255], a[140:143], v[48:51]
    buffer_load_dwordx4 a[184:187], v2, s[80:83], s86 offen offset:0 sc1
    s_waitcnt vmcnt(10)
    v_mfma_f32_16x16x32_bf16 v[32:35], a[0:3], a[144:147], v[32:35]
    v_mfma_f32_16x16x32_bf16 v[36:39], a[4:7], a[144:147], v[36:39]
    v_mfma_f32_16x16x32_bf16 v[40:43], a[8:11], a[144:147], v[40:43]
    buffer_load_dwordx4 a[188:191], v2, s[80:83], s86 offen offset:1024 sc1
    v_mfma_f32_16x16x32_bf16 v[44:47], a[12:15], a[144:147], v[44:47]
    v_mfma_f32_16x16x32_bf16 v[48:51], a[16:19], a[144:147], v[48:51]
    s_waitcnt vmcnt(10)
    v_mfma_f32_16x16x32_bf16 v[32:35], a[20:23], a[148:151], v[32:35]
    buffer_load_dwordx4 a[192:195], v2, s[80:83], s86 offen offset:2048 sc1
    v_mfma_f32_16x16x32_bf16 v[36:39], a[24:27], a[148:151], v[36:39]
    v_mfma_f32_16x16x32_bf16 v[40:43], a[28:31], a[148:151], v[40:43]
    v_mfma_f32_16x16x32_bf16 v[44:47], a[32:35], a[148:151], v[44:47]
    v_mfma_f32_16x16x32_bf16 v[48:51], a[36:39], a[148:151], v[48:51]
    buffer_load_dwordx4 a[196:199], v2, s[80:83], s86 offen offset:3072 sc1
    s_waitcnt vmcnt(11)
    v_mfma_f32_16x16x32_bf16 v[32:35], a[40:43], a[152:155], v[32:35]
    v_lshlrev_b32 v104, 16, v142
    v_and_b32 v105, s10, v142
    v_mfma_f32_16x16x32_bf16 v[36:39], a[44:47], a[152:155], v[36:39]
    v_lshlrev_b32 v106, 16, v143
    s_add_u32 s86, s59, 3211520
    v_mfma_f32_16x16x32_bf16 v[40:43], a[48:51], a[152:155], v[40:43]
    buffer_load_dwordx4 a[200:203], v2, s[80:83], s86 offen offset:0 sc1
    v_mfma_f32_16x16x32_bf16 v[44:47], a[52:55], a[152:155], v[44:47]
    v_and_b32 v107, s10, v143
    v_lshlrev_b32 v108, 16, v146
    v_mfma_f32_16x16x32_bf16 v[48:51], a[56:59], a[152:155], v[48:51]
    v_and_b32 v109, s10, v146
    s_waitcnt vmcnt(11)
    v_mfma_f32_16x16x32_bf16 v[32:35], a[60:63], a[156:159], v[32:35]
    buffer_load_dwordx4 a[204:207], v2, s[80:83], s86 offen offset:1024 sc1
    v_mfma_f32_16x16x32_bf16 v[36:39], a[64:67], a[156:159], v[36:39]
    v_lshlrev_b32 v110, 16, v147
    v_and_b32 v111, s10, v147
    v_mfma_f32_16x16x32_bf16 v[40:43], a[68:71], a[156:159], v[40:43]
    s_add_u32 s12, s95, 1310720
    s_add_u32 s13, s100, 1310848
    v_mfma_f32_16x16x32_bf16 v[44:47], a[72:75], a[156:159], v[44:47]
    s_cmp_eq_u32 s3, 2
    s_cselect_b32 s13, s13, 0x7ff00000
    v_mfma_f32_16x16x32_bf16 v[48:51], a[76:79], a[156:159], v[48:51]
    buffer_load_dwordx4 a[208:211], v2, s[80:83], s86 offen offset:2048 sc1
    s_waitcnt vmcnt(12)
    v_mfma_f32_16x16x32_bf16 v[32:35], a[80:83], a[160:163], v[32:35]
    v_lshlrev_b32 v112, 16, v144
    v_and_b32 v113, s10, v144
    v_mfma_f32_16x16x32_bf16 v[36:39], a[84:87], a[160:163], v[36:39]
    v_lshlrev_b32 v114, 16, v145
    v_mfma_f32_16x16x32_bf16 v[40:43], a[88:91], a[160:163], v[40:43]
    v_and_b32 v115, s10, v145
    v_mfma_f32_16x16x32_bf16 v[44:47], a[92:95], a[160:163], v[44:47]
    v_lshlrev_b32 v116, 16, v146
    v_mfma_f32_16x16x32_bf16 v[48:51], a[96:99], a[160:163], v[48:51]
    v_and_b32 v117, s10, v146
    v_lshlrev_b32 v118, 16, v147
    s_waitcnt vmcnt(11)
    v_mfma_f32_16x16x32_bf16 v[32:35], a[100:103], a[164:167], v[32:35]
    v_and_b32 v119, s10, v147
    v_mfma_f32_16x16x32_bf16 v[36:39], a[104:107], a[164:167], v[36:39]
    s_add_u32 s14, s95, 1331200
    v_mfma_f32_16x16x32_bf16 v[40:43], a[108:111], a[164:167], v[40:43]
    buffer_load_dwordx4 a[212:215], v2, s[80:83], s86 offen offset:3072 sc1
    v_mfma_f32_16x16x32_bf16 v[44:47], a[112:115], a[164:167], v[44:47]
    s_add_u32 s15, s100, 1331328
    v_mfma_f32_16x16x32_bf16 v[48:51], a[116:119], a[164:167], v[48:51]
    s_cmp_eq_u32 s3, 3
    s_cselect_b32 s15, s15, 0x7ff00000
    s_waitcnt vmcnt(11)
    v_mfma_f32_16x16x32_bf16 v[52:55], v[148:151], a[168:171], 0
    v_mfma_f32_16x16x32_bf16 v[56:59], v[152:155], a[168:171], 0
    v_mfma_f32_16x16x32_bf16 v[60:63], v[156:159], a[168:171], 0
    ds_write_b128 v25, v[32:35] offset:0
    v_mfma_f32_16x16x32_bf16 v[64:67], v[160:163], a[168:171], 0
    v_mfma_f32_16x16x32_bf16 v[68:71], v[164:167], a[168:171], 0
    s_waitcnt vmcnt(10)
    v_mfma_f32_16x16x32_bf16 v[52:55], v[168:171], a[172:175], v[52:55]
    v_mfma_f32_16x16x32_bf16 v[56:59], v[172:175], a[172:175], v[56:59]
    ds_write_b128 v25, v[36:39] offset:1024
    v_mfma_f32_16x16x32_bf16 v[60:63], v[176:179], a[172:175], v[60:63]
    v_mfma_f32_16x16x32_bf16 v[64:67], v[180:183], a[172:175], v[64:67]
    v_mfma_f32_16x16x32_bf16 v[68:71], v[184:187], a[172:175], v[68:71]
    s_waitcnt vmcnt(9)
    v_mfma_f32_16x16x32_bf16 v[52:55], v[188:191], a[176:179], v[52:55]
    ds_write_b128 v25, v[40:43] offset:2048
    v_mfma_f32_16x16x32_bf16 v[56:59], v[192:195], a[176:179], v[56:59]
    v_mfma_f32_16x16x32_bf16 v[60:63], v[196:199], a[176:179], v[60:63]
    v_mfma_f32_16x16x32_bf16 v[64:67], v[200:203], a[176:179], v[64:67]
    v_mfma_f32_16x16x32_bf16 v[68:71], v[204:207], a[176:179], v[68:71]
    s_waitcnt vmcnt(8)
    v_mfma_f32_16x16x32_bf16 v[52:55], v[208:211], a[180:183], v[52:55]
    v_mfma_f32_16x16x32_bf16 v[56:59], v[212:215], a[180:183], v[56:59]
    ds_write_b128 v25, v[44:47] offset:3072
    v_mfma_f32_16x16x32_bf16 v[60:63], v[216:219], a[180:183], v[60:63]
    v_mfma_f32_16x16x32_bf16 v[64:67], v[220:223], a[180:183], v[64:67]
    v_mfma_f32_16x16x32_bf16 v[68:71], v[224:227], a[180:183], v[68:71]
    s_waitcnt vmcnt(7)
    v_mfma_f32_16x16x32_bf16 v[52:55], v[228:231], a[184:187], v[52:55]
    v_mfma_f32_16x16x32_bf16 v[56:59], v[232:235], a[184:187], v[56:59]
    v_mfma_f32_16x16x32_bf16 v[60:63], v[236:239], a[184:187], v[60:63]
    ds_write_b128 v25, v[48:51] offset:4096
    v_mfma_f32_16x16x32_bf16 v[64:67], v[240:243], a[184:187], v[64:67]
    v_mfma_f32_16x16x32_bf16 v[68:71], v[244:247], a[184:187], v[68:71]
    s_waitcnt lgkmcnt(0)
    s_barrier
    s_waitcnt vmcnt(6)
    v_mfma_f32_16x16x32_bf16 v[52:55], v[248:251], a[188:191], v[52:55]
    ds_read_b128 v[72:75], v26 offset:0
    v_mfma_f32_16x16x32_bf16 v[56:59], a[240:243], a[188:191], v[56:59]
    ds_read_b128 v[76:79], v26 offset:5120
    v_mfma_f32_16x16x32_bf16 v[60:63], a[244:247], a[188:191], v[60:63]
    v_mfma_f32_16x16x32_bf16 v[64:67], a[248:251], a[188:191], v[64:67]
    ds_read_b128 v[80:83], v26 offset:10240
    v_mfma_f32_16x16x32_bf16 v[68:71], a[252:255], a[188:191], v[68:71]
    ds_read_b128 v[84:87], v26 offset:15360
    s_waitcnt vmcnt(5)
    v_mfma_f32_16x16x32_bf16 v[52:55], a[0:3], a[192:195], v[52:55]
    ds_read_b128 v[88:91], v2 offset:4096
    s_waitcnt vmcnt(4)
    v_mfma_f32_16x16x32_bf16 v[52:55], a[20:23], a[196:199], v[52:55]
    s_waitcnt vmcnt(3)
    v_mfma_f32_16x16x32_bf16 v[52:55], a[40:43], a[200:203], v[52:55]
    ds_read_b128 v[92:95], v2 offset:9216
    s_waitcnt vmcnt(2)
    v_mfma_f32_16x16x32_bf16 v[52:55], a[60:63], a[204:207], v[52:55]
    ds_read_b128 v[96:99], v2 offset:14336
    s_waitcnt vmcnt(1)
    v_mfma_f32_16x16x32_bf16 v[52:55], a[80:83], a[208:211], v[52:55]
    ds_read_b128 v[100:103], v2 offset:19456
    s_waitcnt vmcnt(0)
    v_mfma_f32_16x16x32_bf16 v[52:55], a[100:103], a[212:215], v[52:55]
    v_mfma_f32_16x16x32_bf16 v[56:59], a[4:7], a[192:195], v[56:59]
    s_waitcnt lgkmcnt(7)
    v_add_f32 v104, v104, v72
    v_add_f32 v105, v105, v73
    v_mfma_f32_16x16x32_bf16 v[56:59], a[24:27], a[196:199], v[56:59]
    v_add_f32 v106, v106, v74
    v_add_f32 v107, v107, v75
    v_mfma_f32_16x16x32_bf16 v[56:59], a[44:47], a[200:203], v[56:59]
    s_waitcnt lgkmcnt(6)
    v_add_f32 v104, v104, v76
    v_add_f32 v105, v105, v77
    v_mfma_f32_16x16x32_bf16 v[56:59], a[64:67], a[204:207], v[56:59]
    v_add_f32 v106, v106, v78
    v_mfma_f32_16x16x32_bf16 v[56:59], a[84:87], a[208:211], v[56:59]
    v_add_f32 v107, v107, v79
    s_waitcnt lgkmcnt(5)
    v_add_f32 v104, v104, v80
    v_mfma_f32_16x16x32_bf16 v[56:59], a[104:107], a[212:215], v[56:59]
    v_add_f32 v105, v105, v81
    v_add_f32 v106, v106, v82
    v_mfma_f32_16x16x32_bf16 v[60:63], a[8:11], a[192:195], v[60:63]
    v_add_f32 v107, v107, v83
    s_waitcnt lgkmcnt(4)
    v_add_f32 v104, v104, v84
    v_mfma_f32_16x16x32_bf16 v[60:63], a[28:31], a[196:199], v[60:63]
    v_add_f32 v105, v105, v85
    v_mfma_f32_16x16x32_bf16 v[60:63], a[48:51], a[200:203], v[60:63]
    ds_write_b128 v25, v[52:55] offset:40960
    v_mfma_f32_16x16x32_bf16 v[60:63], a[68:71], a[204:207], v[60:63]
    v_add_f32 v106, v106, v86
    v_add_f32 v107, v107, v87
    v_mfma_f32_16x16x32_bf16 v[60:63], a[88:91], a[208:211], v[60:63]
    v_cvt_pk_bf16_f32 v72, v104, v105
    v_cvt_pk_bf16_f32 v73, v106, v107
    v_mfma_f32_16x16x32_bf16 v[60:63], a[108:111], a[212:215], v[60:63]
    buffer_store_dwordx2 v[72:73], v27, s[76:79], s12 offen
    v_mfma_f32_16x16x32_bf16 v[64:67], a[12:15], a[192:195], v[64:67]
    s_waitcnt lgkmcnt(4)
    v_add_f32 v108, v108, v88
    v_add_f32 v109, v109, v89
    v_mfma_f32_16x16x32_bf16 v[64:67], a[32:35], a[196:199], v[64:67]
    v_add_f32 v110, v110, v90
    v_add_f32 v111, v111, v91
    v_mfma_f32_16x16x32_bf16 v[64:67], a[52:55], a[200:203], v[64:67]
    s_waitcnt lgkmcnt(3)
    v_add_f32 v108, v108, v92
    v_add_f32 v109, v109, v93
    v_mfma_f32_16x16x32_bf16 v[64:67], a[72:75], a[204:207], v[64:67]
    v_add_f32 v110, v110, v94
    v_add_f32 v111, v111, v95
    v_mfma_f32_16x16x32_bf16 v[64:67], a[92:95], a[208:211], v[64:67]
    ds_write_b128 v25, v[56:59] offset:41984
    v_mfma_f32_16x16x32_bf16 v[64:67], a[112:115], a[212:215], v[64:67]
    s_waitcnt lgkmcnt(3)
    v_add_f32 v108, v108, v96
    v_add_f32 v109, v109, v97
    v_mfma_f32_16x16x32_bf16 v[68:71], a[16:19], a[192:195], v[68:71]
    v_add_f32 v110, v110, v98
    v_add_f32 v111, v111, v99
    v_mfma_f32_16x16x32_bf16 v[68:71], a[36:39], a[196:199], v[68:71]
    s_waitcnt lgkmcnt(2)
    v_add_f32 v108, v108, v100
    v_add_f32 v109, v109, v101
    v_mfma_f32_16x16x32_bf16 v[68:71], a[56:59], a[200:203], v[68:71]
    v_add_f32 v110, v110, v102
    v_add_f32 v111, v111, v103
    v_mfma_f32_16x16x32_bf16 v[68:71], a[76:79], a[204:207], v[68:71]
    v_cvt_pk_bf16_f32 v88, v108, v109
    v_cvt_pk_bf16_f32 v89, v110, v111
    v_mfma_f32_16x16x32_bf16 v[68:71], a[96:99], a[208:211], v[68:71]
    ds_write_b128 v25, v[60:63] offset:43008
    v_mfma_f32_16x16x32_bf16 v[68:71], a[116:119], a[212:215], v[68:71]
    buffer_store_dwordx2 v[88:89], v27, s[76:79], s13 offen
    ds_write_b128 v25, v[64:67] offset:44032
    s_nop 5
    ds_write_b128 v25, v[68:71] offset:45056
    s_waitcnt lgkmcnt(0)
    s_barrier
    ds_read_b128 v[72:75], v26 offset:40960
    ds_read_b128 v[76:79], v26 offset:46080
    ds_read_b128 v[80:83], v26 offset:51200
    ds_read_b128 v[84:87], v26 offset:56320
    ds_read_b128 v[88:91], v2 offset:45056
    ds_read_b128 v[92:95], v2 offset:50176
    ds_read_b128 v[96:99], v2 offset:55296
    ds_read_b128 v[100:103], v2 offset:60416
    s_waitcnt lgkmcnt(7)
    v_pk_add_f32 v[112:113], v[112:113], v[72:73]
    v_pk_add_f32 v[114:115], v[114:115], v[74:75]
    s_waitcnt lgkmcnt(5)
    v_pk_add_f32 v[76:77], v[76:77], v[80:81]
    v_pk_add_f32 v[78:79], v[78:79], v[82:83]
    s_waitcnt lgkmcnt(4)
    v_pk_add_f32 v[112:113], v[112:113], v[84:85]
    v_pk_add_f32 v[114:115], v[114:115], v[86:87]
    v_pk_add_f32 v[112:113], v[112:113], v[76:77]
    v_pk_add_f32 v[114:115], v[114:115], v[78:79]
    v_cvt_pk_bf16_f32 v72, v112, v113
    v_cvt_pk_bf16_f32 v73, v114, v115
    buffer_store_dwordx2 v[72:73], v27, s[76:79], s14 offen
    s_waitcnt lgkmcnt(3)
    v_pk_add_f32 v[116:117], v[116:117], v[88:89]
    v_pk_add_f32 v[118:119], v[118:119], v[90:91]
    s_waitcnt lgkmcnt(1)
    v_pk_add_f32 v[92:93], v[92:93], v[96:97]
    v_pk_add_f32 v[94:95], v[94:95], v[98:99]
    s_waitcnt lgkmcnt(0)
    v_pk_add_f32 v[116:117], v[116:117], v[100:101]
    v_pk_add_f32 v[118:119], v[118:119], v[102:103]
    v_pk_add_f32 v[116:117], v[116:117], v[92:93]
    v_pk_add_f32 v[118:119], v[118:119], v[94:95]
    v_cvt_pk_bf16_f32 v88, v116, v117
    v_cvt_pk_bf16_f32 v89, v118, v119
    buffer_store_dwordx2 v[88:89], v27, s[76:79], s15 offen
L_end:
    s_endpgm
.p2align 6
L_p0_stc:
    v_and_b32 v127, 7, v1
    v_mul_u32_u24 v132, 1280, v127
    v_bfe_u32 v125, v1, 3, 1
    v_lshlrev_b32 v125, 6, v125
    v_and_or_b32 v125, v1, 48, v125
    v_add_u32 v132, v132, v125
    v_mul_u32_u24 v124, 1344, v127
    v_add_u32 v124, 134144, v124
    v_add_u32 v124, v124, v125
    s_mov_b32 s50, 2621440
    s_mov_b32 s51, 0x20000
    s_mov_b32 s54, 2621440
    s_mov_b32 s55, 0x20000
    s_mov_b32 s46, 2621440
    s_mov_b32 s47, 0x20000
    s_mov_b32 s58, 5120
    s_mov_b32 s59, 0x20000
    s_mov_b32 s82, 21790720
    s_mov_b32 s83, 0x20000
    s_mov_b32 s63, 0x20000
    s_mul_i32 s16, s4, 20
    s_add_u32 s16, s16, s5
    s_lshl_b32 s16, s16, 2
    s_add_u32 s16, s16, s3
    s_movk_i32 s62, 4096
    s_mov_b32 s8, 0x05040100
    s_mov_b32 s9, 0x07060302
    s_mov_b32 s10, 0xffff0000
    v_lshlrev_b32 v2, 4, v1
    s_lshl_b32 s14, s3, 12
    s_lshl_b32 s15, s4, 8
    s_add_u32 s14, s14, s15
    s_lshl_b32 s15, s5, 2
    s_add_u32 s14, s14, s15
    v_lshl_add_u32 v4, v1, 11, s14
    s_lshr_b32 s17, s5, 2
    s_lshr_b32 s14, s4, 2
    s_lshl_b32 s14, s14, 3
    s_add_u32 s17, s17, s14
    s_and_b32 s18, s5, 3
    s_and_b32 s14, s4, 3
    s_lshl_b32 s14, s14, 2
    s_add_u32 s18, s18, s14
    s_and_b32 s19, s18, 7
    s_lshr_b32 s20, s18, 3
    s_lshl_b32 s14, s17, 10
    s_lshl_b32 s15, s3, 8
    s_add_u32 s15, s15, s14
    s_lshl_b32 s43, s18, 2
    s_add_u32 s15, s15, s43
    s_cmp_lt_u32 s3, 4
    s_cselect_b32 s15, s15, 0x7ff00000
    v_mov_b32 v3, s15
    s_lshr_b32 s15, s18, 2
    s_lshl_b32 s15, s15, 8
    s_add_u32 s14, s14, s15
    v_and_b32 v7, 3, v1
    v_lshl_add_u32 v7, v7, 4, s14
    s_lshl_b32 s14, s18, 2
    s_add_u32 s14, s14, s3
    s_mul_i32 s88, s14, 61440
    s_add_u32 s88, s88, 8650752
    s_lshl_b32 s14, s19, 2
    s_add_u32 s14, s14, s3
    s_mul_i32 s89, s14, 61440
    s_add_u32 s89, s89, 12582912
    s_lshl_b32 s14, s17, 1
    s_add_u32 s14, s14, s20
    s_mul_i32 s40, s14, 98816
    s_mul_i32 s14, s3, 12288
    s_add_u32 s40, s40, s14
    s_add_u32 s40, s40, 14680064
    v_bfe_u32 v125, v1, 2, 2
    v_mul_u32_u24 v125, 1344, v125
    v_lshrrev_b32 v126, 4, v1
    v_lshl_add_u32 v125, v126, 5, v125
    v_and_b32 v127, 3, v1
    v_lshl_add_u32 v125, v127, 3, v125
    v_add_u32 v125, 134144, v125
    v_lshrrev_b32 v131, 2, v1
    v_mul_u32_u24 v131, 144, v131
    v_lshl_add_u32 v131, v127, 5, v131
    v_add_u32 v131, 16, v131
    v_and_b32 v126, 15, v1
    v_lshrrev_b32 v128, 2, v126
    v_lshl_add_u32 v128, v128, 4, v126
    v_lshlrev_b32 v128, 2, v128
    v_add_u32 v132, s13, v132
    v_lshrrev_b32 v170, 3, v1
    v_and_b32 v171, 7, v1
    v_lshlrev_b32 v171, 4, v171
    v_mul_u32_u24 v172, 144, v170
    s_mul_i32 s15, s3, 5760
    s_add_u32 s15, s15, 0
    v_add3_u32 v172, v172, v171, s15
    v_mul_u32_u24 v173, 32896, v170
    s_mul_i32 s14, s3, 1315840
    s_lshl_b32 s15, s6, 7
    s_add_u32 s14, s14, s15
    v_add3_u32 v173, v173, v171, s14
    s_waitcnt lgkmcnt(0)
    s_mov_b64 s[44:45], s[64:65]
    buffer_load_dwordx4 v[32:35], v132, s[44:47], 0 offen offset:0 nt
    buffer_load_dwordx4 v[36:39], v132, s[44:47], 0 offen offset:128 nt
    buffer_load_dwordx4 v[40:43], v132, s[44:47], 0 offen offset:256 nt
    buffer_load_dwordx4 v[44:47], v132, s[44:47], 0 offen offset:384 nt
    buffer_load_dwordx4 v[48:51], v132, s[44:47], 0 offen offset:512 nt
    buffer_load_dwordx4 v[52:55], v132, s[44:47], 0 offen offset:640 nt
    buffer_load_dwordx4 v[56:59], v132, s[44:47], 0 offen offset:768 nt
    buffer_load_dwordx4 v[60:63], v132, s[44:47], 0 offen offset:896 nt
    buffer_load_dwordx4 v[64:67], v132, s[44:47], 0 offen offset:1024 nt
    buffer_load_dwordx4 v[68:71], v132, s[44:47], 0 offen offset:1152 nt
    s_load_dword s92, s[80:81], 98304
    s_mov_b64 s[64:65], s[78:79]
    s_mov_b64 s[68:69], s[32:33]
    s_mov_b32 s66, 1966080
    s_mov_b32 s67, 0x20000
    s_mov_b32 s70, 1966080
    s_mov_b32 s71, 0x20000
    s_lshl_b32 s14, s16, 1
    s_and_b32 s14, s14, -4
    s_load_dword s21, s[74:75], s14
    s_lshl_b32 s12, s16, 12
    s_add_u32 s60, s72, s12
    s_addc_u32 s61, s73, 0
    s_mov_b64 s[76:77], s[36:37]
    s_mov_b32 s78, 2621440
    s_mov_b32 s79, 0x20000
    s_lshr_b32 s101, s16, 2
    s_add_u32 s101, s101, 288
    v_lshrrev_b32 v207, 3, v0
    v_mul_u32_u24 v207, 3072, v207
    v_and_b32 v171, 7, v1
    v_lshl_add_u32 v207, v171, 4, v207
    s_mul_i32 s15, s3, 16768
    v_add_u32 v241, s15, v2
    v_add_u32 v240, 67072, v241
    v_lshlrev_b32 v10, 2, v1
    s_mov_b32 s14, 0x64175302
    v_bfe_u32 v10, s14, v10, 4
    v_mul_u32_u24 v10, 2096, v10
    v_cmp_eq_u32 vcc, 0, v1
    s_nop 1
    v_cndmask_b32_e64 v11, 0, 16, vcc
    v_add3_u32 v243, v10, v11, s15
    v_add_u32 v242, 67072, v243
    v_lshrrev_b32 v12, 4, v1
    v_and_b32 v13, 15, v1
    v_lshl_add_u32 v14, v12, 3, v13
    v_add_u32 v14, 1, v14
    v_and_b32 v15, 7, v14
    v_lshlrev_b32 v15, 2, v15
    v_bfe_u32 v15, s14, v15, 4
    v_mul_u32_u24 v15, 2096, v15
    v_lshrrev_b32 v14, 3, v14
    v_lshlrev_b32 v14, 4, v14
    v_add3_u32 v9, v14, v15, s15
    v_add_u32 v251, 67072, v9
    s_mul_i32 s15, s3, 9248
    s_add_u32 s15, s15, 67072
    v_lshlrev_b32 v10, 1, v13
    v_sub_u32 v10, v10, v12
    v_add_u32 v10, 5, v10
    v_lshlrev_b32 v10, 4, v10
    v_add_u32 v10, s15, v10
    v_lshlrev_b32 v11, 5, v13
    v_lshl_add_u32 v11, v12, 3, v11
    s_add_u32 s14, s15, 5136
    v_add_u32 v11, s14, v11
    v_lshrrev_b32 v14, 1, v12
    v_lshl_add_u32 v14, v13, 1, v14
    v_lshlrev_b32 v14, 6, v14
    v_and_b32 v15, 1, v12
    v_lshlrev_b32 v16, 4, v15
    v_add_u32 v14, 108032, v14
    v_add_u32 v14, v14, v16
    v_lshrrev_b32 v16, 2, v13
    v_lshl_add_u32 v15, v15, 2, v16
    v_mul_u32_u24 v15, 82048, v15
    s_bfe_u32 s14, s16, 0x20001
    v_and_b32 v16, 3, v13
    v_xor_b32 v16, s14, v16
    v_lshlrev_b32 v16, 5, v16
    v_lshrrev_b32 v17, 1, v12
    v_lshlrev_b32 v17, 4, v17
    v_add3_u32 v15, v15, v16, v17
    v_lshl_add_u32 v28, v12, 3, v13
    v_sub_u32 v28, 15, v28
    v_lshlrev_b32 v16, 4, v0
    v_and_b32 v17, 7, v0
    v_mul_u32_u24 v17, 4624, v17
    v_lshrrev_b32 v19, 3, v0
    v_add_u32 v17, 67072, v17
    s_lshr_b32 s12, s18, 2
    s_mov_b32 s13, 0
    s_mul_i32 s85, s19, 10240
    s_add_u32 s85, s85, 81920
    s_mul_i32 s14, s12, 20480
    s_sub_u32 s85, s85, s14
    s_sub_u32 s14, s85, 81920
    s_min_u32 s23, s85, s14
    s_lshl_b32 s84, s3, 11
    s_add_u32 s84, s84, s23
    s_sub_u32 s14, s84, 81920
    s_min_u32 s84, s84, s14
    s_add_u32 s85, s23, 8192
    s_sub_u32 s14, s85, 81920
    s_min_u32 s85, s85, s14
    s_sub_u32 s23, s23, 1024
    s_cmp_gt_u32 s23, 70656
    s_cselect_b32 s23, 16384, 0
    s_mul_i32 s24, s17, 82048
    s_lshl_b32 s25, s3, 12
    s_add_u32 s24, s24, 5767168
    s_mul_i32 s15, s12, 20480
    s_add_u32 s15, s15, s25
    s_sub_u32 s14, s15, 81920
    s_min_u32 s15, s15, s14
    s_add_u32 s49, s15, s24
    s_add_u32 s15, s15, 16384
    s_sub_u32 s14, s15, 81920
    s_min_u32 s15, s15, s14
    s_add_u32 s50, s15, s24
    s_add_u32 s15, s15, 16384
    s_sub_u32 s14, s15, 81920
    s_min_u32 s15, s15, s14
    s_add_u32 s51, s15, s24
    s_add_u32 s15, s15, 16384
    s_sub_u32 s14, s15, 81920
    s_min_u32 s15, s15, s14
    s_add_u32 s52, s15, s24
    s_add_u32 s15, s15, 16384
    s_sub_u32 s14, s15, 81920
    s_min_u32 s15, s15, s14
    s_add_u32 s53, s15, s24
    s_add_u32 s14, s12, 0
    s_and_b32 s14, s14, 3
    s_mul_i32 s14, s14, 15360
    s_add_u32 s44, s14, s88
    s_add_u32 s14, s12, 1
    s_and_b32 s14, s14, 3
    s_mul_i32 s14, s14, 15360
    s_add_u32 s45, s14, s88
    s_add_u32 s14, s12, 2
    s_and_b32 s14, s14, 3
    s_mul_i32 s14, s14, 15360
    s_add_u32 s46, s14, s88
    s_add_u32 s14, s12, 3
    s_and_b32 s14, s14, 3
    s_mul_i32 s14, s14, 15360
    s_add_u32 s47, s14, s88
    s_lshl_b32 s14, s17, 14
    s_lshl_b32 s15, s3, 8
    s_add_u32 s14, s14, s15
    s_add_u32 s14, s14, 21004288
    s_lshl_b32 s15, s18, 10
    s_add_u32 s48, s14, s15
    s_and_b32 s15, s15, 3072
    s_add_u32 s94, s14, s15
    s_mul_i32 s54, s13, 20480
    s_add_u32 s54, s54, s89
    s_lshl_b32 s57, s13, 12
    s_add_u32 s57, s57, s40
    s_add_u32 s13, s13, 1
    s_sub_u32 s14, s13, 3
    s_min_u32 s13, s13, s14
    s_mul_i32 s55, s13, 20480
    s_add_u32 s55, s55, s89
    s_lshl_b32 s58, s13, 12
    s_add_u32 s58, s58, s40
    s_add_u32 s13, s13, 1
    s_sub_u32 s14, s13, 3
    s_min_u32 s13, s13, s14
    s_mul_i32 s56, s13, 20480
    s_add_u32 s56, s56, s89
    s_lshl_b32 s59, s13, 12
    s_add_u32 s59, s59, s40
    s_lshl_b32 s87, s18, 2
    s_add_u32 s87, s87, s3
    s_mul_i32 s87, s87, 192
    s_add_u32 s87, s87, 8396800
    v_lshl_add_u32 v17, v19, 4, v17
    v_mov_b32 v244, v9
    v_mov_b32 v245, v10
    v_mov_b32 v246, v11
    v_mov_b32 v247, v14
    v_mov_b32 v248, v15
    v_mov_b32 v249, v16
    v_mov_b32 v250, v17
    v_lshrrev_b32 v12, 2, v1
    v_lshlrev_b32 v13, 7, v12
    v_and_b32 v14, 3, v1
    v_lshl_add_u32 v13, v14, 3, v13
    v_bfe_u32 v14, v1, 3, 2
    v_xor_b32 v15, s3, v14
    s_lshl_b32 s13, s20, 1
    v_xor_b32 v16, s13, v14
    v_lshl_add_u32 v17, v16, 5, v13
    v_add_u32 v13, 131072, v13
    v_xor_b32 v16, 0, v15
    v_lshl_add_u32 v8, v16, 5, v13
    v_xor_b32 v16, 1, v15
    v_lshl_add_u32 v9, v16, 5, v13
    v_xor_b32 v16, 2, v15
    v_lshl_add_u32 v10, v16, 5, v13
    v_xor_b32 v16, 3, v15
    v_lshl_add_u32 v11, v16, 5, v13
    v_and_b32 v16, 15, v1
    v_lshlrev_b32 v16, 4, v16
    v_add_u32 v16, s23, v16
    v_add_u32 v16, 131072, v16
    s_xor_b32 s12, s3, 0
    s_lshl_b32 s12, s12, 8
    v_add_u32 v19, s12, v16
    s_xor_b32 s12, s3, 1
    s_lshl_b32 s12, s12, 8
    v_add_u32 v20, s12, v16
    s_xor_b32 s12, s3, 2
    s_lshl_b32 s12, s12, 8
    v_add_u32 v21, s12, v16
    s_xor_b32 s12, s3, 3
    s_lshl_b32 s12, s12, 8
    v_add_u32 v22, s12, v16
    v_lshrrev_b32 v16, 4, v1
    v_xor_b32 v16, s3, v16
    v_mul_u32_u24 v16, 49408, v16
    v_and_b32 v23, 15, v1
    v_lshl_add_u32 v23, v23, 4, v16
    v_and_b32 v16, 3, v1
    v_cmp_eq_u32 s[32:33], 1, v16
    v_cmp_eq_u32 s[34:35], 2, v16
    v_cmp_eq_u32 s[36:37], 3, v16
    s_mul_i32 s22, s17, 197632
    s_lshl_b32 s13, s18, 2
    s_add_u32 s13, s13, s3
    s_mul_i32 s13, s13, 768
    s_add_u32 s22, s22, s13
    s_add_u32 s22, s22, 14680064
    s_mul_i32 s12, s3, 5120
    v_add_u32 v25, s12, v2
    s_lshl_b32 s12, s3, 10
    v_add_u32 v26, s12, v2
    v_and_b32 v27, 15, v1
    v_mul_u32_u24 v27, 1280, v27
    v_lshrrev_b32 v16, 4, v1
    v_lshl_add_u32 v27, v16, 3, v27
    s_lshl_b32 s12, s17, 1
    s_add_u32 s12, s12, s20
    s_mul_i32 s12, s12, 40960
    s_mul_i32 s13, s19, 160
    s_add_u32 s100, s12, s13
    s_lshl_b32 s13, s3, 5
    s_add_u32 s95, s100, s13
    v_and_b32 v24, 7, v1
    v_max_u32 v24, 5, v24
    v_and_b32 v16, 56, v1
    v_lshlrev_b32 v16, 5, v16
    v_lshl_add_u32 v24, v24, 4, v16
    s_lshl_b32 s12, s4, 11
    v_add_u32 v24, s12, v24
    v_and_b32 v12, 15, v1
    v_lshlrev_b32 v12, 4, v12
    v_and_b32 v13, 48, v1
    v_lshl_add_u32 v13, v13, 8, v12
    v_subrev_u32 v5, 16, v2
    buffer_load_dwordx4 v[208:211], v5, s[60:63], 0 offen nt
    buffer_load_dwordx4 v[212:215], v2, s[60:63], 0 offen offset:0 nt
    buffer_load_dwordx4 v[216:219], v2, s[60:63], 0 offen offset:1008 nt
    buffer_load_dwordx4 v[220:223], v2, s[60:63], 0 offen offset:1024 nt
    buffer_load_dwordx4 v[224:227], v2, s[60:63], 0 offen offset:2032 nt
    buffer_load_dwordx4 v[228:231], v2, s[60:63], 0 offen offset:2048 nt
    buffer_load_dwordx4 v[232:235], v2, s[60:63], 0 offen offset:3056 nt
    buffer_load_dwordx4 v[236:239], v2, s[60:63], 0 offen offset:3072 nt
    v_mov_b32 v80, 0x3f803f80
    v_mov_b32 v81, 0x3f803f80
    v_mov_b32 v82, 0x3f803f80
    v_mov_b32 v83, 0x3f803f80
    s_waitcnt vmcnt(17)
    ds_write_b128 v124, v[32:35] offset:0
    v_mfma_f32_16x16x32_bf16 v[72:75], v[32:35], v[32:35], 0
    ds_read_b64_tr_b16 v[84:85], v125 offset:0
    v_mfma_f32_16x16x32_bf16 v[76:79], v[80:83], v[32:35], 0
    ds_read_b64_tr_b16 v[86:87], v125 offset:5376
    s_waitcnt vmcnt(16)
    ds_write_b128 v124, v[36:39] offset:128
    v_mfma_f32_16x16x32_bf16 v[72:75], v[36:39], v[36:39], v[72:75]
    ds_read_b64_tr_b16 v[88:89], v125 offset:128
    v_mfma_f32_16x16x32_bf16 v[76:79], v[80:83], v[36:39], v[76:79]
    ds_read_b64_tr_b16 v[90:91], v125 offset:5504
    s_waitcnt vmcnt(15)
    ds_write_b128 v124, v[40:43] offset:256
    v_mfma_f32_16x16x32_bf16 v[72:75], v[40:43], v[40:43], v[72:75]
    ds_read_b64_tr_b16 v[92:93], v125 offset:256
    v_mfma_f32_16x16x32_bf16 v[76:79], v[80:83], v[40:43], v[76:79]
    ds_read_b64_tr_b16 v[94:95], v125 offset:5632
    s_waitcnt vmcnt(14)
    ds_write_b128 v124, v[44:47] offset:384
    v_mfma_f32_16x16x32_bf16 v[72:75], v[44:47], v[44:47], v[72:75]
    ds_read_b64_tr_b16 v[96:97], v125 offset:384
    v_mfma_f32_16x16x32_bf16 v[76:79], v[80:83], v[44:47], v[76:79]
    ds_read_b64_tr_b16 v[98:99], v125 offset:5760
    s_waitcnt vmcnt(13)
    ds_write_b128 v124, v[48:51] offset:512
    v_mfma_f32_16x16x32_bf16 v[72:75], v[48:51], v[48:51], v[72:75]
    ds_read_b64_tr_b16 v[100:101], v125 offset:512
    v_mfma_f32_16x16x32_bf16 v[76:79], v[80:83], v[48:51], v[76:79]
    ds_read_b64_tr_b16 v[102:103], v125 offset:5888
    s_waitcnt vmcnt(12)
    ds_write_b128 v124, v[52:55] offset:640
    v_mfma_f32_16x16x32_bf16 v[72:75], v[52:55], v[52:55], v[72:75]
    ds_read_b64_tr_b16 v[104:105], v125 offset:640
    v_mfma_f32_16x16x32_bf16 v[76:79], v[80:83], v[52:55], v[76:79]
    ds_read_b64_tr_b16 v[106:107], v125 offset:6016
    s_waitcnt vmcnt(11)
    ds_write_b128 v124, v[56:59] offset:768
    v_mfma_f32_16x16x32_bf16 v[72:75], v[56:59], v[56:59], v[72:75]
    ds_read_b64_tr_b16 v[108:109], v125 offset:768
    v_mfma_f32_16x16x32_bf16 v[76:79], v[80:83], v[56:59], v[76:79]
    ds_read_b64_tr_b16 v[110:111], v125 offset:6144
    s_waitcnt vmcnt(10)
    ds_write_b128 v124, v[60:63] offset:896
    v_mfma_f32_16x16x32_bf16 v[72:75], v[60:63], v[60:63], v[72:75]
    ds_read_b64_tr_b16 v[112:113], v125 offset:896
    v_mfma_f32_16x16x32_bf16 v[76:79], v[80:83], v[60:63], v[76:79]
    ds_read_b64_tr_b16 v[114:115], v125 offset:6272
    s_waitcnt vmcnt(9)
    ds_write_b128 v124, v[64:67] offset:1024
    v_mfma_f32_16x16x32_bf16 v[72:75], v[64:67], v[64:67], v[72:75]
    ds_read_b64_tr_b16 v[116:117], v125 offset:1024
    v_mfma_f32_16x16x32_bf16 v[76:79], v[80:83], v[64:67], v[76:79]
    ds_read_b64_tr_b16 v[118:119], v125 offset:6400
    s_waitcnt vmcnt(8)
    ds_write_b128 v124, v[68:71] offset:1152
    v_mfma_f32_16x16x32_bf16 v[72:75], v[68:71], v[68:71], v[72:75]
    ds_read_b64_tr_b16 v[120:121], v125 offset:1152
    v_mfma_f32_16x16x32_bf16 v[76:79], v[80:83], v[68:71], v[76:79]
    ds_read_b64_tr_b16 v[122:123], v125 offset:6528
    s_waitcnt lgkmcnt(0)
    ds_write_b128 v131, v[84:87] offset:0
    ds_write_b128 v131, v[88:91] offset:2304
    ds_write_b128 v131, v[92:95] offset:4608
    ds_write_b128 v131, v[96:99] offset:6912
    ds_write_b128 v131, v[100:103] offset:9216
    ds_write_b128 v131, v[104:107] offset:11520
    ds_write_b128 v131, v[108:111] offset:13824
    ds_write_b128 v131, v[112:115] offset:16128
    ds_write_b128 v131, v[116:119] offset:18432
    ds_write_b128 v131, v[120:123] offset:20736
    v_cmp_eq_u32 vcc, 1, v127
    s_nop 1
    v_cndmask_b32 v72, v72, v73, vcc
    v_cmp_eq_u32 vcc, 2, v127
    s_nop 1
    v_cndmask_b32 v72, v72, v74, vcc
    v_cmp_eq_u32 vcc, 3, v127
    s_nop 1
    v_cndmask_b32 v72, v72, v75, vcc
    ds_bpermute_b32 v129, v128, v72
    v_add_f32_dpp v130, v76, v76 row_ror:8 row_mask:0xf bank_mask:0xf
    s_waitcnt lgkmcnt(0)
    v_add_f32_dpp v129, v129, v129 row_ror:8 row_mask:0xf bank_mask:0xf
    v_mul_f32 v130, 0x3acccccd, v130
    v_mul_f32 v129, 0x3acccccd, v129
    v_fma_f32 v129, -v130, v130, v129
    v_max_f32 v129, 0, v129
    v_add_f32 v129, 0x3727c5ac, v129
    v_rsq_f32 v129, v129
    v_cmp_gt_u32 vcc, 8, v126
    v_mul_f32_e64 v130, -v130, v129
    s_nop 0
    v_cndmask_b32 v129, v130, v129, vcc
    v_lshlrev_b32 v125, 2, v1
    s_lshl_b32 s14, s6, 6
    s_add_u32 s14, s14, 102400
    s_mov_b64 exec, 0xffff
    buffer_store_dword v129, v125, s[80:83], s14 offen sc1
    s_mov_b64 exec, -1
    s_branch L_p0_joinc
.p2align 6
L_p0_kvf:
    v_lshlrev_b32 v2, 3, v0
    v_add_u32 v78, s13, v2
    v_subrev_u32 v79, 3840, v78
    v_lshlrev_b32 v80, 5, v0
    s_movk_i32 s11, 160
    s_mov_b32 s50, 2621440
    s_mov_b32 s51, 0x20000
    s_mov_b32 s54, 2621440
    s_mov_b32 s55, 0x20000
    s_mov_b32 s46, 2621440
    s_mov_b32 s47, 0x20000
    s_mov_b32 s58, 5120
    s_mov_b32 s59, 0x20000
    s_mov_b32 s82, 21790720
    s_mov_b32 s83, 0x20000
    s_mov_b32 s63, 0x20000
    s_mul_i32 s16, s4, 20
    s_add_u32 s16, s16, s5
    s_lshl_b32 s16, s16, 2
    s_add_u32 s16, s16, s3
    s_movk_i32 s62, 4096
    s_mov_b32 s8, 0x05040100
    s_mov_b32 s9, 0x07060302
    s_mov_b32 s10, 0xffff0000
    v_lshlrev_b32 v2, 4, v1
    s_lshl_b32 s14, s3, 12
    s_lshl_b32 s15, s4, 8
    s_add_u32 s14, s14, s15
    s_lshl_b32 s15, s5, 2
    s_add_u32 s14, s14, s15
    v_lshl_add_u32 v4, v1, 11, s14
    s_lshr_b32 s17, s5, 2
    s_lshr_b32 s14, s4, 2
    s_lshl_b32 s14, s14, 3
    s_add_u32 s17, s17, s14
    s_and_b32 s18, s5, 3
    s_and_b32 s14, s4, 3
    s_lshl_b32 s14, s14, 2
    s_add_u32 s18, s18, s14
    s_and_b32 s19, s18, 7
    s_lshr_b32 s20, s18, 3
    s_lshl_b32 s14, s17, 10
    s_lshl_b32 s15, s3, 8
    s_add_u32 s15, s15, s14
    s_lshl_b32 s43, s18, 2
    s_add_u32 s15, s15, s43
    s_cmp_lt_u32 s3, 4
    s_cselect_b32 s15, s15, 0x7ff00000
    v_mov_b32 v3, s15
    s_lshr_b32 s15, s18, 2
    s_lshl_b32 s15, s15, 8
    s_add_u32 s14, s14, s15
    v_and_b32 v7, 3, v1
    v_lshl_add_u32 v7, v7, 4, s14
    s_lshl_b32 s14, s18, 2
    s_add_u32 s14, s14, s3
    s_mul_i32 s88, s14, 61440
    s_add_u32 s88, s88, 8650752
    s_lshl_b32 s14, s19, 2
    s_add_u32 s14, s14, s3
    s_mul_i32 s89, s14, 61440
    s_add_u32 s89, s89, 12582912
    s_lshl_b32 s14, s17, 1
    s_add_u32 s14, s14, s20
    s_mul_i32 s40, s14, 98816
    s_mul_i32 s14, s3, 12288
    s_add_u32 s40, s40, s14
    s_add_u32 s40, s40, 14680064
    v_mul_u32_u24 v206, 144, v0
    v_add_u32 v206, 0, v206
    v_lshrrev_b32 v170, 3, v1
    v_and_b32 v171, 7, v1
    v_lshlrev_b32 v171, 4, v171
    v_mul_u32_u24 v172, 144, v170
    s_mul_i32 s15, s3, 5760
    s_add_u32 s15, s15, 0
    v_add3_u32 v172, v172, v171, s15
    v_mul_u32_u24 v173, 32896, v170
    s_mul_i32 s14, s3, 1315840
    s_lshl_b32 s15, s6, 7
    s_add_u32 s14, s14, s15
    v_add3_u32 v173, v173, v171, s14
    v_cmp_gt_u32 s[30:31], s11, v0
    s_waitcnt lgkmcnt(0)
    s_mov_b64 s[48:49], s[66:67]
    s_mov_b64 s[56:57], s[70:71]
    s_mov_b64 s[52:53], s[68:69]
    s_mov_b32 s14, 5120
    s_mov_b64 exec, s[30:31]
    buffer_load_dwordx2 v[40:41], v79, s[48:51], 0 offen offset:0 nt
    buffer_load_dwordx2 v[42:43], v79, s[48:51], 0 offen offset:1280 nt
    buffer_load_dwordx2 v[44:45], v79, s[48:51], 0 offen offset:2560 nt
    buffer_load_dwordx2 v[46:47], v78, s[48:51], 0 offen offset:0 nt
    buffer_load_dwordx2 v[48:49], v78, s[48:51], 0 offen offset:1280 nt
    buffer_load_dwordx2 v[50:51], v78, s[48:51], 0 offen offset:2560 nt
    buffer_load_dwordx2 v[52:53], v78, s[48:51], 0 offen offset:3840 nt
    buffer_load_dwordx2 v[54:55], v78, s[48:51], s14 offen offset:0 nt
    buffer_load_dwordx2 v[56:57], v78, s[48:51], s14 offen offset:1280 nt
    buffer_load_dwordx2 v[58:59], v78, s[48:51], s14 offen offset:2560 nt
    buffer_load_dwordx2 v[60:61], v78, s[48:51], s14 offen offset:3840 nt
    buffer_load_dwordx4 v[32:35], v80, s[56:59], 0 offen
    buffer_load_dwordx4 v[36:39], v80, s[56:59], 0 offen offset:16
    buffer_load_dwordx2 v[62:63], v78, s[52:55], 0 offen offset:0 nt
    buffer_load_dwordx2 v[64:65], v78, s[52:55], 0 offen offset:1280 nt
    buffer_load_dwordx2 v[66:67], v78, s[52:55], 0 offen offset:2560 nt
    buffer_load_dwordx2 v[68:69], v78, s[52:55], 0 offen offset:3840 nt
    buffer_load_dwordx2 v[70:71], v78, s[52:55], s14 offen offset:0 nt
    buffer_load_dwordx2 v[72:73], v78, s[52:55], s14 offen offset:1280 nt
    buffer_load_dwordx2 v[74:75], v78, s[52:55], s14 offen offset:2560 nt
    buffer_load_dwordx2 v[76:77], v78, s[52:55], s14 offen offset:3840 nt
    s_mov_b64 exec, -1
    s_load_dword s92, s[80:81], 98304
    s_mov_b64 s[64:65], s[78:79]
    s_mov_b64 s[68:69], s[32:33]
    s_mov_b32 s66, 1966080
    s_mov_b32 s67, 0x20000
    s_mov_b32 s70, 1966080
    s_mov_b32 s71, 0x20000
    s_mov_b64 s[72:73], s[34:35]
    s_mov_b32 s74, 1966080
    s_mov_b32 s75, 0x20000
    s_mov_b64 s[76:77], s[36:37]
    s_mov_b32 s78, 2621440
    s_mov_b32 s79, 0x20000
    s_mul_i32 s24, s4, 12
    s_add_u32 s24, s24, s5
    s_sub_u32 s24, s24, 20
    s_mul_i32 s101, s24, 3
    s_and_b32 s25, s24, 3
    s_lshr_b32 s24, s24, 2
    v_lshrrev_b32 v207, 3, v0
    v_mul_u32_u24 v207, 3072, v207
    v_and_b32 v171, 7, v1
    v_lshl_add_u32 v207, v171, 4, v207
    s_add_u32 s15, s101, 0
    s_mul_i32 s12, s15, 2731
    s_lshr_b32 s12, s12, 16
    s_mul_i32 s14, s12, 24
    s_sub_u32 s15, s15, s14
    s_mul_i32 s14, s12, 768
    s_add_u32 s14, s14, s15
    s_lshl_b32 s14, s14, 7
    s_lshl_b32 s12, s3, 10
    s_add_u32 m0, s12, 67072
    s_nop 0
    buffer_load_dwordx4 v207, s[64:67], s14 offen nt lds
    s_add_u32 m0, m0, 4224
    s_nop 0
    buffer_load_dwordx4 v207, s[68:71], s14 offen nt lds
    s_add_u32 s15, s101, 1
    s_mul_i32 s12, s15, 2731
    s_lshr_b32 s12, s12, 16
    s_mul_i32 s14, s12, 24
    s_sub_u32 s15, s15, s14
    s_mul_i32 s14, s12, 768
    s_add_u32 s14, s14, s15
    s_lshl_b32 s14, s14, 7
    s_lshl_b32 s12, s3, 10
    s_add_u32 m0, s12, 75520
    s_nop 0
    buffer_load_dwordx4 v207, s[64:67], s14 offen nt lds
    s_add_u32 m0, m0, 4224
    s_nop 0
    buffer_load_dwordx4 v207, s[68:71], s14 offen nt lds
    s_add_u32 s15, s101, 2
    s_mul_i32 s12, s15, 2731
    s_lshr_b32 s12, s12, 16
    s_mul_i32 s14, s12, 24
    s_sub_u32 s15, s15, s14
    s_mul_i32 s14, s12, 768
    s_add_u32 s14, s14, s15
    s_lshl_b32 s14, s14, 7
    s_lshl_b32 s12, s3, 10
    s_add_u32 m0, s12, 83968
    s_nop 0
    buffer_load_dwordx4 v207, s[64:67], s14 offen nt lds
    s_add_u32 m0, m0, 4224
    s_nop 0
    buffer_load_dwordx4 v207, s[68:71], s14 offen nt lds
    s_waitcnt vmcnt(26)
    v_lshlrev_b32 v94, 16, v40
    v_and_b32 v95, s10, v40
    v_lshlrev_b32 v96, 16, v41
    v_and_b32 v97, s10, v41
    s_waitcnt vmcnt(25)
    v_lshlrev_b32 v98, 16, v42
    v_and_b32 v99, s10, v42
    v_lshlrev_b32 v100, 16, v43
    v_and_b32 v101, s10, v43
    s_waitcnt vmcnt(24)
    v_lshlrev_b32 v102, 16, v44
    v_and_b32 v103, s10, v44
    v_lshlrev_b32 v104, 16, v45
    v_and_b32 v105, s10, v45
    s_waitcnt vmcnt(23)
    v_lshlrev_b32 v106, 16, v46
    v_and_b32 v107, s10, v46
    v_lshlrev_b32 v108, 16, v47
    v_and_b32 v109, s10, v47
    s_waitcnt vmcnt(22)
    v_lshlrev_b32 v110, 16, v48
    v_and_b32 v111, s10, v48
    v_lshlrev_b32 v112, 16, v49
    v_and_b32 v113, s10, v49
    s_waitcnt vmcnt(21)
    v_lshlrev_b32 v114, 16, v50
    v_and_b32 v115, s10, v50
    v_lshlrev_b32 v116, 16, v51
    v_and_b32 v117, s10, v51
    s_waitcnt vmcnt(20)
    v_lshlrev_b32 v118, 16, v52
    v_and_b32 v119, s10, v52
    v_lshlrev_b32 v120, 16, v53
    v_and_b32 v121, s10, v53
    s_waitcnt vmcnt(19)
    v_lshlrev_b32 v122, 16, v54
    v_and_b32 v123, s10, v54
    v_lshlrev_b32 v124, 16, v55
    v_and_b32 v125, s10, v55
    s_waitcnt vmcnt(18)
    v_lshlrev_b32 v126, 16, v56
    v_and_b32 v127, s10, v56
    v_lshlrev_b32 v128, 16, v57
    v_and_b32 v129, s10, v57
    s_waitcnt vmcnt(17)
    v_lshlrev_b32 v130, 16, v58
    v_and_b32 v131, s10, v58
    v_lshlrev_b32 v132, 16, v59
    v_and_b32 v133, s10, v59
    s_waitcnt vmcnt(16)
    v_lshlrev_b32 v134, 16, v60
    v_and_b32 v135, s10, v60
    v_lshlrev_b32 v136, 16, v61
    v_and_b32 v137, s10, v61
    s_waitcnt vmcnt(15)
    v_lshlrev_b32 v78, 16, v32
    v_and_b32 v82, s10, v32
    v_lshlrev_b32 v86, 16, v33
    v_and_b32 v90, s10, v33
    v_lshlrev_b32 v79, 16, v34
    v_and_b32 v83, s10, v34
    v_lshlrev_b32 v87, 16, v35
    v_and_b32 v91, s10, v35
    s_waitcnt vmcnt(14)
    v_lshlrev_b32 v80, 16, v36
    v_and_b32 v84, s10, v36
    v_lshlrev_b32 v88, 16, v37
    v_and_b32 v92, s10, v37
    v_lshlrev_b32 v81, 16, v38
    v_and_b32 v85, s10, v38
    v_lshlrev_b32 v89, 16, v39
    v_and_b32 v93, s10, v39
    v_pk_mul_f32 v[138:139], v[106:107], v[78:79]
    v_pk_mul_f32 v[140:141], v[108:109], v[80:81]
    v_pk_mul_f32 v[142:143], v[110:111], v[78:79]
    v_pk_mul_f32 v[144:145], v[112:113], v[80:81]
    v_pk_mul_f32 v[146:147], v[114:115], v[78:79]
    v_pk_mul_f32 v[148:149], v[116:117], v[80:81]
    v_pk_mul_f32 v[150:151], v[118:119], v[78:79]
    v_pk_mul_f32 v[152:153], v[120:121], v[80:81]
    v_pk_mul_f32 v[154:155], v[122:123], v[78:79]
    v_pk_mul_f32 v[156:157], v[124:125], v[80:81]
    v_pk_mul_f32 v[158:159], v[126:127], v[78:79]
    v_pk_mul_f32 v[160:161], v[128:129], v[80:81]
    v_pk_mul_f32 v[162:163], v[130:131], v[78:79]
    v_pk_mul_f32 v[164:165], v[132:133], v[80:81]
    v_pk_mul_f32 v[166:167], v[134:135], v[78:79]
    v_pk_mul_f32 v[168:169], v[136:137], v[80:81]
    v_pk_fma_f32 v[138:139], v[102:103], v[82:83], v[138:139]
    v_pk_fma_f32 v[140:141], v[104:105], v[84:85], v[140:141]
    v_pk_fma_f32 v[142:143], v[106:107], v[82:83], v[142:143]
    v_pk_fma_f32 v[144:145], v[108:109], v[84:85], v[144:145]
    v_pk_fma_f32 v[146:147], v[110:111], v[82:83], v[146:147]
    v_pk_fma_f32 v[148:149], v[112:113], v[84:85], v[148:149]
    v_pk_fma_f32 v[150:151], v[114:115], v[82:83], v[150:151]
    v_pk_fma_f32 v[152:153], v[116:117], v[84:85], v[152:153]
    v_pk_fma_f32 v[154:155], v[118:119], v[82:83], v[154:155]
    v_pk_fma_f32 v[156:157], v[120:121], v[84:85], v[156:157]
    v_pk_fma_f32 v[158:159], v[122:123], v[82:83], v[158:159]
    v_pk_fma_f32 v[160:161], v[124:125], v[84:85], v[160:161]
    v_pk_fma_f32 v[162:163], v[126:127], v[82:83], v[162:163]
    v_pk_fma_f32 v[164:165], v[128:129], v[84:85], v[164:165]
    v_pk_fma_f32 v[166:167], v[130:131], v[82:83], v[166:167]
    v_pk_fma_f32 v[168:169], v[132:133], v[84:85], v[168:169]
    v_pk_fma_f32 v[138:139], v[98:99], v[86:87], v[138:139]
    v_pk_fma_f32 v[140:141], v[100:101], v[88:89], v[140:141]
    v_pk_fma_f32 v[142:143], v[102:103], v[86:87], v[142:143]
    v_pk_fma_f32 v[144:145], v[104:105], v[88:89], v[144:145]
    v_pk_fma_f32 v[146:147], v[106:107], v[86:87], v[146:147]
    v_pk_fma_f32 v[148:149], v[108:109], v[88:89], v[148:149]
    v_pk_fma_f32 v[150:151], v[110:111], v[86:87], v[150:151]
    v_pk_fma_f32 v[152:153], v[112:113], v[88:89], v[152:153]
    v_pk_fma_f32 v[154:155], v[114:115], v[86:87], v[154:155]
    v_pk_fma_f32 v[156:157], v[116:117], v[88:89], v[156:157]
    v_pk_fma_f32 v[158:159], v[118:119], v[86:87], v[158:159]
    v_pk_fma_f32 v[160:161], v[120:121], v[88:89], v[160:161]
    v_pk_fma_f32 v[162:163], v[122:123], v[86:87], v[162:163]
    v_pk_fma_f32 v[164:165], v[124:125], v[88:89], v[164:165]
    v_pk_fma_f32 v[166:167], v[126:127], v[86:87], v[166:167]
    v_pk_fma_f32 v[168:169], v[128:129], v[88:89], v[168:169]
    v_pk_fma_f32 v[138:139], v[94:95], v[90:91], v[138:139]
    v_pk_fma_f32 v[140:141], v[96:97], v[92:93], v[140:141]
    v_pk_fma_f32 v[142:143], v[98:99], v[90:91], v[142:143]
    v_pk_fma_f32 v[144:145], v[100:101], v[92:93], v[144:145]
    v_pk_fma_f32 v[146:147], v[102:103], v[90:91], v[146:147]
    v_pk_fma_f32 v[148:149], v[104:105], v[92:93], v[148:149]
    v_pk_fma_f32 v[150:151], v[106:107], v[90:91], v[150:151]
    v_pk_fma_f32 v[152:153], v[108:109], v[92:93], v[152:153]
    v_pk_fma_f32 v[154:155], v[110:111], v[90:91], v[154:155]
    v_pk_fma_f32 v[156:157], v[112:113], v[92:93], v[156:157]
    v_pk_fma_f32 v[158:159], v[114:115], v[90:91], v[158:159]
    v_pk_fma_f32 v[160:161], v[116:117], v[92:93], v[160:161]
    v_pk_fma_f32 v[162:163], v[118:119], v[90:91], v[162:163]
    v_pk_fma_f32 v[164:165], v[120:121], v[92:93], v[164:165]
    v_pk_fma_f32 v[166:167], v[122:123], v[90:91], v[166:167]
    v_pk_fma_f32 v[168:169], v[124:125], v[92:93], v[168:169]
    s_waitcnt vmcnt(13)
    v_lshlrev_b32 v174, 16, v62
    v_and_b32 v175, s10, v62
    v_lshlrev_b32 v176, 16, v63
    v_and_b32 v177, s10, v63
    s_waitcnt vmcnt(12)
    v_lshlrev_b32 v178, 16, v64
    v_and_b32 v179, s10, v64
    v_lshlrev_b32 v180, 16, v65
    v_and_b32 v181, s10, v65
    s_waitcnt vmcnt(11)
    v_lshlrev_b32 v182, 16, v66
    v_and_b32 v183, s10, v66
    v_lshlrev_b32 v184, 16, v67
    v_and_b32 v185, s10, v67
    s_waitcnt vmcnt(10)
    v_lshlrev_b32 v186, 16, v68
    v_and_b32 v187, s10, v68
    v_lshlrev_b32 v188, 16, v69
    v_and_b32 v189, s10, v69
    s_waitcnt vmcnt(9)
    v_lshlrev_b32 v190, 16, v70
    v_and_b32 v191, s10, v70
    v_lshlrev_b32 v192, 16, v71
    v_and_b32 v193, s10, v71
    s_waitcnt vmcnt(8)
    v_lshlrev_b32 v194, 16, v72
    v_and_b32 v195, s10, v72
    v_lshlrev_b32 v196, 16, v73
    v_and_b32 v197, s10, v73
    s_waitcnt vmcnt(7)
    v_lshlrev_b32 v198, 16, v74
    v_and_b32 v199, s10, v74
    v_lshlrev_b32 v200, 16, v75
    v_and_b32 v201, s10, v75
    s_waitcnt vmcnt(6)
    v_lshlrev_b32 v202, 16, v76
    v_and_b32 v203, s10, v76
    v_lshlrev_b32 v204, 16, v77
    v_and_b32 v205, s10, v77
    v_pk_mul_f32 v[138:139], v[138:139], v[174:175]
    v_pk_mul_f32 v[140:141], v[140:141], v[176:177]
    v_pk_mul_f32 v[142:143], v[142:143], v[178:179]
    v_pk_mul_f32 v[144:145], v[144:145], v[180:181]
    v_pk_mul_f32 v[146:147], v[146:147], v[182:183]
    v_pk_mul_f32 v[148:149], v[148:149], v[184:185]
    v_pk_mul_f32 v[150:151], v[150:151], v[186:187]
    v_pk_mul_f32 v[152:153], v[152:153], v[188:189]
    v_pk_mul_f32 v[154:155], v[154:155], v[190:191]
    v_pk_mul_f32 v[156:157], v[156:157], v[192:193]
    v_pk_mul_f32 v[158:159], v[158:159], v[194:195]
    v_pk_mul_f32 v[160:161], v[160:161], v[196:197]
    v_pk_mul_f32 v[162:163], v[162:163], v[198:199]
    v_pk_mul_f32 v[164:165], v[164:165], v[200:201]
    v_pk_mul_f32 v[166:167], v[166:167], v[202:203]
    v_pk_mul_f32 v[168:169], v[168:169], v[204:205]
    s_mov_b64 exec, s[30:31]
    v_cvt_pk_bf16_f32 v94, v166, v162
    v_cvt_pk_bf16_f32 v95, v158, v154
    v_cvt_pk_bf16_f32 v96, v150, v146
    v_cvt_pk_bf16_f32 v97, v142, v138
    ds_write_b128 v206, v[94:97] offset:0
    v_cvt_pk_bf16_f32 v102, v167, v163
    v_cvt_pk_bf16_f32 v103, v159, v155
    v_cvt_pk_bf16_f32 v104, v151, v147
    v_cvt_pk_bf16_f32 v105, v143, v139
    ds_write_b128 v206, v[102:105] offset:32
    v_cvt_pk_bf16_f32 v110, v168, v164
    v_cvt_pk_bf16_f32 v111, v160, v156
    v_cvt_pk_bf16_f32 v112, v152, v148
    v_cvt_pk_bf16_f32 v113, v144, v140
    ds_write_b128 v206, v[110:113] offset:64
    v_cvt_pk_bf16_f32 v118, v169, v165
    v_cvt_pk_bf16_f32 v119, v161, v157
    v_cvt_pk_bf16_f32 v120, v153, v149
    v_cvt_pk_bf16_f32 v121, v145, v141
    ds_write_b128 v206, v[118:121] offset:96
    s_mov_b64 exec, -1
L_p0_joinf:
    s_nop 4
    s_waitcnt lgkmcnt(0)
    s_barrier
    ds_read_b128 v[140:143], v172 offset:0
    ds_read_b128 v[144:147], v172 offset:1152
    ds_read_b128 v[148:151], v172 offset:2304
    ds_read_b128 v[152:155], v172 offset:3456
    ds_read_b128 v[156:159], v172 offset:4608
    s_mul_i32 s92, s92, 1664525
    s_add_u32 s92, s92, 1013904223
    s_mov_b32 s93, s92
    v_mov_b32 v6, s92
    s_mov_b32 s14, 262144
    s_waitcnt lgkmcnt(4)
    buffer_store_dwordx4 v[140:143], v173, s[80:83], s14 offen sc1
    s_mov_b32 s14, 525312
    s_waitcnt lgkmcnt(3)
    buffer_store_dwordx4 v[144:147], v173, s[80:83], s14 offen sc1
    s_mov_b32 s14, 788480
    s_waitcnt lgkmcnt(2)
    buffer_store_dwordx4 v[148:151], v173, s[80:83], s14 offen sc1
    s_mov_b32 s14, 1051648
    s_waitcnt lgkmcnt(1)
    buffer_store_dwordx4 v[152:155], v173, s[80:83], s14 offen sc1
    s_mov_b32 s14, 1314816
    s_waitcnt lgkmcnt(0)
    buffer_store_dwordx4 v[156:159], v173, s[80:83], s14 offen sc1
    s_lshr_b32 s32, s3, 1
    v_lshrrev_b32 v104, 4, v1
    v_lshlrev_b32 v88, 9, v104
    v_bfe_u32 v105, v1, 2, 2
    v_lshl_add_u32 v88, v105, 5, v88
    v_and_b32 v105, 1, v1
    v_lshl_add_u32 v88, v105, 4, v88
    v_bfe_u32 v105, v1, 1, 1
    v_mul_u32_u24 v105, 4224, v105
    s_lshl_b32 s12, s3, 2
    s_add_u32 s12, s12, 67072
    v_add3_u32 v88, v88, v105, s12
    v_bfe_u32 v90, v1, 2, 2
    v_lshl_add_u32 v90, v90, 3, v104
    v_mul_u32_u24 v90, 320, v90
    v_and_b32 v105, 3, v1
    v_lshl_add_u32 v90, v105, 3, v90
    s_and_b32 s12, s3, 1
    s_mul_i32 s12, s12, 1280
    s_lshr_b32 s14, s3, 1
    s_mul_i32 s15, s14, 160
    s_add_u32 s12, s12, s15
    s_add_u32 s12, s12, 108288
    v_add_u32 v90, s12, v90
    v_and_b32 v104, 15, v1
    v_and_b32 v91, 48, v1
    v_lshl_add_u32 v91, v104, 6, v91
    v_mov_b32 v105, 0x3f803f80
    v_cmp_eq_u32 vcc, 0, v104
    s_nop 1
    v_cndmask_b32 v92, 0, v105, vcc
    v_cndmask_b32 v93, 0, v105, vcc
    v_cndmask_b32 v94, 0, v105, vcc
    v_cndmask_b32 v95, 0, v105, vcc
    v_cmp_eq_u32 vcc, 1, v104
    s_nop 1
    v_cndmask_b32 v96, 0, v105, vcc
    v_cndmask_b32 v97, 0, v105, vcc
    v_cndmask_b32 v98, 0, v105, vcc
    v_cndmask_b32 v99, 0, v105, vcc
    s_waitcnt vmcnt(0)
    s_barrier
    s_and_b32 s43, s2, 128
    s_add_u32 s43, s43, 0
    s_mov_b64 exec, 3
    buffer_atomic_swap v6, v4, s[80:83], s43 offen sc1
    s_mov_b64 exec, -1
    ds_read_b32 v104, v88 offset:0
    ds_read_b32 v105, v88 offset:128
    ds_read_b32 v106, v88 offset:256
    ds_read_b32 v107, v88 offset:384
    ds_read_b32 v108, v88 offset:2048
    ds_read_b32 v109, v88 offset:2176
    ds_read_b32 v110, v88 offset:2304
    ds_read_b32 v111, v88 offset:2432
    ds_read_b32 v112, v88 offset:8448
    ds_read_b32 v113, v88 offset:8576
    ds_read_b32 v114, v88 offset:8704
    ds_read_b32 v115, v88 offset:8832
    ds_read_b32 v116, v88 offset:10496
    ds_read_b32 v117, v88 offset:10624
    ds_read_b32 v118, v88 offset:10752
    ds_read_b32 v119, v88 offset:10880
    ds_read_b32 v120, v88 offset:16896
    ds_read_b32 v121, v88 offset:17024
    ds_read_b32 v122, v88 offset:17152
    ds_read_b32 v123, v88 offset:17280
    ds_read_b32 v124, v88 offset:18944
    ds_read_b32 v125, v88 offset:19072
    ds_read_b32 v126, v88 offset:19200
    ds_read_b32 v127, v88 offset:19328
    s_add_u32 s15, s101, 0
    s_mul_i32 s12, s15, 2731
    s_lshr_b32 s12, s12, 16
    s_mul_i32 s14, s12, 24
    s_sub_u32 s15, s15, s14
    s_lshl_b32 s42, s15, 2
    s_add_u32 s42, s42, s3
    s_lshl_b32 s42, s42, 1
    s_mul_i32 s86, s12, 192
    s_add_u32 s86, s86, s42
    s_lshl_b32 s86, s86, 6
    s_add_u32 s86, s86, 8396800
    s_mul_i32 s41, s12, 3072
    s_add_u32 s41, s41, 8650752
    s_waitcnt lgkmcnt(15)
    v_perm_b32 v128, v105, v104, s8
    v_perm_b32 v129, v107, v106, s8
    v_perm_b32 v130, v109, v108, s8
    v_perm_b32 v131, v111, v110, s8
    s_add_u32 s12, s42, 0
    s_mul_i32 s13, s12, 21846
    s_lshr_b32 s13, s13, 16
    s_mul_i32 s13, s13, 57
    s_add_u32 s12, s12, s13
    s_lshl_b32 s12, s12, 10
    s_add_u32 s12, s12, s41
    v_mfma_f32_16x16x32_bf16 v[100:103], v[128:131], v[92:95], 0
    buffer_store_dwordx4 v[128:131], v2, s[80:83], s12 offen sc1
    v_perm_b32 v132, v105, v104, s9
    v_perm_b32 v133, v107, v106, s9
    v_perm_b32 v134, v109, v108, s9
    v_perm_b32 v135, v111, v110, s9
    s_add_u32 s12, s42, 1
    s_mul_i32 s13, s12, 21846
    s_lshr_b32 s13, s13, 16
    s_mul_i32 s13, s13, 57
    s_add_u32 s12, s12, s13
    s_lshl_b32 s12, s12, 10
    s_add_u32 s12, s12, s41
    v_mfma_f32_16x16x32_bf16 v[100:103], v[132:135], v[96:99], v[100:103]
    buffer_store_dwordx4 v[132:135], v2, s[80:83], s12 offen sc1
    s_mov_b32 exec_lo, 0x00030003
    s_mov_b32 exec_hi, 0x00030003
    s_nop 4
    buffer_store_dwordx4 v[100:103], v91, s[80:83], s86 offen sc1
    s_mov_b64 exec, -1
    s_add_u32 s15, s101, 1
    s_mul_i32 s12, s15, 2731
    s_lshr_b32 s12, s12, 16
    s_mul_i32 s14, s12, 24
    s_sub_u32 s15, s15, s14
    s_lshl_b32 s42, s15, 2
    s_add_u32 s42, s42, s3
    s_lshl_b32 s42, s42, 1
    s_mul_i32 s86, s12, 192
    s_add_u32 s86, s86, s42
    s_lshl_b32 s86, s86, 6
    s_add_u32 s86, s86, 8396800
    s_mul_i32 s41, s12, 3072
    s_add_u32 s41, s41, 8650752
    s_waitcnt lgkmcnt(14)
    v_perm_b32 v136, v113, v112, s8
    s_waitcnt lgkmcnt(12)
    v_perm_b32 v137, v115, v114, s8
    s_waitcnt lgkmcnt(10)
    v_perm_b32 v138, v117, v116, s8
    s_waitcnt lgkmcnt(8)
    v_perm_b32 v139, v119, v118, s8
    s_add_u32 s12, s42, 0
    s_mul_i32 s13, s12, 21846
    s_lshr_b32 s13, s13, 16
    s_mul_i32 s13, s13, 57
    s_add_u32 s12, s12, s13
    s_lshl_b32 s12, s12, 10
    s_add_u32 s12, s12, s41
    v_mfma_f32_16x16x32_bf16 v[100:103], v[136:139], v[92:95], 0
    buffer_store_dwordx4 v[136:139], v2, s[80:83], s12 offen sc1
    v_perm_b32 v140, v113, v112, s9
    v_perm_b32 v141, v115, v114, s9
    v_perm_b32 v142, v117, v116, s9
    v_perm_b32 v143, v119, v118, s9
    s_add_u32 s12, s42, 1
    s_mul_i32 s13, s12, 21846
    s_lshr_b32 s13, s13, 16
    s_mul_i32 s13, s13, 57
    s_add_u32 s12, s12, s13
    s_lshl_b32 s12, s12, 10
    s_add_u32 s12, s12, s41
    v_mfma_f32_16x16x32_bf16 v[100:103], v[140:143], v[96:99], v[100:103]
    buffer_store_dwordx4 v[140:143], v2, s[80:83], s12 offen sc1
    s_mov_b32 exec_lo, 0x00030003
    s_mov_b32 exec_hi, 0x00030003
    s_nop 4
    buffer_store_dwordx4 v[100:103], v91, s[80:83], s86 offen sc1
    s_mov_b64 exec, -1
    s_add_u32 s15, s101, 2
    s_mul_i32 s12, s15, 2731
    s_lshr_b32 s12, s12, 16
    s_mul_i32 s14, s12, 24
    s_sub_u32 s15, s15, s14
    s_lshl_b32 s42, s15, 2
    s_add_u32 s42, s42, s3
    s_lshl_b32 s42, s42, 1
    s_mul_i32 s86, s12, 192
    s_add_u32 s86, s86, s42
    s_lshl_b32 s86, s86, 6
    s_add_u32 s86, s86, 8396800
    s_mul_i32 s41, s12, 3072
    s_add_u32 s41, s41, 8650752
    s_waitcnt lgkmcnt(6)
    v_perm_b32 v128, v121, v120, s8
    s_waitcnt lgkmcnt(4)
    v_perm_b32 v129, v123, v122, s8
    s_waitcnt lgkmcnt(2)
    v_perm_b32 v130, v125, v124, s8
    s_waitcnt lgkmcnt(0)
    v_perm_b32 v131, v127, v126, s8
    s_add_u32 s12, s42, 0
    s_mul_i32 s13, s12, 21846
    s_lshr_b32 s13, s13, 16
    s_mul_i32 s13, s13, 57
    s_add_u32 s12, s12, s13
    s_lshl_b32 s12, s12, 10
    s_add_u32 s12, s12, s41
    v_mfma_f32_16x16x32_bf16 v[100:103], v[128:131], v[92:95], 0
    buffer_store_dwordx4 v[128:131], v2, s[80:83], s12 offen sc1
    v_perm_b32 v132, v121, v120, s9
    v_perm_b32 v133, v123, v122, s9
    v_perm_b32 v134, v125, v124, s9
    v_perm_b32 v135, v127, v126, s9
    s_add_u32 s12, s42, 1
    s_mul_i32 s13, s12, 21846
    s_lshr_b32 s13, s13, 16
    s_mul_i32 s13, s13, 57
    s_add_u32 s12, s12, s13
    s_lshl_b32 s12, s12, 10
    s_add_u32 s12, s12, s41
    v_mfma_f32_16x16x32_bf16 v[100:103], v[132:135], v[96:99], v[100:103]
    buffer_store_dwordx4 v[132:135], v2, s[80:83], s12 offen sc1
    s_mov_b32 exec_lo, 0x00030003
    s_mov_b32 exec_hi, 0x00030003
    s_nop 4
    buffer_store_dwordx4 v[100:103], v91, s[80:83], s86 offen sc1
    s_mov_b64 exec, -1
    s_lshl_b32 s14, s24, 2
    s_add_u32 s14, s14, s3
    s_mul_i32 s14, s14, 20480
    s_mul_i32 s15, s25, 320
    s_add_u32 s14, s14, s15
    s_mul_i32 s12, s3, 5120
    s_add_u32 m0, s12, 108288
    v_add_u32 v121, 0, v1
    v_mul_u32_u24 v122, 3277, v121
    v_lshrrev_b32 v122, 16, v122
    v_mul_u32_u24 v122, 960, v122
    v_lshl_add_u32 v123, v121, 4, v122
    buffer_load_dwordx4 v123, s[72:75], s14 offen nt lds
    s_add_u32 m0, m0, 1024
    v_add_u32 v121, 64, v1
    v_mul_u32_u24 v122, 3277, v121
    v_lshrrev_b32 v122, 16, v122
    v_mul_u32_u24 v122, 960, v122
    v_lshl_add_u32 v123, v121, 4, v122
    buffer_load_dwordx4 v123, s[72:75], s14 offen nt lds
    s_add_u32 m0, m0, 1024
    v_add_u32 v121, 128, v1
    v_mul_u32_u24 v122, 3277, v121
    v_lshrrev_b32 v122, 16, v122
    v_mul_u32_u24 v122, 960, v122
    v_lshl_add_u32 v123, v121, 4, v122
    buffer_load_dwordx4 v123, s[72:75], s14 offen nt lds
    s_add_u32 m0, m0, 1024
    v_add_u32 v121, 192, v1
    v_mul_u32_u24 v122, 3277, v121
    v_lshrrev_b32 v122, 16, v122
    v_mul_u32_u24 v122, 960, v122
    v_lshl_add_u32 v123, v121, 4, v122
    buffer_load_dwordx4 v123, s[72:75], s14 offen nt lds
    s_add_u32 m0, m0, 1024
    v_add_u32 v121, 256, v1
    v_mul_u32_u24 v122, 3277, v121
    v_lshrrev_b32 v122, 16, v122
    v_mul_u32_u24 v122, 960, v122
    v_lshl_add_u32 v123, v121, 4, v122
    buffer_load_dwordx4 v123, s[72:75], s14 offen nt lds
    s_add_u32 m0, m0, 1024
    s_lshl_b32 s25, s25, 1
    s_add_u32 s25, s25, s32
    s_mul_i32 s25, s25, 48
    s_lshl_b32 s24, s24, 1
    s_and_b32 s12, s3, 1
    s_add_u32 s24, s24, s12
    s_add_u32 s24, s24, s25
    s_mul_i32 s24, s24, 5120
    s_add_u32 s24, s24, 12582912
    v_and_b32 v5, 7, v1
    v_and_b32 v252, 56, v1
    v_lshlrev_b32 v252, 5, v252
    v_lshl_add_u32 v5, v5, 4, v252
    s_lshl_b32 s27, s4, 11
    v_add_u32 v5, s27, v5
    s_waitcnt vmcnt(5)
    s_barrier
    s_mov_b32 s43, 16384
    s_mov_b64 exec, 3
    buffer_atomic_swap v6, v4, s[80:83], s43 offen sc1
    s_mov_b64 exec, -1
    s_waitcnt vmcnt(1)
    s_barrier
    ds_read_b64_tr_b16 v[144:145], v90 offset:0
    ds_read_b64_tr_b16 v[146:147], v90 offset:10240
    ds_read_b64_tr_b16 v[148:149], v90 offset:32
    ds_read_b64_tr_b16 v[150:151], v90 offset:10272
    ds_read_b64_tr_b16 v[152:153], v90 offset:64
    ds_read_b64_tr_b16 v[154:155], v90 offset:10304
    ds_read_b64_tr_b16 v[156:157], v90 offset:96
    ds_read_b64_tr_b16 v[158:159], v90 offset:10336
    ds_read_b64_tr_b16 v[160:161], v90 offset:128
    ds_read_b64_tr_b16 v[162:163], v90 offset:10368
    s_waitcnt lgkmcnt(8)
    buffer_store_dwordx4 v[144:147], v2, s[80:83], s24 offen offset:0 sc1
    s_waitcnt lgkmcnt(6)
    buffer_store_dwordx4 v[148:151], v2, s[80:83], s24 offen offset:1024 sc1
    s_waitcnt lgkmcnt(4)
    buffer_store_dwordx4 v[152:155], v2, s[80:83], s24 offen offset:2048 sc1
    s_waitcnt lgkmcnt(2)
    buffer_store_dwordx4 v[156:159], v2, s[80:83], s24 offen offset:3072 sc1
    s_add_u32 s24, s24, 4096
    s_waitcnt lgkmcnt(0)
    buffer_store_dwordx4 v[160:163], v2, s[80:83], s24 offen offset:0 sc1
    s_lshr_b32 s12, s18, 2
    s_mov_b32 s13, 0
    s_mul_i32 s85, s19, 10240
    s_add_u32 s85, s85, 81920
    s_mul_i32 s14, s12, 20480
    s_sub_u32 s85, s85, s14
    s_sub_u32 s14, s85, 81920
    s_min_u32 s23, s85, s14
    s_lshl_b32 s84, s3, 11
    s_add_u32 s84, s84, s23
    s_sub_u32 s14, s84, 81920
    s_min_u32 s84, s84, s14
    s_add_u32 s85, s23, 8192
    s_sub_u32 s14, s85, 81920
    s_min_u32 s85, s85, s14
    s_sub_u32 s23, s23, 1024
    s_cmp_gt_u32 s23, 70656
    s_cselect_b32 s23, 16384, 0
    s_mul_i32 s24, s17, 82048
    s_lshl_b32 s25, s3, 12
    s_add_u32 s24, s24, 5767168
    s_mul_i32 s15, s12, 20480
    s_add_u32 s15, s15, s25
    s_sub_u32 s14, s15, 81920
    s_min_u32 s15, s15, s14
    s_add_u32 s49, s15, s24
    s_add_u32 s15, s15, 16384
    s_sub_u32 s14, s15, 81920
    s_min_u32 s15, s15, s14
    s_add_u32 s50, s15, s24
    s_add_u32 s15, s15, 16384
    s_sub_u32 s14, s15, 81920
    s_min_u32 s15, s15, s14
    s_add_u32 s51, s15, s24
    s_add_u32 s15, s15, 16384
    s_sub_u32 s14, s15, 81920
    s_min_u32 s15, s15, s14
    s_add_u32 s52, s15, s24
    s_add_u32 s15, s15, 16384
    s_sub_u32 s14, s15, 81920
    s_min_u32 s15, s15, s14
    s_add_u32 s53, s15, s24
    s_add_u32 s14, s12, 0
    s_and_b32 s14, s14, 3
    s_mul_i32 s14, s14, 15360
    s_add_u32 s44, s14, s88
    s_add_u32 s14, s12, 1
    s_and_b32 s14, s14, 3
    s_mul_i32 s14, s14, 15360
    s_add_u32 s45, s14, s88
    s_add_u32 s14, s12, 2
    s_and_b32 s14, s14, 3
    s_mul_i32 s14, s14, 15360
    s_add_u32 s46, s14, s88
    s_add_u32 s14, s12, 3
    s_and_b32 s14, s14, 3
    s_mul_i32 s14, s14, 15360
    s_add_u32 s47, s14, s88
    s_lshl_b32 s14, s17, 14
    s_lshl_b32 s15, s3, 8
    s_add_u32 s14, s14, s15
    s_add_u32 s14, s14, 21004288
    s_lshl_b32 s15, s18, 10
    s_add_u32 s48, s14, s15
    s_and_b32 s15, s15, 3072
    s_add_u32 s94, s14, s15
    s_mul_i32 s54, s13, 20480
    s_add_u32 s54, s54, s89
    s_lshl_b32 s57, s13, 12
    s_add_u32 s57, s57, s40
    s_add_u32 s13, s13, 1
    s_sub_u32 s14, s13, 3
    s_min_u32 s13, s13, s14
    s_mul_i32 s55, s13, 20480
    s_add_u32 s55, s55, s89
    s_lshl_b32 s58, s13, 12
    s_add_u32 s58, s58, s40
    s_add_u32 s13, s13, 1
    s_sub_u32 s14, s13, 3
    s_min_u32 s13, s13, s14
    s_mul_i32 s56, s13, 20480
    s_add_u32 s56, s56, s89
    s_lshl_b32 s59, s13, 12
    s_add_u32 s59, s59, s40
    s_lshl_b32 s87, s18, 2
    s_add_u32 s87, s87, s3
    s_mul_i32 s87, s87, 192
    s_add_u32 s87, s87, 8396800
    v_lshrrev_b32 v12, 2, v1
    v_lshlrev_b32 v13, 7, v12
    v_and_b32 v14, 3, v1
    v_lshl_add_u32 v13, v14, 3, v13
    v_bfe_u32 v14, v1, 3, 2
    v_xor_b32 v15, s3, v14
    s_lshl_b32 s13, s20, 1
    v_xor_b32 v16, s13, v14
    v_lshl_add_u32 v17, v16, 5, v13
    v_add_u32 v13, 131072, v13
    v_xor_b32 v16, 0, v15
    v_lshl_add_u32 v8, v16, 5, v13
    v_xor_b32 v16, 1, v15
    v_lshl_add_u32 v9, v16, 5, v13
    v_xor_b32 v16, 2, v15
    v_lshl_add_u32 v10, v16, 5, v13
    v_xor_b32 v16, 3, v15
    v_lshl_add_u32 v11, v16, 5, v13
    v_and_b32 v16, 15, v1
    v_lshlrev_b32 v16, 4, v16
    v_add_u32 v16, s23, v16
    v_add_u32 v16, 131072, v16
    s_xor_b32 s12, s3, 0
    s_lshl_b32 s12, s12, 8
    v_add_u32 v19, s12, v16
    s_xor_b32 s12, s3, 1
    s_lshl_b32 s12, s12, 8
    v_add_u32 v20, s12, v16
    s_xor_b32 s12, s3, 2
    s_lshl_b32 s12, s12, 8
    v_add_u32 v21, s12, v16
    s_xor_b32 s12, s3, 3
    s_lshl_b32 s12, s12, 8
    v_add_u32 v22, s12, v16
    v_lshrrev_b32 v16, 4, v1
    v_xor_b32 v16, s3, v16
    v_mul_u32_u24 v16, 49408, v16
    v_and_b32 v23, 15, v1
    v_lshl_add_u32 v23, v23, 4, v16
    v_and_b32 v16, 3, v1
    v_cmp_eq_u32 s[32:33], 1, v16
    v_cmp_eq_u32 s[34:35], 2, v16
    v_cmp_eq_u32 s[36:37], 3, v16
    s_mul_i32 s22, s17, 197632
    s_lshl_b32 s13, s18, 2
    s_add_u32 s13, s13, s3
    s_mul_i32 s13, s13, 768
    s_add_u32 s22, s22, s13
    s_add_u32 s22, s22, 14680064
    s_mul_i32 s12, s3, 5120
    v_add_u32 v25, s12, v2
    s_lshl_b32 s12, s3, 10
    v_add_u32 v26, s12, v2
    v_and_b32 v27, 15, v1
    v_mul_u32_u24 v27, 1280, v27
    v_lshrrev_b32 v16, 4, v1
    v_lshl_add_u32 v27, v16, 3, v27
    s_lshl_b32 s12, s17, 1
    s_add_u32 s12, s12, s20
    s_mul_i32 s12, s12, 40960
    s_mul_i32 s13, s19, 160
    s_add_u32 s100, s12, s13
    s_lshl_b32 s13, s3, 5
    s_add_u32 s95, s100, s13
    v_and_b32 v24, 7, v1
    v_max_u32 v24, 5, v24
    v_and_b32 v16, 56, v1
    v_lshlrev_b32 v16, 5, v16
    v_lshl_add_u32 v24, v24, 4, v16
    s_lshl_b32 s12, s4, 11
    v_add_u32 v24, s12, v24
    v_and_b32 v12, 15, v1
    v_lshlrev_b32 v12, 4, v12
    v_and_b32 v13, 48, v1
    v_lshl_add_u32 v13, v13, 8, v12
    v_mov_b32 v28, 0x3f803f80
    v_mov_b32 v29, 0x3f803f80
    v_mov_b32 v30, 0x3f803f80
    v_mov_b32 v31, 0x3f803f80
    s_waitcnt vmcnt(0)
    s_cmp_lg_u32 s3, 0
    s_cbranch_scc1 L_skip_2
    s_mov_b32 s27, 16384
    s_mov_b32 s11, 0x20000
L_poll_3:
    buffer_load_dwordx4 v[252:255], v5, s[80:83], s27 offen sc1
    s_waitcnt vmcnt(0)
    v_cmp_eq_u64 vcc, s[92:93], v[252:253]
    v_cmp_eq_u64 s[30:31], s[92:93], v[254:255]
    s_nop 0
    s_and_b64 vcc, vcc, s[30:31]
    s_cmp_eq_u64 vcc, -1
    s_cbranch_scc1 L_polld_4
    s_sub_u32 s11, s11, 1
    s_cbranch_scc0 L_poll_3
L_polld_4:
L_skip_2:
    s_nop 4
    s_barrier
    s_mov_b32 s43, 16512
    s_mov_b64 exec, 3
    buffer_atomic_swap v6, v4, s[80:83], s43 offen sc1
    s_mov_b64 exec, -1
    v_mov_b32 v4, 0x7ff00000
    v_and_b32 v166, 15, v1
    v_mul_u32_u24 v167, 12288, v166
    v_and_or_b32 v167, v1, 48, v167
    v_lshrrev_b32 v166, 2, v166
    v_lshlrev_b32 v166, 28, v166
    v_add_u32 v166, 196608, v166
    v_add_u32 v166, v166, v167
    s_add_u32 s41, s44, 0
    buffer_load_dwordx4 a[0:3], v2, s[80:83], s41 offen offset:0 sc1
    buffer_load_dwordx4 a[4:7], v2, s[80:83], s41 offen offset:1024 sc1
    buffer_load_dwordx4 a[8:11], v2, s[80:83], s41 offen offset:2048 sc1
    buffer_load_dwordx4 a[12:15], v2, s[80:83], s41 offen offset:3072 sc1
    s_add_u32 s41, s44, 4096
    buffer_load_dwordx4 a[16:19], v2, s[80:83], s41 offen offset:0 sc1
    buffer_load_dwordx4 a[20:23], v2, s[80:83], s41 offen offset:1024 sc1
    buffer_load_dwordx4 a[24:27], v2, s[80:83], s41 offen offset:2048 sc1
    buffer_load_dwordx4 a[28:31], v2, s[80:83], s41 offen offset:3072 sc1
    s_add_u32 s41, s44, 8192
    buffer_load_dwordx4 a[32:35], v2, s[80:83], s41 offen offset:0 sc1
    buffer_load_dwordx4 a[36:39], v2, s[80:83], s41 offen offset:1024 sc1
    buffer_load_dwordx4 a[40:43], v2, s[80:83], s41 offen offset:2048 sc1
    buffer_load_dwordx4 a[44:47], v2, s[80:83], s41 offen offset:3072 sc1
    s_add_u32 s41, s44, 12288
    buffer_load_dwordx4 a[48:51], v2, s[80:83], s41 offen offset:0 sc1
    buffer_load_dwordx4 a[52:55], v2, s[80:83], s41 offen offset:1024 sc1
    buffer_load_dwordx4 a[56:59], v2, s[80:83], s41 offen offset:2048 sc1
    s_add_u32 s41, s45, 0
    buffer_load_dwordx4 a[60:63], v2, s[80:83], s41 offen offset:0 sc1
    buffer_load_dwordx4 a[64:67], v2, s[80:83], s41 offen offset:1024 sc1
    buffer_load_dwordx4 a[68:71], v2, s[80:83], s41 offen offset:2048 sc1
    buffer_load_dwordx4 a[72:75], v2, s[80:83], s41 offen offset:3072 sc1
    s_add_u32 s41, s45, 4096
    buffer_load_dwordx4 a[76:79], v2, s[80:83], s41 offen offset:0 sc1
    buffer_load_dwordx4 a[80:83], v2, s[80:83], s41 offen offset:1024 sc1
    buffer_load_dwordx4 a[84:87], v2, s[80:83], s41 offen offset:2048 sc1
    buffer_load_dwordx4 a[88:91], v2, s[80:83], s41 offen offset:3072 sc1
    s_add_u32 s41, s45, 8192
    buffer_load_dwordx4 a[92:95], v2, s[80:83], s41 offen offset:0 sc1
    buffer_load_dwordx4 a[96:99], v2, s[80:83], s41 offen offset:1024 sc1
    buffer_load_dwordx4 a[100:103], v2, s[80:83], s41 offen offset:2048 sc1
    buffer_load_dwordx4 a[104:107], v2, s[80:83], s41 offen offset:3072 sc1
    s_add_u32 s41, s45, 12288
    buffer_load_dwordx4 a[108:111], v2, s[80:83], s41 offen offset:0 sc1
    buffer_load_dwordx4 a[112:115], v2, s[80:83], s41 offen offset:1024 sc1
    buffer_load_dwordx4 a[116:119], v2, s[80:83], s41 offen offset:2048 sc1
    s_add_u32 s41, s46, 0
    buffer_load_dwordx4 a[120:123], v2, s[80:83], s41 offen offset:0 sc1
    buffer_load_dwordx4 a[124:127], v2, s[80:83], s41 offen offset:1024 sc1
    buffer_load_dwordx4 a[128:131], v2, s[80:83], s41 offen offset:2048 sc1
    buffer_load_dwordx4 a[132:135], v2, s[80:83], s41 offen offset:3072 sc1
    s_add_u32 s41, s46, 4096
    buffer_load_dwordx4 a[136:139], v2, s[80:83], s41 offen offset:0 sc1
    buffer_load_dwordx4 a[140:143], v2, s[80:83], s41 offen offset:1024 sc1
    buffer_load_dwordx4 a[144:147], v2, s[80:83], s41 offen offset:2048 sc1
    buffer_load_dwordx4 a[148:151], v2, s[80:83], s41 offen offset:3072 sc1
    s_add_u32 s41, s46, 8192
    buffer_load_dwordx4 a[152:155], v2, s[80:83], s41 offen offset:0 sc1
    buffer_load_dwordx4 a[156:159], v2, s[80:83], s41 offen offset:1024 sc1
    buffer_load_dwordx4 a[160:163], v2, s[80:83], s41 offen offset:2048 sc1
    buffer_load_dwordx4 a[164:167], v2, s[80:83], s41 offen offset:3072 sc1
    v_and_b32 v5, 7, v1
    v_min_u32 v5, 4, v5
    v_and_b32 v252, 56, v1
    v_lshlrev_b32 v252, 5, v252
    v_lshl_add_u32 v5, v5, 4, v252
    s_lshl_b32 s27, s4, 11
    v_add_u32 v5, s27, v5
    s_cmp_lg_u32 s3, 0
    s_cbranch_scc1 L_skip_5
    s_mov_b32 s27, 32768
    s_mov_b32 s11, 0x20000
L_poll_6:
    buffer_load_dwordx4 v[252:255], v5, s[80:83], s27 offen sc1
    s_waitcnt vmcnt(0)
    v_cmp_eq_u64 vcc, s[92:93], v[252:253]
    v_cmp_eq_u64 s[30:31], s[92:93], v[254:255]
    s_nop 0
    s_and_b64 vcc, vcc, s[30:31]
    s_cmp_eq_u64 vcc, -1
    s_cbranch_scc1 L_polld_7
    s_sub_u32 s11, s11, 1
    s_cbranch_scc0 L_poll_6
L_polld_7:
L_skip_5:
    s_nop 4
    s_barrier
    s_add_u32 s24, s49, 0
    s_add_u32 m0, s25, 131072
    s_nop 0
    buffer_load_dwordx4 v2, s[80:83], s24 offen offset:0 sc1 lds
    buffer_load_dwordx4 v2, s[80:83], s24 offen offset:1024 sc1 lds
    buffer_load_dwordx4 v2, s[80:83], s24 offen offset:2048 sc1 lds
    buffer_load_dwordx4 v2, s[80:83], s24 offen offset:3072 sc1 lds
    s_add_u32 s24, s50, 0
    s_add_u32 m0, s25, 147456
    s_nop 0
    buffer_load_dwordx4 v2, s[80:83], s24 offen offset:0 sc1 lds
    buffer_load_dwordx4 v2, s[80:83], s24 offen offset:1024 sc1 lds
    buffer_load_dwordx4 v2, s[80:83], s24 offen offset:2048 sc1 lds
    buffer_load_dwordx4 v2, s[80:83], s24 offen offset:3072 sc1 lds
    buffer_store_dword v6, v4, s[80:83], 0 offen
    buffer_store_dword v6, v4, s[80:83], 0 offen
    s_branch L_gemm
.p2align 6
L_p0_stf:
    v_and_b32 v127, 7, v1
    v_mul_u32_u24 v132, 1280, v127
    v_bfe_u32 v125, v1, 3, 1
    v_lshlrev_b32 v125, 6, v125
    v_and_or_b32 v125, v1, 48, v125
    v_add_u32 v132, v132, v125
    v_mul_u32_u24 v124, 1344, v127
    v_add_u32 v124, 134144, v124
    v_add_u32 v124, v124, v125
    s_mov_b32 s50, 2621440
    s_mov_b32 s51, 0x20000
    s_mov_b32 s54, 2621440
    s_mov_b32 s55, 0x20000
    s_mov_b32 s46, 2621440
    s_mov_b32 s47, 0x20000
    s_mov_b32 s58, 5120
    s_mov_b32 s59, 0x20000
    s_mov_b32 s82, 21790720
    s_mov_b32 s83, 0x20000
    s_mov_b32 s63, 0x20000
    s_mul_i32 s16, s4, 20
    s_add_u32 s16, s16, s5
    s_lshl_b32 s16, s16, 2
    s_add_u32 s16, s16, s3
    s_movk_i32 s62, 4096
    s_mov_b32 s8, 0x05040100
    s_mov_b32 s9, 0x07060302
    s_mov_b32 s10, 0xffff0000
    v_lshlrev_b32 v2, 4, v1
    s_lshl_b32 s14, s3, 12
    s_lshl_b32 s15, s4, 8
    s_add_u32 s14, s14, s15
    s_lshl_b32 s15, s5, 2
    s_add_u32 s14, s14, s15
    v_lshl_add_u32 v4, v1, 11, s14
    s_lshr_b32 s17, s5, 2
    s_lshr_b32 s14, s4, 2
    s_lshl_b32 s14, s14, 3
    s_add_u32 s17, s17, s14
    s_and_b32 s18, s5, 3
    s_and_b32 s14, s4, 3
    s_lshl_b32 s14, s14, 2
    s_add_u32 s18, s18, s14
    s_and_b32 s19, s18, 7
    s_lshr_b32 s20, s18, 3
    s_lshl_b32 s14, s17, 10
    s_lshl_b32 s15, s3, 8
    s_add_u32 s15, s15, s14
    s_lshl_b32 s43, s18, 2
    s_add_u32 s15, s15, s43
    s_cmp_lt_u32 s3, 4
    s_cselect_b32 s15, s15, 0x7ff00000
    v_mov_b32 v3, s15
    s_lshr_b32 s15, s18, 2
    s_lshl_b32 s15, s15, 8
    s_add_u32 s14, s14, s15
    v_and_b32 v7, 3, v1
    v_lshl_add_u32 v7, v7, 4, s14
    s_lshl_b32 s14, s18, 2
    s_add_u32 s14, s14, s3
    s_mul_i32 s88, s14, 61440
    s_add_u32 s88, s88, 8650752
    s_lshl_b32 s14, s19, 2
    s_add_u32 s14, s14, s3
    s_mul_i32 s89, s14, 61440
    s_add_u32 s89, s89, 12582912
    s_lshl_b32 s14, s17, 1
    s_add_u32 s14, s14, s20
    s_mul_i32 s40, s14, 98816
    s_mul_i32 s14, s3, 12288
    s_add_u32 s40, s40, s14
    s_add_u32 s40, s40, 14680064
    v_bfe_u32 v125, v1, 2, 2
    v_mul_u32_u24 v125, 1344, v125
    v_lshrrev_b32 v126, 4, v1
    v_lshl_add_u32 v125, v126, 5, v125
    v_and_b32 v127, 3, v1
    v_lshl_add_u32 v125, v127, 3, v125
    v_add_u32 v125, 134144, v125
    v_lshrrev_b32 v131, 2, v1
    v_mul_u32_u24 v131, 144, v131
    v_lshl_add_u32 v131, v127, 5, v131
    v_add_u32 v131, 16, v131
    v_and_b32 v126, 15, v1
    v_lshrrev_b32 v128, 2, v126
    v_lshl_add_u32 v128, v128, 4, v126
    v_lshlrev_b32 v128, 2, v128
    v_add_u32 v132, s13, v132
    v_lshrrev_b32 v170, 3, v1
    v_and_b32 v171, 7, v1
    v_lshlrev_b32 v171, 4, v171
    v_mul_u32_u24 v172, 144, v170
    s_mul_i32 s15, s3, 5760
    s_add_u32 s15, s15, 0
    v_add3_u32 v172, v172, v171, s15
    v_mul_u32_u24 v173, 32896, v170
    s_mul_i32 s14, s3, 1315840
    s_lshl_b32 s15, s6, 7
    s_add_u32 s14, s14, s15
    v_add3_u32 v173, v173, v171, s14
    s_waitcnt lgkmcnt(0)
    s_mov_b64 s[44:45], s[64:65]
    buffer_load_dwordx4 v[32:35], v132, s[44:47], 0 offen offset:0 nt
    buffer_load_dwordx4 v[36:39], v132, s[44:47], 0 offen offset:128 nt
    buffer_load_dwordx4 v[40:43], v132, s[44:47], 0 offen offset:256 nt
    buffer_load_dwordx4 v[44:47], v132, s[44:47], 0 offen offset:384 nt
    buffer_load_dwordx4 v[48:51], v132, s[44:47], 0 offen offset:512 nt
    buffer_load_dwordx4 v[52:55], v132, s[44:47], 0 offen offset:640 nt
    buffer_load_dwordx4 v[56:59], v132, s[44:47], 0 offen offset:768 nt
    buffer_load_dwordx4 v[60:63], v132, s[44:47], 0 offen offset:896 nt
    buffer_load_dwordx4 v[64:67], v132, s[44:47], 0 offen offset:1024 nt
    buffer_load_dwordx4 v[68:71], v132, s[44:47], 0 offen offset:1152 nt
    s_load_dword s92, s[80:81], 98304
    s_mov_b64 s[64:65], s[78:79]
    s_mov_b64 s[68:69], s[32:33]
    s_mov_b32 s66, 1966080
    s_mov_b32 s67, 0x20000
    s_mov_b32 s70, 1966080
    s_mov_b32 s71, 0x20000
    s_mov_b64 s[72:73], s[34:35]
    s_mov_b32 s74, 1966080
    s_mov_b32 s75, 0x20000
    s_mov_b64 s[76:77], s[36:37]
    s_mov_b32 s78, 2621440
    s_mov_b32 s79, 0x20000
    s_mul_i32 s24, s4, 12
    s_add_u32 s24, s24, s5
    s_sub_u32 s24, s24, 20
    s_mul_i32 s101, s24, 3
    s_and_b32 s25, s24, 3
    s_lshr_b32 s24, s24, 2
    v_lshrrev_b32 v207, 3, v0
    v_mul_u32_u24 v207, 3072, v207
    v_and_b32 v171, 7, v1
    v_lshl_add_u32 v207, v171, 4, v207
    s_add_u32 s15, s101, 0
    s_mul_i32 s12, s15, 2731
    s_lshr_b32 s12, s12, 16
    s_mul_i32 s14, s12, 24
    s_sub_u32 s15, s15, s14
    s_mul_i32 s14, s12, 768
    s_add_u32 s14, s14, s15
    s_lshl_b32 s14, s14, 7
    s_lshl_b32 s12, s3, 10
    s_add_u32 m0, s12, 67072
    s_nop 0
    buffer_load_dwordx4 v207, s[64:67], s14 offen nt lds
    s_add_u32 m0, m0, 4224
    s_nop 0
    buffer_load_dwordx4 v207, s[68:71], s14 offen nt lds
    s_add_u32 s15, s101, 1
    s_mul_i32 s12, s15, 2731
    s_lshr_b32 s12, s12, 16
    s_mul_i32 s14, s12, 24
    s_sub_u32 s15, s15, s14
    s_mul_i32 s14, s12, 768
    s_add_u32 s14, s14, s15
    s_lshl_b32 s14, s14, 7
    s_lshl_b32 s12, s3, 10
    s_add_u32 m0, s12, 75520
    s_nop 0
    buffer_load_dwordx4 v207, s[64:67], s14 offen nt lds
    s_add_u32 m0, m0, 4224
    s_nop 0
    buffer_load_dwordx4 v207, s[68:71], s14 offen nt lds
    s_add_u32 s15, s101, 2
    s_mul_i32 s12, s15, 2731
    s_lshr_b32 s12, s12, 16
    s_mul_i32 s14, s12, 24
    s_sub_u32 s15, s15, s14
    s_mul_i32 s14, s12, 768
    s_add_u32 s14, s14, s15
    s_lshl_b32 s14, s14, 7
    s_lshl_b32 s12, s3, 10
    s_add_u32 m0, s12, 83968
    s_nop 0
    buffer_load_dwordx4 v207, s[64:67], s14 offen nt lds
    s_add_u32 m0, m0, 4224
    s_nop 0
    buffer_load_dwordx4 v207, s[68:71], s14 offen nt lds
    v_mov_b32 v80, 0x3f803f80
    v_mov_b32 v81, 0x3f803f80
    v_mov_b32 v82, 0x3f803f80
    v_mov_b32 v83, 0x3f803f80
    s_waitcnt vmcnt(15)
    ds_write_b128 v124, v[32:35] offset:0
    v_mfma_f32_16x16x32_bf16 v[72:75], v[32:35], v[32:35], 0
    ds_read_b64_tr_b16 v[84:85], v125 offset:0
    v_mfma_f32_16x16x32_bf16 v[76:79], v[80:83], v[32:35], 0
    ds_read_b64_tr_b16 v[86:87], v125 offset:5376
    s_waitcnt vmcnt(14)
    ds_write_b128 v124, v[36:39] offset:128
    v_mfma_f32_16x16x32_bf16 v[72:75], v[36:39], v[36:39], v[72:75]
    ds_read_b64_tr_b16 v[88:89], v125 offset:128
    v_mfma_f32_16x16x32_bf16 v[76:79], v[80:83], v[36:39], v[76:79]
    ds_read_b64_tr_b16 v[90:91], v125 offset:5504
    s_waitcnt vmcnt(13)
    ds_write_b128 v124, v[40:43] offset:256
    v_mfma_f32_16x16x32_bf16 v[72:75], v[40:43], v[40:43], v[72:75]
    ds_read_b64_tr_b16 v[92:93], v125 offset:256
    v_mfma_f32_16x16x32_bf16 v[76:79], v[80:83], v[40:43], v[76:79]
    ds_read_b64_tr_b16 v[94:95], v125 offset:5632
    s_waitcnt vmcnt(12)
    ds_write_b128 v124, v[44:47] offset:384
    v_mfma_f32_16x16x32_bf16 v[72:75], v[44:47], v[44:47], v[72:75]
    ds_read_b64_tr_b16 v[96:97], v125 offset:384
    v_mfma_f32_16x16x32_bf16 v[76:79], v[80:83], v[44:47], v[76:79]
    ds_read_b64_tr_b16 v[98:99], v125 offset:5760
    s_waitcnt vmcnt(11)
    ds_write_b128 v124, v[48:51] offset:512
    v_mfma_f32_16x16x32_bf16 v[72:75], v[48:51], v[48:51], v[72:75]
    ds_read_b64_tr_b16 v[100:101], v125 offset:512
    v_mfma_f32_16x16x32_bf16 v[76:79], v[80:83], v[48:51], v[76:79]
    ds_read_b64_tr_b16 v[102:103], v125 offset:5888
    s_waitcnt vmcnt(10)
    ds_write_b128 v124, v[52:55] offset:640
    v_mfma_f32_16x16x32_bf16 v[72:75], v[52:55], v[52:55], v[72:75]
    ds_read_b64_tr_b16 v[104:105], v125 offset:640
    v_mfma_f32_16x16x32_bf16 v[76:79], v[80:83], v[52:55], v[76:79]
    ds_read_b64_tr_b16 v[106:107], v125 offset:6016
    s_waitcnt vmcnt(9)
    ds_write_b128 v124, v[56:59] offset:768
    v_mfma_f32_16x16x32_bf16 v[72:75], v[56:59], v[56:59], v[72:75]
    ds_read_b64_tr_b16 v[108:109], v125 offset:768
    v_mfma_f32_16x16x32_bf16 v[76:79], v[80:83], v[56:59], v[76:79]
    ds_read_b64_tr_b16 v[110:111], v125 offset:6144
    s_waitcnt vmcnt(8)
    ds_write_b128 v124, v[60:63] offset:896
    v_mfma_f32_16x16x32_bf16 v[72:75], v[60:63], v[60:63], v[72:75]
    ds_read_b64_tr_b16 v[112:113], v125 offset:896
    v_mfma_f32_16x16x32_bf16 v[76:79], v[80:83], v[60:63], v[76:79]
    ds_read_b64_tr_b16 v[114:115], v125 offset:6272
    s_waitcnt vmcnt(7)
    ds_write_b128 v124, v[64:67] offset:1024
    v_mfma_f32_16x16x32_bf16 v[72:75], v[64:67], v[64:67], v[72:75]
    ds_read_b64_tr_b16 v[116:117], v125 offset:1024
    v_mfma_f32_16x16x32_bf16 v[76:79], v[80:83], v[64:67], v[76:79]
    ds_read_b64_tr_b16 v[118:119], v125 offset:6400
    s_waitcnt vmcnt(6)
    ds_write_b128 v124, v[68:71] offset:1152
    v_mfma_f32_16x16x32_bf16 v[72:75], v[68:71], v[68:71], v[72:75]
    ds_read_b64_tr_b16 v[120:121], v125 offset:1152
    v_mfma_f32_16x16x32_bf16 v[76:79], v[80:83], v[68:71], v[76:79]
    ds_read_b64_tr_b16 v[122:123], v125 offset:6528
    s_waitcnt lgkmcnt(0)
    ds_write_b128 v131, v[84:87] offset:0
    ds_write_b128 v131, v[88:91] offset:2304
    ds_write_b128 v131, v[92:95] offset:4608
    ds_write_b128 v131, v[96:99] offset:6912
    ds_write_b128 v131, v[100:103] offset:9216
    ds_write_b128 v131, v[104:107] offset:11520
    ds_write_b128 v131, v[108:111] offset:13824
    ds_write_b128 v131, v[112:115] offset:16128
    ds_write_b128 v131, v[116:119] offset:18432
    ds_write_b128 v131, v[120:123] offset:20736
    v_cmp_eq_u32 vcc, 1, v127
    s_nop 1
    v_cndmask_b32 v72, v72, v73, vcc
    v_cmp_eq_u32 vcc, 2, v127
    s_nop 1
    v_cndmask_b32 v72, v72, v74, vcc
    v_cmp_eq_u32 vcc, 3, v127
    s_nop 1
    v_cndmask_b32 v72, v72, v75, vcc
    ds_bpermute_b32 v129, v128, v72
    v_add_f32_dpp v130, v76, v76 row_ror:8 row_mask:0xf bank_mask:0xf
    s_waitcnt lgkmcnt(0)
    v_add_f32_dpp v129, v129, v129 row_ror:8 row_mask:0xf bank_mask:0xf
    v_mul_f32 v130, 0x3acccccd, v130
    v_mul_f32 v129, 0x3acccccd, v129
    v_fma_f32 v129, -v130, v130, v129
    v_max_f32 v129, 0, v129
    v_add_f32 v129, 0x3727c5ac, v129
    v_rsq_f32 v129, v129
    v_cmp_gt_u32 vcc, 8, v126
    v_mul_f32_e64 v130, -v130, v129
    s_nop 0
    v_cndmask_b32 v129, v130, v129, vcc
    v_lshlrev_b32 v125, 2, v1
    s_lshl_b32 s14, s6, 6
    s_add_u32 s14, s14, 102400
    s_mov_b64 exec, 0xffff
    buffer_store_dword v129, v125, s[80:83], s14 offen sc1
    s_mov_b64 exec, -1
    s_branch L_p0_joinf
L_code_end:
.set CODE_PF_MAX, (L_code_end - sequential_preLN__ssm_conv_h3__glu_gated_swiglu__prompt_kernel - 4) & 0xffffff80
.section .rodata,"a"
.p2align 6
.amdhsa_kernel sequential_preLN__ssm_conv_h3__glu_gated_swiglu__prompt_kernel
  .amdhsa_next_free_vgpr 512
  .amdhsa_next_free_sgpr 102
  .amdhsa_accum_offset 256
  .amdhsa_group_segment_fixed_size 0
  .amdhsa_kernarg_size 104
  .amdhsa_user_sgpr_count 2
  .amdhsa_user_sgpr_kernarg_segment_ptr 1
  .amdhsa_system_sgpr_workgroup_id_x 1
  .amdhsa_float_denorm_mode_32 3
.end_amdhsa_kernel
```
